```python
import torch

def _softmax(x, axis=-1):
    return torch.softmax(x, dim=axis)
def _gelu(x):
    return torch.nn.functional.gelu(x, approximate="tanh")
def _silu(x):
    return torch.nn.functional.silu(x)
def _sigmoid(x):
    return torch.sigmoid(x)
def _layernorm(x, axis=-1, eps=1e-5):
    m = x.mean(dim=axis, keepdim=True)
    v = x.var(dim=axis, keepdim=True, unbiased=False)
    return (x - m) / torch.sqrt(v + eps)
def _scatter_add(tgt, idx, src, axis=0):
    return tgt.clone().index_add_(axis, idx, src)
def _segment_sum(src, seg, n):
    out = torch.zeros((n,) + src.shape[1:], dtype=src.dtype)
    return out.index_add_(0, seg, src)
def _pad(x, pw):
    flat = tuple(v for pair in reversed(pw) for v in pair)
    return torch.nn.functional.pad(x, flat)

kernel_name = 'sequential_preLN__compressed_kv_cla__swiglu_ffn__prompt'

def setup_inputs():

    _w = (lambda a: (lambda t: t.to(torch.bfloat16) if t.is_floating_point() else t)(torch.as_tensor(a)))
    def _A_setup():
        B, H, Sq, Sk, D, M = 1, 32, 2048, 2048, 128, 576
        Dc = 4 * D
        return {
            "x": _w((lambda *s: torch.randn(*s, dtype=torch.bfloat16) * 0.05)(B, Sq, M)),
            "c_kv": _w((lambda *s: torch.randn(*s, dtype=torch.bfloat16) * 0.4)(B, Sk, Dc)),
            "w_q": _w((lambda *s: torch.randn(*s, dtype=torch.bfloat16) * 1.6)(M, H, D) * (M ** -0.5)),
            "w_uk": _w((lambda *s: torch.randn(*s, dtype=torch.bfloat16) * 1.6)(Dc, H, D) * (Dc ** -0.5)),
            "w_uv": _w((lambda *s: torch.randn(*s, dtype=torch.bfloat16) * 0.4)(Dc, H, D) * (Dc ** -0.5)),
            "w_o": _w((lambda *s: torch.randn(*s, dtype=torch.bfloat16) * 0.4)(H, D, M) * ((H * D) ** -0.5)),
        }
    _A_in = _A_setup()

    def _B_setup():
        B, S, D, F = 1, 2048, 576, 4608
        return {
            "x": _w((lambda *s: torch.randn(*s, dtype=torch.bfloat16) * 0.05)(B, S, D)),
            "w_gate": _w((lambda *s: torch.randn(*s, dtype=torch.bfloat16) * 0.05)(D, F)),
            "w_up": _w((lambda *s: torch.randn(*s, dtype=torch.bfloat16) * 0.05)(D, F)),
            "w_down": _w((lambda *s: torch.randn(*s, dtype=torch.bfloat16) * 0.05)(F, D)),
        }
    _B_in = _B_setup()

    return {
        "A_x": _A_in["x"],
        "A_c_kv": _A_in["c_kv"],
        "A_w_q": _A_in["w_q"],
        "A_w_uk": _A_in["w_uk"],
        "A_w_uv": _A_in["w_uv"],
        "A_w_o": _A_in["w_o"],
        "B_x": _B_in["x"],
        "B_w_gate": _B_in["w_gate"],
        "B_w_up": _B_in["w_up"],
        "B_w_down": _B_in["w_down"],
    }

def reference(A_x, A_c_kv, A_w_q, A_w_uk, A_w_uv, A_w_o, B_x, B_w_gate, B_w_up, B_w_down):
    def _A_ref(x, c_kv, w_q, w_uk, w_uv, w_o):
        B, Sq, M = x.shape[0], x.shape[1], x.shape[2]
        Sk = c_kv.shape[1]
        H, D = w_q.shape[1], w_q.shape[2]
        q = torch.einsum("bqm,mhd->bhqd", x, w_q)
        k = torch.einsum("bkc,chd->bhkd", c_kv, w_uk)
        v = torch.einsum("bkc,chd->bhkd", c_kv, w_uv)
        scores = torch.einsum("bhqd,bhkd->bhqk", q, k) * (D ** -0.5)
        off = Sk - Sq
        qi = torch.arange(Sq)[:, None]
        kj = torch.arange(Sk)[None, :]
        cmask = kj <= (qi + off)
        scores = torch.where(cmask[None, None], scores, -1e9)
        p = _softmax(scores, axis=-1)
        ctx = torch.einsum("bhqk,bhkd->bhqd", p, v)
        return torch.einsum("bhqd,hdm->bqm", ctx, w_o)

    def _B_ref(x, w_gate, w_up, w_down):
        g = _silu(x @ w_gate)
        u = x @ w_up
        return (g * u) @ w_down

    x = A_x
    h = x + _A_ref(_layernorm(x, axis=-1), A_c_kv, A_w_q, A_w_uk, A_w_uv, A_w_o)
    h2 = h + _B_ref(_layernorm(h, axis=-1), B_w_gate, B_w_up, B_w_down)
    return h2
```

```asm
; @launch kernel=mega_kernel grid=(256,1,1) block=(512,1,1) lds=163840
.amdgcn_target "amdgcn-amd-amdhsa--gfx950"
.text
.globl mega_kernel
.p2align 8
.type mega_kernel,@function
mega_kernel:
    s_cmp_ge_u32 s2, 256
    s_cbranch_scc1 L_k67c_end
    s_load_dwordx2 s[90:91], s[0:1], 88
    s_load_dwordx4 s[4:7], s[0:1], 0
    s_load_dwordx4 s[8:11], s[0:1], 24
    s_load_dwordx2 s[12:13], s[0:1], 96
    s_load_dwordx2 s[14:15], s[0:1], 16
    v_lshrrev_b32 v1, 6, v0
    v_and_b32 v2, 63, v0
    s_nop 0
    v_readfirstlane_b32 s32, v1
    s_and_b32 s34, s2, 7
    s_lshl_b32 s34, s34, 2
    s_lshr_b32 s48, s2, 3
    s_and_b32 s48, s48, 3
    s_add_u32 s34, s34, s48
    s_lshr_b32 s33, s2, 5
    s_lshr_b32 s35, s32, 1
    s_and_b32 s36, s32, 1
    s_lshl_b32 s40, s32, 11
    s_waitcnt lgkmcnt(0)
    s_lshl_b32 s48, s33, 18
    s_add_u32 s6, s6, s48
    s_addc_u32 s7, s7, 0
    s_mov_b32 s16, s6
    s_and_b32 s17, s7, 0xffff
    s_mov_b32 s18, 262144
    s_mov_b32 s19, 0x00020000
    s_mov_b32 s46, 262144
    s_cmp_ge_u32 s34, 16
    s_cselect_b32 s8, s10, s8
    s_cselect_b32 s9, s11, s9
    s_and_b32 s48, s34, 15
    s_lshl_b32 s48, s48, 9
    s_add_u32 s8, s8, s48
    s_addc_u32 s9, s9, 0
    s_sub_u32 s47, 4194304, s48
    s_mov_b32 s20, s8
    s_and_b32 s21, s9, 0xffff
    s_mov_b32 s22, s47
    s_mov_b32 s23, 0x00020000
    s_mov_b32 s24, s4
    s_and_b32 s25, s5, 0xffff
    s_mov_b32 s26, 2359296
    s_mov_b32 s27, 0x00020000
    s_mov_b32 s28, s12
    s_and_b32 s29, s13, 0xffff
    s_mov_b32 s30, 268435456
    s_mov_b32 s31, 0x00020000
    s_mov_b32 s92, s90
    s_and_b32 s93, s91, 0xffff
    s_mov_b32 s94, 256
    s_mov_b32 s95, 0x00020000
    s_getpc_b64 s[98:99]
L_pc_here:
    s_cmp_lg_u32 s32, 1
    s_cbranch_scc1 L_nocodepf
    s_lshr_b32 s96, s2, 3
    s_mul_i32 s96, s96, 12
    v_add_u32 v16, s96, v2
    v_lshlrev_b32 v16, 7, v16
    v_min_u32 v16, L_code_end-L_pc_here-4, v16
    s_mov_b64 exec, 0xfff
    global_load_dword v17, v16, s[98:99]
    s_mov_b64 exec, -1
L_nocodepf:
    s_cmp_lg_u32 s32, 0
    s_cbranch_scc1 L_zac
    s_lshl_b32 s96, s2, 7
    s_add_u32 s96, s96, 125829120
    v_mov_b32 v16, 0
    v_lshlrev_b32 v17, 15, v0
    s_mov_b64 exec, 0xff
    buffer_store_dword v16, v17, s[28:31], s96 offen sc1
    s_and_b32 s96, s2, 3
    s_lshl_b32 s96, s96, 6
    v_mov_b32 v17, 1
    s_mov_b64 exec, 1
    s_waitcnt vmcnt(0)
    buffer_atomic_add v17, v16, s[92:95], s96 offen sc1
    s_mov_b64 exec, -1
L_zac:
    s_lshl_b32 s49, s2, 3
    s_add_u32 s49, s49, s32
    s_mul_i32 s50, s49, 1152
    v_lshlrev_b32 v3, 4, v2
    v_mov_b32 v8, 0
    v_mov_b32 v9, 0
    v_mov_b32 v10, 0
    v_mov_b32 v11, 0
    buffer_load_dwordx4 v[4:7], v3, s[24:27], s50 offen
    s_mov_b64 exec, 0xff
    buffer_load_dwordx4 v[8:11], v3, s[24:27], s50 offen offset:1024
    s_mov_b64 exec, -1
    v_lshrrev_b32 v20, 3, v2
    s_lshl_b32 s48, s32, 5
    v_add_u32 v20, s48, v20
    v_lshlrev_b32 v20, 10, v20
    v_lshrrev_b32 v21, 5, v2
    v_and_b32 v22, 7, v2
    v_bfe_u32 v24, v2, 4, 1
    v_lshlrev_b32 v24, 2, v24
    v_xor_b32 v22, v22, v24
    v_sub_u32 v23, 0, v21
    v_and_b32 v23, 3, v23
    v_xor_b32 v23, v23, v22
    v_lshl_add_u32 v23, v23, 4, v20
    v_add_u32 v56, 0, v23
    v_sub_u32 v23, 0, v21
    v_and_b32 v23, 3, v23
    v_xor_b32 v23, v23, v22
    v_lshl_add_u32 v23, v23, 4, v20
    v_add_u32 v57, 8192, v23
    v_sub_u32 v23, 2, v21
    v_and_b32 v23, 3, v23
    v_xor_b32 v23, v23, v22
    v_lshl_add_u32 v23, v23, 4, v20
    v_add_u32 v58, 16384, v23
    v_sub_u32 v23, 2, v21
    v_and_b32 v23, 3, v23
    v_xor_b32 v23, v23, v22
    v_lshl_add_u32 v23, v23, 4, v20
    v_add_u32 v59, 24576, v23
    v_lshrrev_b32 v20, 5, v2
    v_bfe_u32 v21, v2, 1, 4
    v_and_b32 v22, 1, v2
    s_and_b32 s48, s35, 1
    s_lshl_b32 s48, s48, 2
    s_lshl_b32 s51, s32, 2
    v_add_u32 v23, 0, v20
    v_or_b32 v24, s48, v23
    v_xor_b32 v24, v24, v21
    v_lshrrev_b32 v25, 1, v24
    v_lshlrev_b32 v25, 2, v25
    v_and_b32 v24, 1, v24
    v_add_u32 v25, v25, v24
    v_lshl_add_u32 v25, v22, 1, v25
    v_add_u32 v23, s51, v23
    v_lshlrev_b32 v23, 13, v23
    v_lshl_add_u32 v66, v25, 4, v23
    v_add_u32 v23, 2, v20
    v_or_b32 v24, s48, v23
    v_xor_b32 v24, v24, v21
    v_lshrrev_b32 v25, 1, v24
    v_lshlrev_b32 v25, 2, v25
    v_and_b32 v24, 1, v24
    v_add_u32 v25, v25, v24
    v_lshl_add_u32 v25, v22, 1, v25
    v_add_u32 v23, s51, v23
    v_lshlrev_b32 v23, 13, v23
    v_lshl_add_u32 v67, v25, 4, v23
    v_and_b32 v62, 15, v2
    v_lshrrev_b32 v61, 4, v2
    v_bfe_u32 v20, v2, 3, 1
    v_lshlrev_b32 v20, 4, v20
    v_and_b32 v21, 7, v2
    v_add_u32 v60, v20, v21
    v_lshrrev_b32 v20, 2, v62
    v_sub_u32 v20, 0, v20
    v_and_b32 v20, 3, v20
    v_xor_b32 v20, v20, v61
    v_bfe_u32 v21, v2, 1, 1
    v_lshl_or_b32 v20, v21, 2, v20
    s_lshl_b32 s48, s35, 6
    v_add_u32 v21, s48, v60
    v_lshlrev_b32 v21, 7, v21
    v_lshl_add_u32 v70, v20, 4, v21
    v_xor_b32 v71, 64, v70
    v_bfe_u32 v20, v2, 2, 2
    v_and_b32 v21, 1, v61
    v_lshl_or_b32 v21, v21, 2, v20
    v_lshl_add_u32 v22, v61, 3, v20
    v_lshlrev_b32 v22, 9, v22
    v_and_b32 v23, 3, v2
    v_lshl_add_u32 v22, v23, 3, v22
    s_lshl_b32 s48, s36, 8
    s_add_u32 s48, s48, 98304
    v_add_u32 v22, s48, v22
    v_xor_b32 v23, 0, v21
    v_lshl_add_u32 v72, v23, 5, v22
    v_xor_b32 v23, 1, v21
    v_lshl_add_u32 v73, v23, 5, v22
    v_xor_b32 v23, 2, v21
    v_lshl_add_u32 v74, v23, 5, v22
    v_xor_b32 v23, 3, v21
    v_lshl_add_u32 v75, v23, 5, v22
    v_xor_b32 v23, 4, v21
    v_lshl_add_u32 v76, v23, 5, v22
    v_xor_b32 v23, 5, v21
    v_lshl_add_u32 v77, v23, 5, v22
    v_xor_b32 v23, 6, v21
    v_lshl_add_u32 v78, v23, 5, v22
    v_xor_b32 v23, 7, v21
    v_lshl_add_u32 v79, v23, 5, v22
    s_mov_b32 s37, 0
    s_mov_b32 s38, 0
    s_mov_b32 s44, 0
    s_mov_b32 s53, 0
    s_lshl_b32 s54, s32, 12
    s_add_u32 s40, s40, 98304
    s_mov_b32 s60, s14
    s_and_b32 s61, s15, 0xffff
    s_mov_b32 s62, 4718592
    s_mov_b32 s63, 0x00020000
    s_lshl_b32 s64, s2, 3
    s_add_u32 s64, s64, s32
    s_lshl_b32 s64, s64, 8
    v_lshlrev_b32 v50, 7, v2
    s_cmp_ge_u32 s34, 16
    s_cbranch_scc1 L_k1_vpath
    s_mov_b32 s39, 0
    s_mov_b32 s57, 0
    s_add_u32 m0, s39, s40
    s_nop 0
    buffer_load_dwordx4 v66, s[20:23], s38 offen lds
    s_add_u32 m0, m0, 1024
    s_nop 0
    buffer_load_dwordx4 v67, s[20:23], s38 offen lds
    s_add_u32 s38, s38, 262144
    s_add_u32 s44, s44, 1
    s_cmp_lt_u32 s44, 16
    s_cselect_b32 s22, s47, 0
    s_add_u32 s39, s39, 16384
    s_cmp_eq_u32 s39, 65536
    s_cselect_b32 s39, 0, s39
    s_add_u32 m0, s57, s54
    s_nop 0
    buffer_load_dwordx4 v56, s[16:19], s37 offen lds
    s_add_u32 m0, m0, 1024
    s_nop 0
    buffer_load_dwordx4 v57, s[16:19], s37 offen lds
    s_add_u32 m0, s57, s54
    s_add_u32 m0, m0, 2048
    s_nop 0
    buffer_load_dwordx4 v58, s[16:19], s37 offen lds
    s_add_u32 m0, m0, 1024
    s_nop 0
    buffer_load_dwordx4 v59, s[16:19], s37 offen lds
    s_add_u32 s37, s37, 128
    s_add_u32 s53, s53, 1
    s_cmp_lt_u32 s53, 8
    s_cselect_b32 s18, s46, 0
    s_add_u32 s57, s57, 32768
    s_cmp_eq_u32 s57, 98304
    s_cselect_b32 s57, 0, s57
    s_add_u32 m0, s39, s40
    s_nop 0
    buffer_load_dwordx4 v66, s[20:23], s38 offen lds
    s_add_u32 m0, m0, 1024
    s_nop 0
    buffer_load_dwordx4 v67, s[20:23], s38 offen lds
    s_add_u32 s38, s38, 262144
    s_add_u32 s44, s44, 1
    s_cmp_lt_u32 s44, 16
    s_cselect_b32 s22, s47, 0
    s_add_u32 s39, s39, 16384
    s_cmp_eq_u32 s39, 65536
    s_cselect_b32 s39, 0, s39
    s_add_u32 m0, s57, s54
    s_nop 0
    buffer_load_dwordx4 v56, s[16:19], s37 offen lds
    s_add_u32 m0, m0, 1024
    s_nop 0
    buffer_load_dwordx4 v57, s[16:19], s37 offen lds
    s_add_u32 m0, s57, s54
    s_add_u32 m0, m0, 2048
    s_nop 0
    buffer_load_dwordx4 v58, s[16:19], s37 offen lds
    s_add_u32 m0, m0, 1024
    s_nop 0
    buffer_load_dwordx4 v59, s[16:19], s37 offen lds
    s_add_u32 s37, s37, 128
    s_add_u32 s53, s53, 1
    s_cmp_lt_u32 s53, 8
    s_cselect_b32 s18, s46, 0
    s_add_u32 s57, s57, 32768
    s_cmp_eq_u32 s57, 98304
    s_cselect_b32 s57, 0, s57
    s_add_u32 m0, s39, s40
    s_nop 0
    buffer_load_dwordx4 v66, s[20:23], s38 offen lds
    s_add_u32 m0, m0, 1024
    s_nop 0
    buffer_load_dwordx4 v67, s[20:23], s38 offen lds
    s_add_u32 s38, s38, 262144
    s_add_u32 s44, s44, 1
    s_cmp_lt_u32 s44, 16
    s_cselect_b32 s22, s47, 0
    s_add_u32 s39, s39, 16384
    s_cmp_eq_u32 s39, 65536
    s_cselect_b32 s39, 0, s39
    s_add_u32 m0, s57, s54
    s_nop 0
    buffer_load_dwordx4 v56, s[16:19], s37 offen lds
    s_add_u32 m0, m0, 1024
    s_nop 0
    buffer_load_dwordx4 v57, s[16:19], s37 offen lds
    s_mov_b64 exec, 3
    buffer_load_dword v51, v50, s[60:63], s64 offen
    s_mov_b64 exec, -1
    s_add_u32 s64, s64, 524288
    s_waitcnt vmcnt(17)
    v_lshlrev_b32 v20, 16, v4
    v_and_b32 v21, 0xffff0000, v4
    v_lshlrev_b32 v22, 16, v5
    v_and_b32 v23, 0xffff0000, v5
    v_lshlrev_b32 v24, 16, v6
    v_and_b32 v25, 0xffff0000, v6
    v_lshlrev_b32 v26, 16, v7
    v_and_b32 v27, 0xffff0000, v7
    v_lshlrev_b32 v28, 16, v8
    v_and_b32 v29, 0xffff0000, v8
    v_lshlrev_b32 v30, 16, v9
    v_and_b32 v31, 0xffff0000, v9
    v_lshlrev_b32 v32, 16, v10
    v_and_b32 v33, 0xffff0000, v10
    v_lshlrev_b32 v34, 16, v11
    v_and_b32 v35, 0xffff0000, v11
    v_add_f32 v36, v20, v21
    v_add_f32 v36, v36, v22
    v_add_f32 v36, v36, v23
    v_add_f32 v36, v36, v24
    v_add_f32 v36, v36, v25
    v_add_f32 v36, v36, v26
    v_add_f32 v36, v36, v27
    v_add_f32 v36, v36, v28
    v_add_f32 v36, v36, v29
    v_add_f32 v36, v36, v30
    v_add_f32 v36, v36, v31
    v_add_f32 v36, v36, v32
    v_add_f32 v36, v36, v33
    v_add_f32 v36, v36, v34
    v_add_f32 v36, v36, v35
    s_nop 1
    v_add_f32_dpp v36, v36, v36 quad_perm:[1,0,3,2] row_mask:0xf bank_mask:0xf
    s_nop 1
    v_add_f32_dpp v36, v36, v36 quad_perm:[2,3,0,1] row_mask:0xf bank_mask:0xf
    s_nop 1
    v_add_f32_dpp v36, v36, v36 row_half_mirror row_mask:0xf bank_mask:0xf
    s_nop 1
    v_add_f32_dpp v36, v36, v36 row_mirror row_mask:0xf bank_mask:0xf
    v_mov_b32 v37, v36
    s_nop 1
    v_permlane16_swap_b32 v36, v37
    s_nop 1
    v_add_f32 v36, v36, v37
    v_mov_b32 v37, v36
    s_nop 1
    v_permlane32_swap_b32 v36, v37
    s_nop 1
    v_add_f32 v36, v36, v37
    v_mul_f32 v36, 0.001736111111111111, v36
    v_mov_b32 v39, 0
    v_sub_f32 v37, v20, v36
    v_fmac_f32 v39, v37, v37
    v_sub_f32 v37, v21, v36
    v_fmac_f32 v39, v37, v37
    v_sub_f32 v37, v22, v36
    v_fmac_f32 v39, v37, v37
    v_sub_f32 v37, v23, v36
    v_fmac_f32 v39, v37, v37
    v_sub_f32 v37, v24, v36
    v_fmac_f32 v39, v37, v37
    v_sub_f32 v37, v25, v36
    v_fmac_f32 v39, v37, v37
    v_sub_f32 v37, v26, v36
    v_fmac_f32 v39, v37, v37
    v_sub_f32 v37, v27, v36
    v_fmac_f32 v39, v37, v37
    s_mov_b64 exec, 0xff
    v_sub_f32 v37, v28, v36
    v_fmac_f32 v39, v37, v37
    v_sub_f32 v37, v29, v36
    v_fmac_f32 v39, v37, v37
    v_sub_f32 v37, v30, v36
    v_fmac_f32 v39, v37, v37
    v_sub_f32 v37, v31, v36
    v_fmac_f32 v39, v37, v37
    v_sub_f32 v37, v32, v36
    v_fmac_f32 v39, v37, v37
    v_sub_f32 v37, v33, v36
    v_fmac_f32 v39, v37, v37
    v_sub_f32 v37, v34, v36
    v_fmac_f32 v39, v37, v37
    v_sub_f32 v37, v35, v36
    v_fmac_f32 v39, v37, v37
    s_mov_b64 exec, -1
    s_nop 1
    v_add_f32_dpp v39, v39, v39 quad_perm:[1,0,3,2] row_mask:0xf bank_mask:0xf
    s_nop 1
    v_add_f32_dpp v39, v39, v39 quad_perm:[2,3,0,1] row_mask:0xf bank_mask:0xf
    s_nop 1
    v_add_f32_dpp v39, v39, v39 row_half_mirror row_mask:0xf bank_mask:0xf
    s_nop 1
    v_add_f32_dpp v39, v39, v39 row_mirror row_mask:0xf bank_mask:0xf
    v_mov_b32 v37, v39
    s_nop 1
    v_permlane16_swap_b32 v39, v37
    s_nop 1
    v_add_f32 v39, v39, v37
    v_mov_b32 v37, v39
    s_nop 1
    v_permlane32_swap_b32 v39, v37
    s_nop 1
    v_add_f32 v39, v39, v37
    v_mul_f32 v39, 0.001736111111111111, v39
    v_cvt_pk_bf16_f32 v37, v39, v39
    v_lshlrev_b32 v39, 16, v37
    v_add_f32 v39, 0x3727c5ac, v39
    v_cvt_pk_bf16_f32 v37, v39, v39
    v_lshlrev_b32 v39, 16, v37
    v_sqrt_f32 v39, v39
    s_nop 0
    v_cvt_pk_bf16_f32 v37, v39, v39
    v_lshlrev_b32 v39, 16, v37
    v_rcp_f32 v39, v39
    v_cvt_pk_bf16_f32 v37, v36, v36
    v_lshlrev_b32 v36, 16, v37
    v_sub_f32 v20, v20, v36
    v_sub_f32 v21, v21, v36
    v_cvt_pk_bf16_f32 v37, v20, v21
    v_lshlrev_b32 v20, 16, v37
    v_and_b32 v21, 0xffff0000, v37
    v_mul_f32 v20, v20, v39
    v_mul_f32 v21, v21, v39
    v_cvt_pk_bf16_f32 v4, v20, v21
    v_sub_f32 v22, v22, v36
    v_sub_f32 v23, v23, v36
    v_cvt_pk_bf16_f32 v37, v22, v23
    v_lshlrev_b32 v22, 16, v37
    v_and_b32 v23, 0xffff0000, v37
    v_mul_f32 v22, v22, v39
    v_mul_f32 v23, v23, v39
    v_cvt_pk_bf16_f32 v5, v22, v23
    v_sub_f32 v24, v24, v36
    v_sub_f32 v25, v25, v36
    v_cvt_pk_bf16_f32 v37, v24, v25
    v_lshlrev_b32 v24, 16, v37
    v_and_b32 v25, 0xffff0000, v37
    v_mul_f32 v24, v24, v39
    v_mul_f32 v25, v25, v39
    v_cvt_pk_bf16_f32 v6, v24, v25
    v_sub_f32 v26, v26, v36
    v_sub_f32 v27, v27, v36
    v_cvt_pk_bf16_f32 v37, v26, v27
    v_lshlrev_b32 v26, 16, v37
    v_and_b32 v27, 0xffff0000, v37
    v_mul_f32 v26, v26, v39
    v_mul_f32 v27, v27, v39
    v_cvt_pk_bf16_f32 v7, v26, v27
    v_sub_f32 v28, v28, v36
    v_sub_f32 v29, v29, v36
    v_cvt_pk_bf16_f32 v37, v28, v29
    v_lshlrev_b32 v28, 16, v37
    v_and_b32 v29, 0xffff0000, v37
    v_mul_f32 v28, v28, v39
    v_mul_f32 v29, v29, v39
    v_cvt_pk_bf16_f32 v8, v28, v29
    v_sub_f32 v30, v30, v36
    v_sub_f32 v31, v31, v36
    v_cvt_pk_bf16_f32 v37, v30, v31
    v_lshlrev_b32 v30, 16, v37
    v_and_b32 v31, 0xffff0000, v37
    v_mul_f32 v30, v30, v39
    v_mul_f32 v31, v31, v39
    v_cvt_pk_bf16_f32 v9, v30, v31
    v_sub_f32 v32, v32, v36
    v_sub_f32 v33, v33, v36
    v_cvt_pk_bf16_f32 v37, v32, v33
    v_lshlrev_b32 v32, 16, v37
    v_and_b32 v33, 0xffff0000, v37
    v_mul_f32 v32, v32, v39
    v_mul_f32 v33, v33, v39
    v_cvt_pk_bf16_f32 v10, v32, v33
    v_sub_f32 v34, v34, v36
    v_sub_f32 v35, v35, v36
    v_cvt_pk_bf16_f32 v37, v34, v35
    v_lshlrev_b32 v34, 16, v37
    v_and_b32 v35, 0xffff0000, v37
    v_mul_f32 v34, v34, v39
    v_mul_f32 v35, v35, v39
    v_cvt_pk_bf16_f32 v11, v34, v35
    s_lshl_b32 s50, s32, 4
    s_add_u32 s50, s50, 147456
    v_lshlrev_b32 v37, 7, v2
    v_add_u32 v37, s50, v37
    ds_write_b128 v37, v[4:7]
    s_mov_b64 exec, 0xff
    ds_write_b128 v37, v[8:11] offset:8192
    s_mov_b64 exec, -1
    s_mul_i32 s50, s32, 72
    v_add_u32 v38, s50, v2
    v_lshlrev_b32 v37, 4, v38
    v_add_u32 v37, 147456, v37
    s_waitcnt lgkmcnt(0)
    s_barrier
    ds_read_b128 v[4:7], v37
    ds_read_b128 v[8:11], v37 offset:1024
    s_lshr_b32 s50, s2, 2
    s_mul_i32 s50, s50, 36864
    s_and_b32 s51, s2, 3
    s_lshl_b32 s51, s51, 7
    s_add_u32 s50, s50, s51
    s_add_u32 s50, s50, 0
    v_lshrrev_b32 v36, 3, v38
    v_lshlrev_b32 v36, 9, v36
    v_and_b32 v39, 7, v38
    v_lshl_add_u32 v40, v39, 4, v36
    v_add_u32 v38, 64, v38
    v_lshrrev_b32 v36, 3, v38
    v_lshlrev_b32 v36, 9, v36
    v_and_b32 v39, 7, v38
    v_lshl_add_u32 v41, v39, 4, v36
    v_add_u32 v38, 64, v38
    s_waitcnt lgkmcnt(0)
    buffer_store_dwordx4 v[4:7], v40, s[28:31], s50 offen sc1
    s_mov_b64 exec, 0xff
    buffer_store_dwordx4 v[8:11], v41, s[28:31], s50 offen sc1
    s_mov_b64 exec, -1
    v_mov_b32 v128, 0
    v_mov_b32 v129, 0
    v_mov_b32 v130, 0
    v_mov_b32 v131, 0
    v_mov_b32 v132, 0
    v_mov_b32 v133, 0
    v_mov_b32 v134, 0
    v_mov_b32 v135, 0
    v_mov_b32 v136, 0
    v_mov_b32 v137, 0
    v_mov_b32 v138, 0
    v_mov_b32 v139, 0
    v_mov_b32 v140, 0
    v_mov_b32 v141, 0
    v_mov_b32 v142, 0
    v_mov_b32 v143, 0
    v_mov_b32 v144, 0
    v_mov_b32 v145, 0
    v_mov_b32 v146, 0
    v_mov_b32 v147, 0
    v_mov_b32 v148, 0
    v_mov_b32 v149, 0
    v_mov_b32 v150, 0
    v_mov_b32 v151, 0
    v_mov_b32 v152, 0
    v_mov_b32 v153, 0
    v_mov_b32 v154, 0
    v_mov_b32 v155, 0
    v_mov_b32 v156, 0
    v_mov_b32 v157, 0
    v_mov_b32 v158, 0
    v_mov_b32 v159, 0
    v_mov_b32 v160, 0
    v_mov_b32 v161, 0
    v_mov_b32 v162, 0
    v_mov_b32 v163, 0
    v_mov_b32 v164, 0
    v_mov_b32 v165, 0
    v_mov_b32 v166, 0
    v_mov_b32 v167, 0
    v_mov_b32 v168, 0
    v_mov_b32 v169, 0
    v_mov_b32 v170, 0
    v_mov_b32 v171, 0
    v_mov_b32 v172, 0
    v_mov_b32 v173, 0
    v_mov_b32 v174, 0
    v_mov_b32 v175, 0
    v_mov_b32 v176, 0
    v_mov_b32 v177, 0
    v_mov_b32 v178, 0
    v_mov_b32 v179, 0
    v_mov_b32 v180, 0
    v_mov_b32 v181, 0
    v_mov_b32 v182, 0
    v_mov_b32 v183, 0
    v_mov_b32 v184, 0
    v_mov_b32 v185, 0
    v_mov_b32 v186, 0
    v_mov_b32 v187, 0
    v_mov_b32 v188, 0
    v_mov_b32 v189, 0
    v_mov_b32 v190, 0
    v_mov_b32 v191, 0
    v_mov_b32 v192, 0
    v_mov_b32 v193, 0
    v_mov_b32 v194, 0
    v_mov_b32 v195, 0
    v_mov_b32 v196, 0
    v_mov_b32 v197, 0
    v_mov_b32 v198, 0
    v_mov_b32 v199, 0
    v_mov_b32 v200, 0
    v_mov_b32 v201, 0
    v_mov_b32 v202, 0
    v_mov_b32 v203, 0
    v_mov_b32 v204, 0
    v_mov_b32 v205, 0
    v_mov_b32 v206, 0
    v_mov_b32 v207, 0
    v_mov_b32 v208, 0
    v_mov_b32 v209, 0
    v_mov_b32 v210, 0
    v_mov_b32 v211, 0
    v_mov_b32 v212, 0
    v_mov_b32 v213, 0
    v_mov_b32 v214, 0
    v_mov_b32 v215, 0
    v_mov_b32 v216, 0
    v_mov_b32 v217, 0
    v_mov_b32 v218, 0
    v_mov_b32 v219, 0
    v_mov_b32 v220, 0
    v_mov_b32 v221, 0
    v_mov_b32 v222, 0
    v_mov_b32 v223, 0
    v_mov_b32 v224, 0
    v_mov_b32 v225, 0
    v_mov_b32 v226, 0
    v_mov_b32 v227, 0
    v_mov_b32 v228, 0
    v_mov_b32 v229, 0
    v_mov_b32 v230, 0
    v_mov_b32 v231, 0
    v_mov_b32 v232, 0
    v_mov_b32 v233, 0
    v_mov_b32 v234, 0
    v_mov_b32 v235, 0
    v_mov_b32 v236, 0
    v_mov_b32 v237, 0
    v_mov_b32 v238, 0
    v_mov_b32 v239, 0
    v_mov_b32 v240, 0
    v_mov_b32 v241, 0
    v_mov_b32 v242, 0
    v_mov_b32 v243, 0
    v_mov_b32 v244, 0
    v_mov_b32 v245, 0
    v_mov_b32 v246, 0
    v_mov_b32 v247, 0
    v_mov_b32 v248, 0
    v_mov_b32 v249, 0
    v_mov_b32 v250, 0
    v_mov_b32 v251, 0
    v_mov_b32 v252, 0
    v_mov_b32 v253, 0
    v_mov_b32 v254, 0
    v_mov_b32 v255, 0
    s_mov_b32 s42, 16384
    s_mov_b32 s52, 16384
    s_mov_b32 s43, 0
    s_mov_b32 s55, 32768
    s_mov_b32 s58, 32768
    s_mov_b32 s56, 0
    s_waitcnt vmcnt(11)
    s_barrier
    ds_read_b128 v[96:99], v70 offset:0
    ds_read_b128 v[100:103], v70 offset:1024
    ds_read_b128 v[104:107], v70 offset:4096
    ds_read_b128 v[108:111], v70 offset:5120
    v_add_u32 v70, s55, v70
    ds_read_b64_tr_b16 v[80:81], v72 offset:0
    ds_read_b64_tr_b16 v[82:83], v72 offset:2048
    v_add_u32 v72, s42, v72
    ds_read_b64_tr_b16 v[84:85], v73 offset:0
    ds_read_b64_tr_b16 v[86:87], v73 offset:2048
    v_add_u32 v73, s42, v73
    ds_read_b64_tr_b16 v[88:89], v74 offset:0
    ds_read_b64_tr_b16 v[90:91], v74 offset:2048
    v_add_u32 v74, s42, v74
    s_mov_b32 s45, 8
L_k1k_loop:
    s_waitcnt vmcnt(8)
    s_barrier
    s_cmp_lg_u32 s45, 6
    s_cbranch_scc1 L_k1k_nopf
    s_cmp_lg_u32 s32, 0
    s_cbranch_scc1 L_ws_xnk1k
    s_lshl_b32 s96, s2, 7
    s_add_u32 s96, s96, 125992960
    v_mov_b32 v52, 1
    v_mov_b32 v53, 0
    s_mov_b64 exec, 1
    buffer_store_dword v52, v53, s[28:31], s96 offen sc1
    s_mov_b64 exec, -1
L_ws_xnk1k:
L_k1k_nopf:
    s_mov_b32 s41, s42
    s_add_u32 s43, s43, 1
    s_cmp_eq_u32 s43, 4
    s_cselect_b32 s43, 0, s43
    s_cmp_eq_u32 s43, 3
    s_cselect_b32 s42, 4294918144, s52
    ds_read_b64_tr_b16 v[92:93], v75 offset:0
    ds_read_b64_tr_b16 v[94:95], v75 offset:2048
    v_add_u32 v75, s41, v75
    ds_read_b128 v[112:115], v71 offset:0
    s_waitcnt lgkmcnt(7)
    v_mfma_f32_16x16x32_bf16 v[128:131], v[80:83], v[96:99], v[128:131]
    s_add_u32 m0, s39, s40
    s_nop 0
    buffer_load_dwordx4 v66, s[20:23], s38 offen lds
    v_mfma_f32_16x16x32_bf16 v[132:135], v[80:83], v[100:103], v[132:135]
    v_mfma_f32_16x16x32_bf16 v[136:139], v[80:83], v[104:107], v[136:139]
    v_mfma_f32_16x16x32_bf16 v[140:143], v[80:83], v[108:111], v[140:143]
    s_add_u32 m0, m0, 1024
    s_nop 0
    buffer_load_dwordx4 v67, s[20:23], s38 offen lds
    s_add_u32 s38, s38, 262144
    s_add_u32 s44, s44, 1
    s_cmp_lt_u32 s44, 16
    s_cselect_b32 s22, s47, 0
    s_add_u32 s39, s39, 16384
    s_cmp_eq_u32 s39, 65536
    s_cselect_b32 s39, 0, s39
    ds_read_b64_tr_b16 v[80:81], v76 offset:0
    ds_read_b64_tr_b16 v[82:83], v76 offset:2048
    v_add_u32 v76, s41, v76
    ds_read_b128 v[116:119], v71 offset:1024
    s_waitcnt lgkmcnt(8)
    v_mfma_f32_16x16x32_bf16 v[144:147], v[84:87], v[96:99], v[144:147]
    v_mfma_f32_16x16x32_bf16 v[148:151], v[84:87], v[100:103], v[148:151]
    v_mfma_f32_16x16x32_bf16 v[152:155], v[84:87], v[104:107], v[152:155]
    s_add_u32 m0, s57, s54
    s_add_u32 m0, m0, 2048
    s_nop 0
    buffer_load_dwordx4 v58, s[16:19], s37 offen lds
    v_mfma_f32_16x16x32_bf16 v[156:159], v[84:87], v[108:111], v[156:159]
    ds_read_b64_tr_b16 v[84:85], v77 offset:0
    ds_read_b64_tr_b16 v[86:87], v77 offset:2048
    v_add_u32 v77, s41, v77
    ds_read_b128 v[120:123], v71 offset:4096
    s_waitcnt lgkmcnt(9)
    v_mfma_f32_16x16x32_bf16 v[160:163], v[88:91], v[96:99], v[160:163]
    v_mfma_f32_16x16x32_bf16 v[164:167], v[88:91], v[100:103], v[164:167]
    s_add_u32 m0, m0, 1024
    s_nop 0
    buffer_load_dwordx4 v59, s[16:19], s37 offen lds
    s_add_u32 s37, s37, 128
    s_add_u32 s53, s53, 1
    s_cmp_lt_u32 s53, 8
    s_cselect_b32 s18, s46, 0
    s_add_u32 s57, s57, 32768
    s_cmp_eq_u32 s57, 98304
    s_cselect_b32 s57, 0, s57
    v_mfma_f32_16x16x32_bf16 v[168:171], v[88:91], v[104:107], v[168:171]
    v_mfma_f32_16x16x32_bf16 v[172:175], v[88:91], v[108:111], v[172:175]
    ds_read_b64_tr_b16 v[88:89], v78 offset:0
    ds_read_b64_tr_b16 v[90:91], v78 offset:2048
    v_add_u32 v78, s41, v78
    ds_read_b128 v[124:127], v71 offset:5120
    v_add_u32 v71, s55, v71
    s_waitcnt lgkmcnt(10)
    v_mfma_f32_16x16x32_bf16 v[176:179], v[92:95], v[96:99], v[176:179]
    s_mov_b64 exec, 3
    buffer_load_dword v51, v50, s[60:63], s64 offen
    s_mov_b64 exec, -1
    s_add_u32 s64, s64, 524288
    v_mfma_f32_16x16x32_bf16 v[180:183], v[92:95], v[100:103], v[180:183]
    v_mfma_f32_16x16x32_bf16 v[184:187], v[92:95], v[104:107], v[184:187]
    v_mfma_f32_16x16x32_bf16 v[188:191], v[92:95], v[108:111], v[188:191]
    ds_read_b64_tr_b16 v[92:93], v79 offset:0
    ds_read_b64_tr_b16 v[94:95], v79 offset:2048
    v_add_u32 v79, s41, v79
    s_waitcnt lgkmcnt(9)
    v_mfma_f32_16x16x32_bf16 v[192:195], v[80:83], v[96:99], v[192:195]
    v_mfma_f32_16x16x32_bf16 v[196:199], v[80:83], v[100:103], v[196:199]
    v_mfma_f32_16x16x32_bf16 v[200:203], v[80:83], v[104:107], v[200:203]
    v_mfma_f32_16x16x32_bf16 v[204:207], v[80:83], v[108:111], v[204:207]
    ds_read_b64_tr_b16 v[80:81], v72 offset:0
    ds_read_b64_tr_b16 v[82:83], v72 offset:2048
    v_add_u32 v72, s42, v72
    s_waitcnt lgkmcnt(8)
    v_mfma_f32_16x16x32_bf16 v[208:211], v[84:87], v[96:99], v[208:211]
    v_mfma_f32_16x16x32_bf16 v[212:215], v[84:87], v[100:103], v[212:215]
    v_mfma_f32_16x16x32_bf16 v[216:219], v[84:87], v[104:107], v[216:219]
    v_mfma_f32_16x16x32_bf16 v[220:223], v[84:87], v[108:111], v[220:223]
    ds_read_b64_tr_b16 v[84:85], v73 offset:0
    ds_read_b64_tr_b16 v[86:87], v73 offset:2048
    v_add_u32 v73, s42, v73
    s_waitcnt lgkmcnt(7)
    v_mfma_f32_16x16x32_bf16 v[224:227], v[88:91], v[96:99], v[224:227]
    v_mfma_f32_16x16x32_bf16 v[228:231], v[88:91], v[100:103], v[228:231]
    v_mfma_f32_16x16x32_bf16 v[232:235], v[88:91], v[104:107], v[232:235]
    v_mfma_f32_16x16x32_bf16 v[236:239], v[88:91], v[108:111], v[236:239]
    ds_read_b64_tr_b16 v[88:89], v74 offset:0
    ds_read_b64_tr_b16 v[90:91], v74 offset:2048
    v_add_u32 v74, s42, v74
    s_waitcnt lgkmcnt(6)
    v_mfma_f32_16x16x32_bf16 v[240:243], v[92:95], v[96:99], v[240:243]
    v_mfma_f32_16x16x32_bf16 v[244:247], v[92:95], v[100:103], v[244:247]
    v_mfma_f32_16x16x32_bf16 v[248:251], v[92:95], v[104:107], v[248:251]
    v_mfma_f32_16x16x32_bf16 v[252:255], v[92:95], v[108:111], v[252:255]
    s_waitcnt vmcnt(8)
    s_barrier
    s_mov_b32 s41, s42
    s_add_u32 s43, s43, 1
    s_cmp_eq_u32 s43, 4
    s_cselect_b32 s43, 0, s43
    s_cmp_eq_u32 s43, 3
    s_cselect_b32 s42, 4294918144, s52
    s_add_u32 s56, s56, 1
    s_cmp_eq_u32 s56, 3
    s_cselect_b32 s56, 0, s56
    s_cmp_eq_u32 s56, 2
    s_cselect_b32 s55, 4294901760, s58
    ds_read_b64_tr_b16 v[92:93], v75 offset:0
    ds_read_b64_tr_b16 v[94:95], v75 offset:2048
    v_add_u32 v75, s41, v75
    ds_read_b128 v[96:99], v70 offset:0
    s_waitcnt lgkmcnt(7)
    v_mfma_f32_16x16x32_bf16 v[128:131], v[80:83], v[112:115], v[128:131]
    s_add_u32 m0, s39, s40
    s_nop 0
    buffer_load_dwordx4 v66, s[20:23], s38 offen lds
    v_mfma_f32_16x16x32_bf16 v[132:135], v[80:83], v[116:119], v[132:135]
    v_mfma_f32_16x16x32_bf16 v[136:139], v[80:83], v[120:123], v[136:139]
    v_mfma_f32_16x16x32_bf16 v[140:143], v[80:83], v[124:127], v[140:143]
    s_add_u32 m0, m0, 1024
    s_nop 0
    buffer_load_dwordx4 v67, s[20:23], s38 offen lds
    s_add_u32 s38, s38, 262144
    s_add_u32 s44, s44, 1
    s_cmp_lt_u32 s44, 16
    s_cselect_b32 s22, s47, 0
    s_add_u32 s39, s39, 16384
    s_cmp_eq_u32 s39, 65536
    s_cselect_b32 s39, 0, s39
    ds_read_b64_tr_b16 v[80:81], v76 offset:0
    ds_read_b64_tr_b16 v[82:83], v76 offset:2048
    v_add_u32 v76, s41, v76
    ds_read_b128 v[100:103], v70 offset:1024
    s_waitcnt lgkmcnt(8)
    v_mfma_f32_16x16x32_bf16 v[144:147], v[84:87], v[112:115], v[144:147]
    v_mfma_f32_16x16x32_bf16 v[148:151], v[84:87], v[116:119], v[148:151]
    v_mfma_f32_16x16x32_bf16 v[152:155], v[84:87], v[120:123], v[152:155]
    s_add_u32 m0, s57, s54
    s_nop 0
    buffer_load_dwordx4 v56, s[16:19], s37 offen lds
    v_mfma_f32_16x16x32_bf16 v[156:159], v[84:87], v[124:127], v[156:159]
    ds_read_b64_tr_b16 v[84:85], v77 offset:0
    ds_read_b64_tr_b16 v[86:87], v77 offset:2048
    v_add_u32 v77, s41, v77
    ds_read_b128 v[104:107], v70 offset:4096
    s_waitcnt lgkmcnt(9)
    v_mfma_f32_16x16x32_bf16 v[160:163], v[88:91], v[112:115], v[160:163]
    v_mfma_f32_16x16x32_bf16 v[164:167], v[88:91], v[116:119], v[164:167]
    s_add_u32 m0, m0, 1024
    s_nop 0
    buffer_load_dwordx4 v57, s[16:19], s37 offen lds
    v_mfma_f32_16x16x32_bf16 v[168:171], v[88:91], v[120:123], v[168:171]
    v_mfma_f32_16x16x32_bf16 v[172:175], v[88:91], v[124:127], v[172:175]
    ds_read_b64_tr_b16 v[88:89], v78 offset:0
    ds_read_b64_tr_b16 v[90:91], v78 offset:2048
    v_add_u32 v78, s41, v78
    ds_read_b128 v[108:111], v70 offset:5120
    v_add_u32 v70, s55, v70
    s_waitcnt lgkmcnt(10)
    v_mfma_f32_16x16x32_bf16 v[176:179], v[92:95], v[112:115], v[176:179]
    s_mov_b64 exec, 3
    buffer_load_dword v51, v50, s[60:63], s64 offen
    s_mov_b64 exec, -1
    s_add_u32 s64, s64, 524288
    v_mfma_f32_16x16x32_bf16 v[180:183], v[92:95], v[116:119], v[180:183]
    v_mfma_f32_16x16x32_bf16 v[184:187], v[92:95], v[120:123], v[184:187]
    v_mfma_f32_16x16x32_bf16 v[188:191], v[92:95], v[124:127], v[188:191]
    ds_read_b64_tr_b16 v[92:93], v79 offset:0
    ds_read_b64_tr_b16 v[94:95], v79 offset:2048
    v_add_u32 v79, s41, v79
    s_waitcnt lgkmcnt(9)
    v_mfma_f32_16x16x32_bf16 v[192:195], v[80:83], v[112:115], v[192:195]
    v_mfma_f32_16x16x32_bf16 v[196:199], v[80:83], v[116:119], v[196:199]
    v_mfma_f32_16x16x32_bf16 v[200:203], v[80:83], v[120:123], v[200:203]
    v_mfma_f32_16x16x32_bf16 v[204:207], v[80:83], v[124:127], v[204:207]
    ds_read_b64_tr_b16 v[80:81], v72 offset:0
    ds_read_b64_tr_b16 v[82:83], v72 offset:2048
    v_add_u32 v72, s42, v72
    s_waitcnt lgkmcnt(8)
    v_mfma_f32_16x16x32_bf16 v[208:211], v[84:87], v[112:115], v[208:211]
    v_mfma_f32_16x16x32_bf16 v[212:215], v[84:87], v[116:119], v[212:215]
    v_mfma_f32_16x16x32_bf16 v[216:219], v[84:87], v[120:123], v[216:219]
    v_mfma_f32_16x16x32_bf16 v[220:223], v[84:87], v[124:127], v[220:223]
    ds_read_b64_tr_b16 v[84:85], v73 offset:0
    ds_read_b64_tr_b16 v[86:87], v73 offset:2048
    v_add_u32 v73, s42, v73
    s_waitcnt lgkmcnt(7)
    v_mfma_f32_16x16x32_bf16 v[224:227], v[88:91], v[112:115], v[224:227]
    v_mfma_f32_16x16x32_bf16 v[228:231], v[88:91], v[116:119], v[228:231]
    v_mfma_f32_16x16x32_bf16 v[232:235], v[88:91], v[120:123], v[232:235]
    v_mfma_f32_16x16x32_bf16 v[236:239], v[88:91], v[124:127], v[236:239]
    ds_read_b64_tr_b16 v[88:89], v74 offset:0
    ds_read_b64_tr_b16 v[90:91], v74 offset:2048
    v_add_u32 v74, s42, v74
    s_waitcnt lgkmcnt(6)
    v_mfma_f32_16x16x32_bf16 v[240:243], v[92:95], v[112:115], v[240:243]
    v_mfma_f32_16x16x32_bf16 v[244:247], v[92:95], v[116:119], v[244:247]
    v_mfma_f32_16x16x32_bf16 v[248:251], v[92:95], v[120:123], v[248:251]
    v_mfma_f32_16x16x32_bf16 v[252:255], v[92:95], v[124:127], v[252:255]
    s_sub_u32 s45, s45, 1
    s_cmp_lg_u32 s45, 0
    s_cbranch_scc1 L_k1k_loop
    s_waitcnt lgkmcnt(0)
    s_nop 7
    s_nop 7
    s_and_b32 s48, s34, 15
    s_lshl_b32 s48, s48, 1
    s_add_u32 s48, s48, s36
    s_lshl_b32 s48, s48, 6
    s_lshl_b32 s49, s33, 3
    s_add_u32 s48, s48, s49
    s_lshl_b32 s49, s35, 1
    s_add_u32 s48, s48, s49
    s_lshl_b32 s48, s48, 13
    s_add_u32 s66, s48, 4194304
    v_bfe_u32 v20, v62, 2, 1
    v_xor_b32 v20, v20, v61
    v_lshlrev_b32 v21, 6, v60
    v_lshl_add_u32 v12, v20, 4, v21
    v_xor_b32 v13, 32, v12
    s_mov_b32 s67, 0
    s_branch L_k12_mid
L_k1_vpath:
    s_mov_b32 s39, 0
    s_mov_b32 s57, 0
    s_add_u32 m0, s39, s40
    s_nop 0
    buffer_load_dwordx4 v66, s[20:23], s38 offen lds
    s_add_u32 m0, m0, 1024
    s_nop 0
    buffer_load_dwordx4 v67, s[20:23], s38 offen lds
    s_add_u32 s38, s38, 262144
    s_add_u32 s44, s44, 1
    s_cmp_lt_u32 s44, 16
    s_cselect_b32 s22, s47, 0
    s_add_u32 s39, s39, 16384
    s_cmp_eq_u32 s39, 65536
    s_cselect_b32 s39, 0, s39
    s_add_u32 m0, s57, s54
    s_nop 0
    buffer_load_dwordx4 v56, s[16:19], s37 offen lds
    s_add_u32 m0, m0, 1024
    s_nop 0
    buffer_load_dwordx4 v57, s[16:19], s37 offen lds
    s_add_u32 m0, s57, s54
    s_add_u32 m0, m0, 2048
    s_nop 0
    buffer_load_dwordx4 v58, s[16:19], s37 offen lds
    s_add_u32 m0, m0, 1024
    s_nop 0
    buffer_load_dwordx4 v59, s[16:19], s37 offen lds
    s_add_u32 s37, s37, 128
    s_add_u32 s53, s53, 1
    s_cmp_lt_u32 s53, 8
    s_cselect_b32 s18, s46, 0
    s_add_u32 s57, s57, 32768
    s_cmp_eq_u32 s57, 98304
    s_cselect_b32 s57, 0, s57
    s_add_u32 m0, s39, s40
    s_nop 0
    buffer_load_dwordx4 v66, s[20:23], s38 offen lds
    s_add_u32 m0, m0, 1024
    s_nop 0
    buffer_load_dwordx4 v67, s[20:23], s38 offen lds
    s_add_u32 s38, s38, 262144
    s_add_u32 s44, s44, 1
    s_cmp_lt_u32 s44, 16
    s_cselect_b32 s22, s47, 0
    s_add_u32 s39, s39, 16384
    s_cmp_eq_u32 s39, 65536
    s_cselect_b32 s39, 0, s39
    s_add_u32 m0, s57, s54
    s_nop 0
    buffer_load_dwordx4 v56, s[16:19], s37 offen lds
    s_add_u32 m0, m0, 1024
    s_nop 0
    buffer_load_dwordx4 v57, s[16:19], s37 offen lds
    s_add_u32 m0, s57, s54
    s_add_u32 m0, m0, 2048
    s_nop 0
    buffer_load_dwordx4 v58, s[16:19], s37 offen lds
    s_add_u32 m0, m0, 1024
    s_nop 0
    buffer_load_dwordx4 v59, s[16:19], s37 offen lds
    s_add_u32 s37, s37, 128
    s_add_u32 s53, s53, 1
    s_cmp_lt_u32 s53, 8
    s_cselect_b32 s18, s46, 0
    s_add_u32 s57, s57, 32768
    s_cmp_eq_u32 s57, 98304
    s_cselect_b32 s57, 0, s57
    s_add_u32 m0, s39, s40
    s_nop 0
    buffer_load_dwordx4 v66, s[20:23], s38 offen lds
    s_add_u32 m0, m0, 1024
    s_nop 0
    buffer_load_dwordx4 v67, s[20:23], s38 offen lds
    s_add_u32 s38, s38, 262144
    s_add_u32 s44, s44, 1
    s_cmp_lt_u32 s44, 16
    s_cselect_b32 s22, s47, 0
    s_add_u32 s39, s39, 16384
    s_cmp_eq_u32 s39, 65536
    s_cselect_b32 s39, 0, s39
    s_add_u32 m0, s57, s54
    s_nop 0
    buffer_load_dwordx4 v56, s[16:19], s37 offen lds
    s_add_u32 m0, m0, 1024
    s_nop 0
    buffer_load_dwordx4 v57, s[16:19], s37 offen lds
    s_mov_b64 exec, 3
    buffer_load_dword v51, v50, s[60:63], s64 offen
    s_mov_b64 exec, -1
    s_add_u32 s64, s64, 524288
    s_waitcnt vmcnt(17)
    v_lshlrev_b32 v20, 16, v4
    v_and_b32 v21, 0xffff0000, v4
    v_lshlrev_b32 v22, 16, v5
    v_and_b32 v23, 0xffff0000, v5
    v_lshlrev_b32 v24, 16, v6
    v_and_b32 v25, 0xffff0000, v6
    v_lshlrev_b32 v26, 16, v7
    v_and_b32 v27, 0xffff0000, v7
    v_lshlrev_b32 v28, 16, v8
    v_and_b32 v29, 0xffff0000, v8
    v_lshlrev_b32 v30, 16, v9
    v_and_b32 v31, 0xffff0000, v9
    v_lshlrev_b32 v32, 16, v10
    v_and_b32 v33, 0xffff0000, v10
    v_lshlrev_b32 v34, 16, v11
    v_and_b32 v35, 0xffff0000, v11
    v_add_f32 v36, v20, v21
    v_add_f32 v36, v36, v22
    v_add_f32 v36, v36, v23
    v_add_f32 v36, v36, v24
    v_add_f32 v36, v36, v25
    v_add_f32 v36, v36, v26
    v_add_f32 v36, v36, v27
    v_add_f32 v36, v36, v28
    v_add_f32 v36, v36, v29
    v_add_f32 v36, v36, v30
    v_add_f32 v36, v36, v31
    v_add_f32 v36, v36, v32
    v_add_f32 v36, v36, v33
    v_add_f32 v36, v36, v34
    v_add_f32 v36, v36, v35
    s_nop 1
    v_add_f32_dpp v36, v36, v36 quad_perm:[1,0,3,2] row_mask:0xf bank_mask:0xf
    s_nop 1
    v_add_f32_dpp v36, v36, v36 quad_perm:[2,3,0,1] row_mask:0xf bank_mask:0xf
    s_nop 1
    v_add_f32_dpp v36, v36, v36 row_half_mirror row_mask:0xf bank_mask:0xf
    s_nop 1
    v_add_f32_dpp v36, v36, v36 row_mirror row_mask:0xf bank_mask:0xf
    v_mov_b32 v37, v36
    s_nop 1
    v_permlane16_swap_b32 v36, v37
    s_nop 1
    v_add_f32 v36, v36, v37
    v_mov_b32 v37, v36
    s_nop 1
    v_permlane32_swap_b32 v36, v37
    s_nop 1
    v_add_f32 v36, v36, v37
    v_mul_f32 v36, 0.001736111111111111, v36
    v_mov_b32 v39, 0
    v_sub_f32 v37, v20, v36
    v_fmac_f32 v39, v37, v37
    v_sub_f32 v37, v21, v36
    v_fmac_f32 v39, v37, v37
    v_sub_f32 v37, v22, v36
    v_fmac_f32 v39, v37, v37
    v_sub_f32 v37, v23, v36
    v_fmac_f32 v39, v37, v37
    v_sub_f32 v37, v24, v36
    v_fmac_f32 v39, v37, v37
    v_sub_f32 v37, v25, v36
    v_fmac_f32 v39, v37, v37
    v_sub_f32 v37, v26, v36
    v_fmac_f32 v39, v37, v37
    v_sub_f32 v37, v27, v36
    v_fmac_f32 v39, v37, v37
    s_mov_b64 exec, 0xff
    v_sub_f32 v37, v28, v36
    v_fmac_f32 v39, v37, v37
    v_sub_f32 v37, v29, v36
    v_fmac_f32 v39, v37, v37
    v_sub_f32 v37, v30, v36
    v_fmac_f32 v39, v37, v37
    v_sub_f32 v37, v31, v36
    v_fmac_f32 v39, v37, v37
    v_sub_f32 v37, v32, v36
    v_fmac_f32 v39, v37, v37
    v_sub_f32 v37, v33, v36
    v_fmac_f32 v39, v37, v37
    v_sub_f32 v37, v34, v36
    v_fmac_f32 v39, v37, v37
    v_sub_f32 v37, v35, v36
    v_fmac_f32 v39, v37, v37
    s_mov_b64 exec, -1
    s_nop 1
    v_add_f32_dpp v39, v39, v39 quad_perm:[1,0,3,2] row_mask:0xf bank_mask:0xf
    s_nop 1
    v_add_f32_dpp v39, v39, v39 quad_perm:[2,3,0,1] row_mask:0xf bank_mask:0xf
    s_nop 1
    v_add_f32_dpp v39, v39, v39 row_half_mirror row_mask:0xf bank_mask:0xf
    s_nop 1
    v_add_f32_dpp v39, v39, v39 row_mirror row_mask:0xf bank_mask:0xf
    v_mov_b32 v37, v39
    s_nop 1
    v_permlane16_swap_b32 v39, v37
    s_nop 1
    v_add_f32 v39, v39, v37
    v_mov_b32 v37, v39
    s_nop 1
    v_permlane32_swap_b32 v39, v37
    s_nop 1
    v_add_f32 v39, v39, v37
    v_mul_f32 v39, 0.001736111111111111, v39
    v_cvt_pk_bf16_f32 v37, v39, v39
    v_lshlrev_b32 v39, 16, v37
    v_add_f32 v39, 0x3727c5ac, v39
    v_cvt_pk_bf16_f32 v37, v39, v39
    v_lshlrev_b32 v39, 16, v37
    v_sqrt_f32 v39, v39
    s_nop 0
    v_cvt_pk_bf16_f32 v37, v39, v39
    v_lshlrev_b32 v39, 16, v37
    v_rcp_f32 v39, v39
    v_cvt_pk_bf16_f32 v37, v36, v36
    v_lshlrev_b32 v36, 16, v37
    v_sub_f32 v20, v20, v36
    v_sub_f32 v21, v21, v36
    v_cvt_pk_bf16_f32 v37, v20, v21
    v_lshlrev_b32 v20, 16, v37
    v_and_b32 v21, 0xffff0000, v37
    v_mul_f32 v20, v20, v39
    v_mul_f32 v21, v21, v39
    v_cvt_pk_bf16_f32 v4, v20, v21
    v_sub_f32 v22, v22, v36
    v_sub_f32 v23, v23, v36
    v_cvt_pk_bf16_f32 v37, v22, v23
    v_lshlrev_b32 v22, 16, v37
    v_and_b32 v23, 0xffff0000, v37
    v_mul_f32 v22, v22, v39
    v_mul_f32 v23, v23, v39
    v_cvt_pk_bf16_f32 v5, v22, v23
    v_sub_f32 v24, v24, v36
    v_sub_f32 v25, v25, v36
    v_cvt_pk_bf16_f32 v37, v24, v25
    v_lshlrev_b32 v24, 16, v37
    v_and_b32 v25, 0xffff0000, v37
    v_mul_f32 v24, v24, v39
    v_mul_f32 v25, v25, v39
    v_cvt_pk_bf16_f32 v6, v24, v25
    v_sub_f32 v26, v26, v36
    v_sub_f32 v27, v27, v36
    v_cvt_pk_bf16_f32 v37, v26, v27
    v_lshlrev_b32 v26, 16, v37
    v_and_b32 v27, 0xffff0000, v37
    v_mul_f32 v26, v26, v39
    v_mul_f32 v27, v27, v39
    v_cvt_pk_bf16_f32 v7, v26, v27
    v_sub_f32 v28, v28, v36
    v_sub_f32 v29, v29, v36
    v_cvt_pk_bf16_f32 v37, v28, v29
    v_lshlrev_b32 v28, 16, v37
    v_and_b32 v29, 0xffff0000, v37
    v_mul_f32 v28, v28, v39
    v_mul_f32 v29, v29, v39
    v_cvt_pk_bf16_f32 v8, v28, v29
    v_sub_f32 v30, v30, v36
    v_sub_f32 v31, v31, v36
    v_cvt_pk_bf16_f32 v37, v30, v31
    v_lshlrev_b32 v30, 16, v37
    v_and_b32 v31, 0xffff0000, v37
    v_mul_f32 v30, v30, v39
    v_mul_f32 v31, v31, v39
    v_cvt_pk_bf16_f32 v9, v30, v31
    v_sub_f32 v32, v32, v36
    v_sub_f32 v33, v33, v36
    v_cvt_pk_bf16_f32 v37, v32, v33
    v_lshlrev_b32 v32, 16, v37
    v_and_b32 v33, 0xffff0000, v37
    v_mul_f32 v32, v32, v39
    v_mul_f32 v33, v33, v39
    v_cvt_pk_bf16_f32 v10, v32, v33
    v_sub_f32 v34, v34, v36
    v_sub_f32 v35, v35, v36
    v_cvt_pk_bf16_f32 v37, v34, v35
    v_lshlrev_b32 v34, 16, v37
    v_and_b32 v35, 0xffff0000, v37
    v_mul_f32 v34, v34, v39
    v_mul_f32 v35, v35, v39
    v_cvt_pk_bf16_f32 v11, v34, v35
    s_lshl_b32 s50, s32, 4
    s_add_u32 s50, s50, 147456
    v_lshlrev_b32 v37, 7, v2
    v_add_u32 v37, s50, v37
    ds_write_b128 v37, v[4:7]
    s_mov_b64 exec, 0xff
    ds_write_b128 v37, v[8:11] offset:8192
    s_mov_b64 exec, -1
    s_mul_i32 s50, s32, 72
    v_add_u32 v38, s50, v2
    v_lshlrev_b32 v37, 4, v38
    v_add_u32 v37, 147456, v37
    s_waitcnt lgkmcnt(0)
    s_barrier
    ds_read_b128 v[4:7], v37
    ds_read_b128 v[8:11], v37 offset:1024
    s_lshr_b32 s50, s2, 2
    s_mul_i32 s50, s50, 36864
    s_and_b32 s51, s2, 3
    s_lshl_b32 s51, s51, 7
    s_add_u32 s50, s50, s51
    s_add_u32 s50, s50, 0
    v_lshrrev_b32 v36, 3, v38
    v_lshlrev_b32 v36, 9, v36
    v_and_b32 v39, 7, v38
    v_lshl_add_u32 v40, v39, 4, v36
    v_add_u32 v38, 64, v38
    v_lshrrev_b32 v36, 3, v38
    v_lshlrev_b32 v36, 9, v36
    v_and_b32 v39, 7, v38
    v_lshl_add_u32 v41, v39, 4, v36
    v_add_u32 v38, 64, v38
    s_waitcnt lgkmcnt(0)
    buffer_store_dwordx4 v[4:7], v40, s[28:31], s50 offen sc1
    s_mov_b64 exec, 0xff
    buffer_store_dwordx4 v[8:11], v41, s[28:31], s50 offen sc1
    s_mov_b64 exec, -1
    v_mov_b32 v128, 0
    v_mov_b32 v129, 0
    v_mov_b32 v130, 0
    v_mov_b32 v131, 0
    v_mov_b32 v132, 0
    v_mov_b32 v133, 0
    v_mov_b32 v134, 0
    v_mov_b32 v135, 0
    v_mov_b32 v136, 0
    v_mov_b32 v137, 0
    v_mov_b32 v138, 0
    v_mov_b32 v139, 0
    v_mov_b32 v140, 0
    v_mov_b32 v141, 0
    v_mov_b32 v142, 0
    v_mov_b32 v143, 0
    v_mov_b32 v144, 0
    v_mov_b32 v145, 0
    v_mov_b32 v146, 0
    v_mov_b32 v147, 0
    v_mov_b32 v148, 0
    v_mov_b32 v149, 0
    v_mov_b32 v150, 0
    v_mov_b32 v151, 0
    v_mov_b32 v152, 0
    v_mov_b32 v153, 0
    v_mov_b32 v154, 0
    v_mov_b32 v155, 0
    v_mov_b32 v156, 0
    v_mov_b32 v157, 0
    v_mov_b32 v158, 0
    v_mov_b32 v159, 0
    v_mov_b32 v160, 0
    v_mov_b32 v161, 0
    v_mov_b32 v162, 0
    v_mov_b32 v163, 0
    v_mov_b32 v164, 0
    v_mov_b32 v165, 0
    v_mov_b32 v166, 0
    v_mov_b32 v167, 0
    v_mov_b32 v168, 0
    v_mov_b32 v169, 0
    v_mov_b32 v170, 0
    v_mov_b32 v171, 0
    v_mov_b32 v172, 0
    v_mov_b32 v173, 0
    v_mov_b32 v174, 0
    v_mov_b32 v175, 0
    v_mov_b32 v176, 0
    v_mov_b32 v177, 0
    v_mov_b32 v178, 0
    v_mov_b32 v179, 0
    v_mov_b32 v180, 0
    v_mov_b32 v181, 0
    v_mov_b32 v182, 0
    v_mov_b32 v183, 0
    v_mov_b32 v184, 0
    v_mov_b32 v185, 0
    v_mov_b32 v186, 0
    v_mov_b32 v187, 0
    v_mov_b32 v188, 0
    v_mov_b32 v189, 0
    v_mov_b32 v190, 0
    v_mov_b32 v191, 0
    v_mov_b32 v192, 0
    v_mov_b32 v193, 0
    v_mov_b32 v194, 0
    v_mov_b32 v195, 0
    v_mov_b32 v196, 0
    v_mov_b32 v197, 0
    v_mov_b32 v198, 0
    v_mov_b32 v199, 0
    v_mov_b32 v200, 0
    v_mov_b32 v201, 0
    v_mov_b32 v202, 0
    v_mov_b32 v203, 0
    v_mov_b32 v204, 0
    v_mov_b32 v205, 0
    v_mov_b32 v206, 0
    v_mov_b32 v207, 0
    v_mov_b32 v208, 0
    v_mov_b32 v209, 0
    v_mov_b32 v210, 0
    v_mov_b32 v211, 0
    v_mov_b32 v212, 0
    v_mov_b32 v213, 0
    v_mov_b32 v214, 0
    v_mov_b32 v215, 0
    v_mov_b32 v216, 0
    v_mov_b32 v217, 0
    v_mov_b32 v218, 0
    v_mov_b32 v219, 0
    v_mov_b32 v220, 0
    v_mov_b32 v221, 0
    v_mov_b32 v222, 0
    v_mov_b32 v223, 0
    v_mov_b32 v224, 0
    v_mov_b32 v225, 0
    v_mov_b32 v226, 0
    v_mov_b32 v227, 0
    v_mov_b32 v228, 0
    v_mov_b32 v229, 0
    v_mov_b32 v230, 0
    v_mov_b32 v231, 0
    v_mov_b32 v232, 0
    v_mov_b32 v233, 0
    v_mov_b32 v234, 0
    v_mov_b32 v235, 0
    v_mov_b32 v236, 0
    v_mov_b32 v237, 0
    v_mov_b32 v238, 0
    v_mov_b32 v239, 0
    v_mov_b32 v240, 0
    v_mov_b32 v241, 0
    v_mov_b32 v242, 0
    v_mov_b32 v243, 0
    v_mov_b32 v244, 0
    v_mov_b32 v245, 0
    v_mov_b32 v246, 0
    v_mov_b32 v247, 0
    v_mov_b32 v248, 0
    v_mov_b32 v249, 0
    v_mov_b32 v250, 0
    v_mov_b32 v251, 0
    v_mov_b32 v252, 0
    v_mov_b32 v253, 0
    v_mov_b32 v254, 0
    v_mov_b32 v255, 0
    s_mov_b32 s42, 16384
    s_mov_b32 s52, 16384
    s_mov_b32 s43, 0
    s_mov_b32 s55, 32768
    s_mov_b32 s58, 32768
    s_mov_b32 s56, 0
    s_waitcnt vmcnt(11)
    s_barrier
    ds_read_b128 v[96:99], v70 offset:0
    ds_read_b128 v[100:103], v70 offset:1024
    ds_read_b128 v[104:107], v70 offset:4096
    ds_read_b128 v[108:111], v70 offset:5120
    v_add_u32 v70, s55, v70
    ds_read_b64_tr_b16 v[80:81], v72 offset:0
    ds_read_b64_tr_b16 v[82:83], v72 offset:2048
    v_add_u32 v72, s42, v72
    ds_read_b64_tr_b16 v[84:85], v73 offset:0
    ds_read_b64_tr_b16 v[86:87], v73 offset:2048
    v_add_u32 v73, s42, v73
    ds_read_b64_tr_b16 v[88:89], v74 offset:0
    ds_read_b64_tr_b16 v[90:91], v74 offset:2048
    v_add_u32 v74, s42, v74
    s_mov_b32 s45, 8
L_k1v_loop:
    s_waitcnt vmcnt(8)
    s_barrier
    s_cmp_lg_u32 s45, 6
    s_cbranch_scc1 L_k1v_nopf
    s_cmp_lg_u32 s32, 0
    s_cbranch_scc1 L_ws_xnk1v
    s_lshl_b32 s96, s2, 7
    s_add_u32 s96, s96, 125992960
    v_mov_b32 v52, 1
    v_mov_b32 v53, 0
    s_mov_b64 exec, 1
    buffer_store_dword v52, v53, s[28:31], s96 offen sc1
    s_mov_b64 exec, -1
L_ws_xnk1v:
L_k1v_nopf:
    s_mov_b32 s41, s42
    s_add_u32 s43, s43, 1
    s_cmp_eq_u32 s43, 4
    s_cselect_b32 s43, 0, s43
    s_cmp_eq_u32 s43, 3
    s_cselect_b32 s42, 4294918144, s52
    ds_read_b64_tr_b16 v[92:93], v75 offset:0
    ds_read_b64_tr_b16 v[94:95], v75 offset:2048
    v_add_u32 v75, s41, v75
    ds_read_b128 v[112:115], v71 offset:0
    s_waitcnt lgkmcnt(7)
    v_mfma_f32_16x16x32_bf16 v[128:131], v[96:99], v[80:83], v[128:131]
    s_add_u32 m0, s39, s40
    s_nop 0
    buffer_load_dwordx4 v66, s[20:23], s38 offen lds
    v_mfma_f32_16x16x32_bf16 v[132:135], v[100:103], v[80:83], v[132:135]
    v_mfma_f32_16x16x32_bf16 v[136:139], v[104:107], v[80:83], v[136:139]
    v_mfma_f32_16x16x32_bf16 v[140:143], v[108:111], v[80:83], v[140:143]
    s_add_u32 m0, m0, 1024
    s_nop 0
    buffer_load_dwordx4 v67, s[20:23], s38 offen lds
    s_add_u32 s38, s38, 262144
    s_add_u32 s44, s44, 1
    s_cmp_lt_u32 s44, 16
    s_cselect_b32 s22, s47, 0
    s_add_u32 s39, s39, 16384
    s_cmp_eq_u32 s39, 65536
    s_cselect_b32 s39, 0, s39
    ds_read_b64_tr_b16 v[80:81], v76 offset:0
    ds_read_b64_tr_b16 v[82:83], v76 offset:2048
    v_add_u32 v76, s41, v76
    ds_read_b128 v[116:119], v71 offset:1024
    s_waitcnt lgkmcnt(8)
    v_mfma_f32_16x16x32_bf16 v[144:147], v[96:99], v[84:87], v[144:147]
    v_mfma_f32_16x16x32_bf16 v[148:151], v[100:103], v[84:87], v[148:151]
    v_mfma_f32_16x16x32_bf16 v[152:155], v[104:107], v[84:87], v[152:155]
    s_add_u32 m0, s57, s54
    s_add_u32 m0, m0, 2048
    s_nop 0
    buffer_load_dwordx4 v58, s[16:19], s37 offen lds
    v_mfma_f32_16x16x32_bf16 v[156:159], v[108:111], v[84:87], v[156:159]
    ds_read_b64_tr_b16 v[84:85], v77 offset:0
    ds_read_b64_tr_b16 v[86:87], v77 offset:2048
    v_add_u32 v77, s41, v77
    ds_read_b128 v[120:123], v71 offset:4096
    s_waitcnt lgkmcnt(9)
    v_mfma_f32_16x16x32_bf16 v[160:163], v[96:99], v[88:91], v[160:163]
    v_mfma_f32_16x16x32_bf16 v[164:167], v[100:103], v[88:91], v[164:167]
    s_add_u32 m0, m0, 1024
    s_nop 0
    buffer_load_dwordx4 v59, s[16:19], s37 offen lds
    s_add_u32 s37, s37, 128
    s_add_u32 s53, s53, 1
    s_cmp_lt_u32 s53, 8
    s_cselect_b32 s18, s46, 0
    s_add_u32 s57, s57, 32768
    s_cmp_eq_u32 s57, 98304
    s_cselect_b32 s57, 0, s57
    v_mfma_f32_16x16x32_bf16 v[168:171], v[104:107], v[88:91], v[168:171]
    v_mfma_f32_16x16x32_bf16 v[172:175], v[108:111], v[88:91], v[172:175]
    ds_read_b64_tr_b16 v[88:89], v78 offset:0
    ds_read_b64_tr_b16 v[90:91], v78 offset:2048
    v_add_u32 v78, s41, v78
    ds_read_b128 v[124:127], v71 offset:5120
    v_add_u32 v71, s55, v71
    s_waitcnt lgkmcnt(10)
    v_mfma_f32_16x16x32_bf16 v[176:179], v[96:99], v[92:95], v[176:179]
    s_mov_b64 exec, 3
    buffer_load_dword v51, v50, s[60:63], s64 offen
    s_mov_b64 exec, -1
    s_add_u32 s64, s64, 524288
    v_mfma_f32_16x16x32_bf16 v[180:183], v[100:103], v[92:95], v[180:183]
    v_mfma_f32_16x16x32_bf16 v[184:187], v[104:107], v[92:95], v[184:187]
    v_mfma_f32_16x16x32_bf16 v[188:191], v[108:111], v[92:95], v[188:191]
    ds_read_b64_tr_b16 v[92:93], v79 offset:0
    ds_read_b64_tr_b16 v[94:95], v79 offset:2048
    v_add_u32 v79, s41, v79
    s_waitcnt lgkmcnt(9)
    v_mfma_f32_16x16x32_bf16 v[192:195], v[96:99], v[80:83], v[192:195]
    v_mfma_f32_16x16x32_bf16 v[196:199], v[100:103], v[80:83], v[196:199]
    v_mfma_f32_16x16x32_bf16 v[200:203], v[104:107], v[80:83], v[200:203]
    v_mfma_f32_16x16x32_bf16 v[204:207], v[108:111], v[80:83], v[204:207]
    ds_read_b64_tr_b16 v[80:81], v72 offset:0
    ds_read_b64_tr_b16 v[82:83], v72 offset:2048
    v_add_u32 v72, s42, v72
    s_waitcnt lgkmcnt(8)
    v_mfma_f32_16x16x32_bf16 v[208:211], v[96:99], v[84:87], v[208:211]
    v_mfma_f32_16x16x32_bf16 v[212:215], v[100:103], v[84:87], v[212:215]
    v_mfma_f32_16x16x32_bf16 v[216:219], v[104:107], v[84:87], v[216:219]
    v_mfma_f32_16x16x32_bf16 v[220:223], v[108:111], v[84:87], v[220:223]
    ds_read_b64_tr_b16 v[84:85], v73 offset:0
    ds_read_b64_tr_b16 v[86:87], v73 offset:2048
    v_add_u32 v73, s42, v73
    s_waitcnt lgkmcnt(7)
    v_mfma_f32_16x16x32_bf16 v[224:227], v[96:99], v[88:91], v[224:227]
    v_mfma_f32_16x16x32_bf16 v[228:231], v[100:103], v[88:91], v[228:231]
    v_mfma_f32_16x16x32_bf16 v[232:235], v[104:107], v[88:91], v[232:235]
    v_mfma_f32_16x16x32_bf16 v[236:239], v[108:111], v[88:91], v[236:239]
    ds_read_b64_tr_b16 v[88:89], v74 offset:0
    ds_read_b64_tr_b16 v[90:91], v74 offset:2048
    v_add_u32 v74, s42, v74
    s_waitcnt lgkmcnt(6)
    v_mfma_f32_16x16x32_bf16 v[240:243], v[96:99], v[92:95], v[240:243]
    v_mfma_f32_16x16x32_bf16 v[244:247], v[100:103], v[92:95], v[244:247]
    v_mfma_f32_16x16x32_bf16 v[248:251], v[104:107], v[92:95], v[248:251]
    v_mfma_f32_16x16x32_bf16 v[252:255], v[108:111], v[92:95], v[252:255]
    s_waitcnt vmcnt(8)
    s_barrier
    s_mov_b32 s41, s42
    s_add_u32 s43, s43, 1
    s_cmp_eq_u32 s43, 4
    s_cselect_b32 s43, 0, s43
    s_cmp_eq_u32 s43, 3
    s_cselect_b32 s42, 4294918144, s52
    s_add_u32 s56, s56, 1
    s_cmp_eq_u32 s56, 3
    s_cselect_b32 s56, 0, s56
    s_cmp_eq_u32 s56, 2
    s_cselect_b32 s55, 4294901760, s58
    ds_read_b64_tr_b16 v[92:93], v75 offset:0
    ds_read_b64_tr_b16 v[94:95], v75 offset:2048
    v_add_u32 v75, s41, v75
    ds_read_b128 v[96:99], v70 offset:0
    s_waitcnt lgkmcnt(7)
    v_mfma_f32_16x16x32_bf16 v[128:131], v[112:115], v[80:83], v[128:131]
    s_add_u32 m0, s39, s40
    s_nop 0
    buffer_load_dwordx4 v66, s[20:23], s38 offen lds
    v_mfma_f32_16x16x32_bf16 v[132:135], v[116:119], v[80:83], v[132:135]
    v_mfma_f32_16x16x32_bf16 v[136:139], v[120:123], v[80:83], v[136:139]
    v_mfma_f32_16x16x32_bf16 v[140:143], v[124:127], v[80:83], v[140:143]
    s_add_u32 m0, m0, 1024
    s_nop 0
    buffer_load_dwordx4 v67, s[20:23], s38 offen lds
    s_add_u32 s38, s38, 262144
    s_add_u32 s44, s44, 1
    s_cmp_lt_u32 s44, 16
    s_cselect_b32 s22, s47, 0
    s_add_u32 s39, s39, 16384
    s_cmp_eq_u32 s39, 65536
    s_cselect_b32 s39, 0, s39
    ds_read_b64_tr_b16 v[80:81], v76 offset:0
    ds_read_b64_tr_b16 v[82:83], v76 offset:2048
    v_add_u32 v76, s41, v76
    ds_read_b128 v[100:103], v70 offset:1024
    s_waitcnt lgkmcnt(8)
    v_mfma_f32_16x16x32_bf16 v[144:147], v[112:115], v[84:87], v[144:147]
    v_mfma_f32_16x16x32_bf16 v[148:151], v[116:119], v[84:87], v[148:151]
    v_mfma_f32_16x16x32_bf16 v[152:155], v[120:123], v[84:87], v[152:155]
    s_add_u32 m0, s57, s54
    s_nop 0
    buffer_load_dwordx4 v56, s[16:19], s37 offen lds
    v_mfma_f32_16x16x32_bf16 v[156:159], v[124:127], v[84:87], v[156:159]
    ds_read_b64_tr_b16 v[84:85], v77 offset:0
    ds_read_b64_tr_b16 v[86:87], v77 offset:2048
    v_add_u32 v77, s41, v77
    ds_read_b128 v[104:107], v70 offset:4096
    s_waitcnt lgkmcnt(9)
    v_mfma_f32_16x16x32_bf16 v[160:163], v[112:115], v[88:91], v[160:163]
    v_mfma_f32_16x16x32_bf16 v[164:167], v[116:119], v[88:91], v[164:167]
    s_add_u32 m0, m0, 1024
    s_nop 0
    buffer_load_dwordx4 v57, s[16:19], s37 offen lds
    v_mfma_f32_16x16x32_bf16 v[168:171], v[120:123], v[88:91], v[168:171]
    v_mfma_f32_16x16x32_bf16 v[172:175], v[124:127], v[88:91], v[172:175]
    ds_read_b64_tr_b16 v[88:89], v78 offset:0
    ds_read_b64_tr_b16 v[90:91], v78 offset:2048
    v_add_u32 v78, s41, v78
    ds_read_b128 v[108:111], v70 offset:5120
    v_add_u32 v70, s55, v70
    s_waitcnt lgkmcnt(10)
    v_mfma_f32_16x16x32_bf16 v[176:179], v[112:115], v[92:95], v[176:179]
    s_mov_b64 exec, 3
    buffer_load_dword v51, v50, s[60:63], s64 offen
    s_mov_b64 exec, -1
    s_add_u32 s64, s64, 524288
    v_mfma_f32_16x16x32_bf16 v[180:183], v[116:119], v[92:95], v[180:183]
    v_mfma_f32_16x16x32_bf16 v[184:187], v[120:123], v[92:95], v[184:187]
    v_mfma_f32_16x16x32_bf16 v[188:191], v[124:127], v[92:95], v[188:191]
    ds_read_b64_tr_b16 v[92:93], v79 offset:0
    ds_read_b64_tr_b16 v[94:95], v79 offset:2048
    v_add_u32 v79, s41, v79
    s_waitcnt lgkmcnt(9)
    v_mfma_f32_16x16x32_bf16 v[192:195], v[112:115], v[80:83], v[192:195]
    v_mfma_f32_16x16x32_bf16 v[196:199], v[116:119], v[80:83], v[196:199]
    v_mfma_f32_16x16x32_bf16 v[200:203], v[120:123], v[80:83], v[200:203]
    v_mfma_f32_16x16x32_bf16 v[204:207], v[124:127], v[80:83], v[204:207]
    ds_read_b64_tr_b16 v[80:81], v72 offset:0
    ds_read_b64_tr_b16 v[82:83], v72 offset:2048
    v_add_u32 v72, s42, v72
    s_waitcnt lgkmcnt(8)
    v_mfma_f32_16x16x32_bf16 v[208:211], v[112:115], v[84:87], v[208:211]
    v_mfma_f32_16x16x32_bf16 v[212:215], v[116:119], v[84:87], v[212:215]
    v_mfma_f32_16x16x32_bf16 v[216:219], v[120:123], v[84:87], v[216:219]
    v_mfma_f32_16x16x32_bf16 v[220:223], v[124:127], v[84:87], v[220:223]
    ds_read_b64_tr_b16 v[84:85], v73 offset:0
    ds_read_b64_tr_b16 v[86:87], v73 offset:2048
    v_add_u32 v73, s42, v73
    s_waitcnt lgkmcnt(7)
    v_mfma_f32_16x16x32_bf16 v[224:227], v[112:115], v[88:91], v[224:227]
    v_mfma_f32_16x16x32_bf16 v[228:231], v[116:119], v[88:91], v[228:231]
    v_mfma_f32_16x16x32_bf16 v[232:235], v[120:123], v[88:91], v[232:235]
    v_mfma_f32_16x16x32_bf16 v[236:239], v[124:127], v[88:91], v[236:239]
    ds_read_b64_tr_b16 v[88:89], v74 offset:0
    ds_read_b64_tr_b16 v[90:91], v74 offset:2048
    v_add_u32 v74, s42, v74
    s_waitcnt lgkmcnt(6)
    v_mfma_f32_16x16x32_bf16 v[240:243], v[112:115], v[92:95], v[240:243]
    v_mfma_f32_16x16x32_bf16 v[244:247], v[116:119], v[92:95], v[244:247]
    v_mfma_f32_16x16x32_bf16 v[248:251], v[120:123], v[92:95], v[248:251]
    v_mfma_f32_16x16x32_bf16 v[252:255], v[124:127], v[92:95], v[252:255]
    s_sub_u32 s45, s45, 1
    s_cmp_lg_u32 s45, 0
    s_cbranch_scc1 L_k1v_loop
    s_waitcnt lgkmcnt(0)
    s_nop 7
    s_nop 7
    s_and_b32 s48, s34, 15
    s_lshl_b32 s48, s48, 1
    s_add_u32 s48, s48, s36
    s_lshl_b32 s48, s48, 6
    s_lshl_b32 s49, s33, 3
    s_add_u32 s48, s48, s49
    s_lshl_b32 s49, s35, 1
    s_add_u32 s48, s48, s49
    s_lshl_b32 s48, s48, 13
    s_add_u32 s66, s48, 20971520
    v_bfe_u32 v20, v62, 2, 1
    v_xor_b32 v20, v20, v61
    v_lshlrev_b32 v21, 6, v60
    v_lshl_add_u32 v12, v20, 4, v21
    v_xor_b32 v13, 32, v12
    s_mov_b32 s67, 1
L_k12_mid:
    s_waitcnt vmcnt(0)
    s_barrier
    s_load_dwordx2 s[4:5], s[0:1], 16
    s_load_dwordx2 s[6:7], s[0:1], 96
    s_load_dwordx2 s[8:9], s[0:1], 40
    s_load_dwordx4 s[12:15], s[0:1], 56
    s_load_dwordx2 s[10:11], s[0:1], 72
    v_lshrrev_b32 v1, 6, v0
    v_and_b32 v2, 63, v0
    s_nop 0
    v_readfirstlane_b32 s32, v1
    s_and_b32 s33, s2, 7
    s_lshl_b32 s33, s33, 2
    s_lshr_b32 s48, s2, 3
    s_and_b32 s48, s48, 3
    s_add_u32 s33, s33, s48
    s_lshr_b32 s34, s2, 5
    s_and_b32 s35, s32, 3
    s_lshr_b32 s36, s32, 2
    v_lshlrev_b32 v27, 4, v2
    s_waitcnt lgkmcnt(0)
    s_lshl_b32 s48, s33, 8
    s_add_u32 s4, s4, s48
    s_addc_u32 s5, s5, 0
    s_sub_u32 s49, 4718592, s48
    s_mov_b32 s16, s4
    s_and_b32 s17, s5, 0xffff
    s_mov_b32 s18, s49
    s_mov_b32 s19, 0x00020000
    s_mov_b32 s20, s6
    s_and_b32 s21, s7, 0xffff
    s_mov_b32 s22, 268435456
    s_mov_b32 s23, 0x00020000
    s_mov_b32 s24, s6
    s_and_b32 s25, s7, 0xffff
    s_mov_b32 s26, 268435456
    s_mov_b32 s27, 0x00020000
    s_mov_b32 s28, s6
    s_and_b32 s29, s7, 0xffff
    s_mov_b32 s30, 268435456
    s_mov_b32 s31, 0x00020000
    s_sub_u32 s48, 15, s34
    s_cmp_eq_u32 s36, 1
    s_cselect_b32 s48, s48, s34
    s_lshl_b32 s48, s48, 2
    s_add_u32 s48, s48, s35
    s_mul_i32 s50, s48, 36864
    s_add_u32 s50, s50, 0
    v_lshrrev_b32 v3, 4, v2
    v_bfe_u32 v4, v2, 2, 2
    v_xor_b32 v4, v4, v3
    v_lshlrev_b32 v4, 6, v4
    v_and_b32 v5, 3, v2
    v_lshl_add_u32 v4, v5, 4, v4
    s_lshl_b32 s48, s32, 3
    v_add_u32 v3, s48, v3
    v_lshl_add_u32 v24, v3, 13, v4
    v_add_u32 v25, 32768, v24
    s_lshl_b32 s51, s32, 11
    s_add_u32 s51, s51, 65536
    s_add_u32 m0, s51, 0
    s_mov_b32 s52, 0
    buffer_load_dwordx4 v24, s[16:19], s52 offen lds
    s_add_u32 m0, m0, 1024
    s_nop 0
    buffer_load_dwordx4 v25, s[16:19], s52 offen lds
    s_add_u32 m0, s51, 16384
    s_mov_b32 s52, 524288
    buffer_load_dwordx4 v24, s[16:19], s52 offen lds
    s_add_u32 m0, m0, 1024
    s_nop 0
    buffer_load_dwordx4 v25, s[16:19], s52 offen lds
    s_add_u32 m0, s51, 32768
    s_mov_b32 s52, 1048576
    buffer_load_dwordx4 v24, s[16:19], s52 offen lds
    s_add_u32 m0, m0, 1024
    s_nop 0
    buffer_load_dwordx4 v25, s[16:19], s52 offen lds
    s_add_u32 m0, s51, 49152
    s_mov_b32 s52, 1572864
    buffer_load_dwordx4 v24, s[16:19], s52 offen lds
    s_add_u32 m0, m0, 1024
    s_nop 0
    buffer_load_dwordx4 v25, s[16:19], s52 offen lds
    s_cmp_eq_u32 s67, 1
    s_cbranch_scc1 L_k12_vpk
    v_cvt_pk_bf16_f32 v128, v128, v129
    v_cvt_pk_bf16_f32 v129, v130, v131
    v_cvt_pk_bf16_f32 v130, v144, v145
    v_cvt_pk_bf16_f32 v131, v146, v147
    v_cvt_pk_bf16_f32 v132, v132, v133
    v_cvt_pk_bf16_f32 v133, v134, v135
    v_cvt_pk_bf16_f32 v134, v148, v149
    v_cvt_pk_bf16_f32 v135, v150, v151
    v_cvt_pk_bf16_f32 v136, v136, v137
    v_cvt_pk_bf16_f32 v137, v138, v139
    v_cvt_pk_bf16_f32 v138, v152, v153
    v_cvt_pk_bf16_f32 v139, v154, v155
    v_cvt_pk_bf16_f32 v140, v140, v141
    v_cvt_pk_bf16_f32 v141, v142, v143
    v_cvt_pk_bf16_f32 v142, v156, v157
    v_cvt_pk_bf16_f32 v143, v158, v159
    v_cvt_pk_bf16_f32 v160, v160, v161
    v_cvt_pk_bf16_f32 v161, v162, v163
    v_cvt_pk_bf16_f32 v162, v176, v177
    v_cvt_pk_bf16_f32 v163, v178, v179
    v_cvt_pk_bf16_f32 v164, v164, v165
    v_cvt_pk_bf16_f32 v165, v166, v167
    v_cvt_pk_bf16_f32 v166, v180, v181
    v_cvt_pk_bf16_f32 v167, v182, v183
    v_cvt_pk_bf16_f32 v168, v168, v169
    v_cvt_pk_bf16_f32 v169, v170, v171
    v_cvt_pk_bf16_f32 v170, v184, v185
    v_cvt_pk_bf16_f32 v171, v186, v187
    v_cvt_pk_bf16_f32 v172, v172, v173
    v_cvt_pk_bf16_f32 v173, v174, v175
    v_cvt_pk_bf16_f32 v174, v188, v189
    v_cvt_pk_bf16_f32 v175, v190, v191
    v_cvt_pk_bf16_f32 v192, v192, v193
    v_cvt_pk_bf16_f32 v193, v194, v195
    v_cvt_pk_bf16_f32 v194, v208, v209
    v_cvt_pk_bf16_f32 v195, v210, v211
    v_cvt_pk_bf16_f32 v196, v196, v197
    v_cvt_pk_bf16_f32 v197, v198, v199
    v_cvt_pk_bf16_f32 v198, v212, v213
    v_cvt_pk_bf16_f32 v199, v214, v215
    v_cvt_pk_bf16_f32 v200, v200, v201
    v_cvt_pk_bf16_f32 v201, v202, v203
    v_cvt_pk_bf16_f32 v202, v216, v217
    v_cvt_pk_bf16_f32 v203, v218, v219
    v_cvt_pk_bf16_f32 v204, v204, v205
    v_cvt_pk_bf16_f32 v205, v206, v207
    v_cvt_pk_bf16_f32 v206, v220, v221
    v_cvt_pk_bf16_f32 v207, v222, v223
    v_cvt_pk_bf16_f32 v224, v224, v225
    v_cvt_pk_bf16_f32 v225, v226, v227
    v_cvt_pk_bf16_f32 v226, v240, v241
    v_cvt_pk_bf16_f32 v227, v242, v243
    v_cvt_pk_bf16_f32 v228, v228, v229
    v_cvt_pk_bf16_f32 v229, v230, v231
    v_cvt_pk_bf16_f32 v230, v244, v245
    v_cvt_pk_bf16_f32 v231, v246, v247
    v_cvt_pk_bf16_f32 v232, v232, v233
    v_cvt_pk_bf16_f32 v233, v234, v235
    v_cvt_pk_bf16_f32 v234, v248, v249
    v_cvt_pk_bf16_f32 v235, v250, v251
    v_cvt_pk_bf16_f32 v236, v236, v237
    v_cvt_pk_bf16_f32 v237, v238, v239
    v_cvt_pk_bf16_f32 v238, v252, v253
    v_cvt_pk_bf16_f32 v239, v254, v255
    s_branch L_k12_pkdone
L_k12_vpk:
    v_cvt_pk_bf16_f32 v128, v128, v129
    v_cvt_pk_bf16_f32 v129, v130, v131
    v_cvt_pk_bf16_f32 v130, v132, v133
    v_cvt_pk_bf16_f32 v131, v134, v135
    v_cvt_pk_bf16_f32 v132, v136, v137
    v_cvt_pk_bf16_f32 v133, v138, v139
    v_cvt_pk_bf16_f32 v134, v140, v141
    v_cvt_pk_bf16_f32 v135, v142, v143
    v_cvt_pk_bf16_f32 v136, v144, v145
    v_cvt_pk_bf16_f32 v137, v146, v147
    v_cvt_pk_bf16_f32 v138, v148, v149
    v_cvt_pk_bf16_f32 v139, v150, v151
    v_cvt_pk_bf16_f32 v140, v152, v153
    v_cvt_pk_bf16_f32 v141, v154, v155
    v_cvt_pk_bf16_f32 v142, v156, v157
    v_cvt_pk_bf16_f32 v143, v158, v159
    v_cvt_pk_bf16_f32 v160, v160, v161
    v_cvt_pk_bf16_f32 v161, v162, v163
    v_cvt_pk_bf16_f32 v162, v164, v165
    v_cvt_pk_bf16_f32 v163, v166, v167
    v_cvt_pk_bf16_f32 v164, v168, v169
    v_cvt_pk_bf16_f32 v165, v170, v171
    v_cvt_pk_bf16_f32 v166, v172, v173
    v_cvt_pk_bf16_f32 v167, v174, v175
    v_cvt_pk_bf16_f32 v168, v176, v177
    v_cvt_pk_bf16_f32 v169, v178, v179
    v_cvt_pk_bf16_f32 v170, v180, v181
    v_cvt_pk_bf16_f32 v171, v182, v183
    v_cvt_pk_bf16_f32 v172, v184, v185
    v_cvt_pk_bf16_f32 v173, v186, v187
    v_cvt_pk_bf16_f32 v174, v188, v189
    v_cvt_pk_bf16_f32 v175, v190, v191
    v_cvt_pk_bf16_f32 v192, v192, v193
    v_cvt_pk_bf16_f32 v193, v194, v195
    v_cvt_pk_bf16_f32 v194, v196, v197
    v_cvt_pk_bf16_f32 v195, v198, v199
    v_cvt_pk_bf16_f32 v196, v200, v201
    v_cvt_pk_bf16_f32 v197, v202, v203
    v_cvt_pk_bf16_f32 v198, v204, v205
    v_cvt_pk_bf16_f32 v199, v206, v207
    v_cvt_pk_bf16_f32 v200, v208, v209
    v_cvt_pk_bf16_f32 v201, v210, v211
    v_cvt_pk_bf16_f32 v202, v212, v213
    v_cvt_pk_bf16_f32 v203, v214, v215
    v_cvt_pk_bf16_f32 v204, v216, v217
    v_cvt_pk_bf16_f32 v205, v218, v219
    v_cvt_pk_bf16_f32 v206, v220, v221
    v_cvt_pk_bf16_f32 v207, v222, v223
    v_cvt_pk_bf16_f32 v224, v224, v225
    v_cvt_pk_bf16_f32 v225, v226, v227
    v_cvt_pk_bf16_f32 v226, v228, v229
    v_cvt_pk_bf16_f32 v227, v230, v231
    v_cvt_pk_bf16_f32 v228, v232, v233
    v_cvt_pk_bf16_f32 v229, v234, v235
    v_cvt_pk_bf16_f32 v230, v236, v237
    v_cvt_pk_bf16_f32 v231, v238, v239
    v_cvt_pk_bf16_f32 v232, v240, v241
    v_cvt_pk_bf16_f32 v233, v242, v243
    v_cvt_pk_bf16_f32 v234, v244, v245
    v_cvt_pk_bf16_f32 v235, v246, v247
    v_cvt_pk_bf16_f32 v236, v248, v249
    v_cvt_pk_bf16_f32 v237, v250, v251
    v_cvt_pk_bf16_f32 v238, v252, v253
    v_cvt_pk_bf16_f32 v239, v254, v255
L_k12_pkdone:
    s_cmp_lg_u32 s32, 0
    s_cbranch_scc1 L_zw_z_done
    v_lshlrev_b32 v17, 6, v0
    s_mov_b32 s96, 0x100000
    s_mov_b64 exec, 15
L_zw_z_loop:
    buffer_load_dword v16, v17, s[92:95], 0 offen sc1
    s_waitcnt vmcnt(0)
    v_cmp_ne_u32 vcc, 64, v16
    s_nop 1
    s_cbranch_vccz L_zw_z_ok
    s_sleep 8
    s_sub_u32 s96, s96, 1
    s_cmp_lg_u32 s96, 0
    s_cbranch_scc1 L_zw_z_loop
L_zw_z_ok:
    s_mov_b64 exec, -1
L_zw_z_done:
    s_cmp_lg_u32 s32, 0
    s_cbranch_scc1 L_ww_xn_done
    v_and_b32 v16, 63, v0
    s_lshl_b32 s48, s34, 4
    s_sub_u32 s49, 224, s48
    v_cmp_gt_u32 vcc, 16, v16
    v_mov_b32 v19, s49
    v_mov_b32 v17, s48
    v_cndmask_b32 v17, v19, v17, vcc
    v_add_u32 v17, v17, v16
    v_lshlrev_b32 v17, 7, v17
    s_mov_b32 s97, 125992960
    s_mov_b32 s96, 0x100000
    s_mov_b64 exec, 4294967295
L_ww_xn_loop:
    buffer_load_dword v18, v17, s[28:31], s97 offen sc1
    s_waitcnt vmcnt(0)
    v_cmp_ne_u32 vcc, 1, v18
    s_nop 1
    s_cbranch_vccz L_ww_xn_ok
    s_sleep 2
    s_sub_u32 s96, s96, 1
    s_cmp_lg_u32 s96, 0
    s_cbranch_scc1 L_ww_xn_loop
L_ww_xn_ok:
    s_mov_b64 exec, -1
L_ww_xn_done:
    s_barrier
    buffer_load_dwordx4 v[48:51], v27, s[20:23], s50 offen offset:0
    buffer_load_dwordx4 v[52:55], v27, s[20:23], s50 offen offset:1024
    buffer_load_dwordx4 v[56:59], v27, s[20:23], s50 offen offset:2048
    buffer_load_dwordx4 v[60:63], v27, s[20:23], s50 offen offset:3072
    s_add_u32 s50, s50, 4096
    buffer_load_dwordx4 v[64:67], v27, s[20:23], s50 offen offset:0
    buffer_load_dwordx4 v[68:71], v27, s[20:23], s50 offen offset:1024
    buffer_load_dwordx4 v[72:75], v27, s[20:23], s50 offen offset:2048
    buffer_load_dwordx4 v[76:79], v27, s[20:23], s50 offen offset:3072
    s_add_u32 s50, s50, 4096
    buffer_load_dwordx4 v[80:83], v27, s[20:23], s50 offen offset:0
    buffer_load_dwordx4 v[84:87], v27, s[20:23], s50 offen offset:1024
    buffer_load_dwordx4 v[88:91], v27, s[20:23], s50 offen offset:2048
    buffer_load_dwordx4 v[92:95], v27, s[20:23], s50 offen offset:3072
    s_add_u32 s50, s50, 4096
    buffer_load_dwordx4 v[96:99], v27, s[20:23], s50 offen offset:0
    buffer_load_dwordx4 v[100:103], v27, s[20:23], s50 offen offset:1024
    buffer_load_dwordx4 v[104:107], v27, s[20:23], s50 offen offset:2048
    buffer_load_dwordx4 v[108:111], v27, s[20:23], s50 offen offset:3072
    s_lshl_b32 s48, s33, 19
    s_bfe_u32 s59, s32, 0x10001
    s_and_b32 s49, s32, 1
    s_lshl_b32 s49, s49, 12
    s_add_u32 s40, s48, s49
    s_add_u32 s58, s40, 4194304
    s_xor_b32 s49, s59, 1
    s_lshl_b32 s49, s49, 13
    s_add_u32 s40, s58, s49
    s_lshl_b32 s49, s35, 12
    s_add_u32 s41, s48, s49
    s_add_u32 s41, s41, 20971520
    s_lshl_b32 s42, s32, 12
    s_add_u32 s45, s42, 32768
    s_lshl_b32 s37, s34, 1
    s_add_u32 s37, s37, 2
    v_lshrrev_b32 v3, 5, v2
    v_bfe_u32 v4, v2, 2, 2
    v_lshl_add_u32 v3, v3, 3, v4
    v_lshlrev_b32 v3, 8, v3
    v_bfe_u32 v5, v2, 4, 1
    v_lshl_add_u32 v3, v5, 5, v3
    v_and_b32 v5, 3, v2
    v_lshl_add_u32 v3, v5, 3, v3
    v_add_u32 v3, 65536, v3
    v_xor_b32 v5, 0, v4
    v_lshl_add_u32 v28, v5, 6, v3
    v_xor_b32 v5, 1, v4
    v_lshl_add_u32 v29, v5, 6, v3
    v_xor_b32 v5, 2, v4
    v_lshl_add_u32 v30, v5, 6, v3
    v_xor_b32 v5, 3, v4
    v_lshl_add_u32 v31, v5, 6, v3
    v_mov_b32 v144, 0
    v_mov_b32 v145, 0
    v_mov_b32 v146, 0
    v_mov_b32 v147, 0
    v_mov_b32 v148, 0
    v_mov_b32 v149, 0
    v_mov_b32 v150, 0
    v_mov_b32 v151, 0
    v_mov_b32 v152, 0
    v_mov_b32 v153, 0
    v_mov_b32 v154, 0
    v_mov_b32 v155, 0
    v_mov_b32 v156, 0
    v_mov_b32 v157, 0
    v_mov_b32 v158, 0
    v_mov_b32 v159, 0
    v_mov_b32 v176, 0
    v_mov_b32 v177, 0
    v_mov_b32 v178, 0
    v_mov_b32 v179, 0
    v_mov_b32 v180, 0
    v_mov_b32 v181, 0
    v_mov_b32 v182, 0
    v_mov_b32 v183, 0
    v_mov_b32 v184, 0
    v_mov_b32 v185, 0
    v_mov_b32 v186, 0
    v_mov_b32 v187, 0
    v_mov_b32 v188, 0
    v_mov_b32 v189, 0
    v_mov_b32 v190, 0
    v_mov_b32 v191, 0
    v_mov_b32 v208, 0
    v_mov_b32 v209, 0
    v_mov_b32 v210, 0
    v_mov_b32 v211, 0
    v_mov_b32 v212, 0
    v_mov_b32 v213, 0
    v_mov_b32 v214, 0
    v_mov_b32 v215, 0
    v_mov_b32 v216, 0
    v_mov_b32 v217, 0
    v_mov_b32 v218, 0
    v_mov_b32 v219, 0
    v_mov_b32 v220, 0
    v_mov_b32 v221, 0
    v_mov_b32 v222, 0
    v_mov_b32 v223, 0
    v_mov_b32 v240, 0
    v_mov_b32 v241, 0
    v_mov_b32 v242, 0
    v_mov_b32 v243, 0
    v_mov_b32 v244, 0
    v_mov_b32 v245, 0
    v_mov_b32 v246, 0
    v_mov_b32 v247, 0
    v_mov_b32 v248, 0
    v_mov_b32 v249, 0
    v_mov_b32 v250, 0
    v_mov_b32 v251, 0
    v_mov_b32 v252, 0
    v_mov_b32 v253, 0
    v_mov_b32 v254, 0
    v_mov_b32 v255, 0
    s_waitcnt vmcnt(22)
    s_barrier
    ds_read_b64_tr_b16 v[32:33], v28 offset:0
    ds_read_b64_tr_b16 v[34:35], v28 offset:1024
    ds_read_b64_tr_b16 v[36:37], v29 offset:0
    ds_read_b64_tr_b16 v[38:39], v29 offset:1024
    ds_read_b64_tr_b16 v[40:41], v30 offset:0
    ds_read_b64_tr_b16 v[42:43], v30 offset:1024
    s_waitcnt vmcnt(20)
    s_barrier
    s_add_u32 m0, s51, 65536
    s_mov_b32 s52, 2097152
    buffer_load_dwordx4 v24, s[16:19], s52 offen lds
    s_add_u32 m0, m0, 1024
    s_nop 0
    buffer_load_dwordx4 v25, s[16:19], s52 offen lds
    s_add_u32 s50, s50, 4096
    buffer_load_dwordx4 v[112:115], v27, s[20:23], s50 offen offset:0
    buffer_load_dwordx4 v[116:119], v27, s[20:23], s50 offen offset:1024
    buffer_load_dwordx4 v[120:123], v27, s[20:23], s50 offen offset:2048
    buffer_load_dwordx4 v[124:127], v27, s[20:23], s50 offen offset:3072
    s_waitcnt vmcnt(21)
    ds_read_b64_tr_b16 v[44:45], v31 offset:0
    ds_read_b64_tr_b16 v[46:47], v31 offset:1024
    s_waitcnt lgkmcnt(6)
    v_mfma_f32_32x32x16_bf16 v[144:159], v[32:35], v[48:51], v[144:159]
    ds_read_b64_tr_b16 v[32:33], v28 offset:4096
    ds_read_b64_tr_b16 v[34:35], v28 offset:5120
    s_waitcnt lgkmcnt(6)
    v_mfma_f32_32x32x16_bf16 v[176:191], v[36:39], v[48:51], v[176:191]
    ds_read_b64_tr_b16 v[36:37], v29 offset:4096
    ds_read_b64_tr_b16 v[38:39], v29 offset:5120
    s_waitcnt lgkmcnt(6)
    v_mfma_f32_32x32x16_bf16 v[208:223], v[40:43], v[48:51], v[208:223]
    ds_read_b64_tr_b16 v[40:41], v30 offset:4096
    ds_read_b64_tr_b16 v[42:43], v30 offset:5120
    s_waitcnt lgkmcnt(6)
    v_mfma_f32_32x32x16_bf16 v[240:255], v[44:47], v[48:51], v[240:255]
    s_waitcnt vmcnt(20)
    ds_read_b64_tr_b16 v[44:45], v31 offset:4096
    ds_read_b64_tr_b16 v[46:47], v31 offset:5120
    s_waitcnt lgkmcnt(6)
    v_mfma_f32_32x32x16_bf16 v[144:159], v[32:35], v[52:55], v[144:159]
    ds_read_b64_tr_b16 v[32:33], v28 offset:8192
    ds_read_b64_tr_b16 v[34:35], v28 offset:9216
    s_waitcnt lgkmcnt(6)
    v_mfma_f32_32x32x16_bf16 v[176:191], v[36:39], v[52:55], v[176:191]
    ds_read_b64_tr_b16 v[36:37], v29 offset:8192
    ds_read_b64_tr_b16 v[38:39], v29 offset:9216
    s_waitcnt lgkmcnt(6)
    v_mfma_f32_32x32x16_bf16 v[208:223], v[40:43], v[52:55], v[208:223]
    ds_read_b64_tr_b16 v[40:41], v30 offset:8192
    ds_read_b64_tr_b16 v[42:43], v30 offset:9216
    s_waitcnt lgkmcnt(6)
    v_mfma_f32_32x32x16_bf16 v[240:255], v[44:47], v[52:55], v[240:255]
    s_cmp_eq_u32 s67, 1
    s_cbranch_scc1 L_k12_sv0
    s_add_u32 s68, s66, 0
    buffer_store_dwordx4 v[128:131], v12, s[28:31], s68 offen sc1
    s_branch L_k12_sd0
L_k12_sv0:
    s_add_u32 s68, s66, 0
    buffer_store_dwordx4 v[128:131], v12, s[28:31], s68 offen sc1
L_k12_sd0:
    s_waitcnt vmcnt(20)
    ds_read_b64_tr_b16 v[44:45], v31 offset:8192
    ds_read_b64_tr_b16 v[46:47], v31 offset:9216
    s_waitcnt lgkmcnt(6)
    v_mfma_f32_32x32x16_bf16 v[144:159], v[32:35], v[56:59], v[144:159]
    ds_read_b64_tr_b16 v[32:33], v28 offset:12288
    ds_read_b64_tr_b16 v[34:35], v28 offset:13312
    v_add_u32 v28, 16384, v28
    s_waitcnt lgkmcnt(6)
    v_mfma_f32_32x32x16_bf16 v[176:191], v[36:39], v[56:59], v[176:191]
    ds_read_b64_tr_b16 v[36:37], v29 offset:12288
    ds_read_b64_tr_b16 v[38:39], v29 offset:13312
    v_add_u32 v29, 16384, v29
    s_waitcnt lgkmcnt(6)
    v_mfma_f32_32x32x16_bf16 v[208:223], v[40:43], v[56:59], v[208:223]
    ds_read_b64_tr_b16 v[40:41], v30 offset:12288
    ds_read_b64_tr_b16 v[42:43], v30 offset:13312
    v_add_u32 v30, 16384, v30
    s_waitcnt lgkmcnt(6)
    v_mfma_f32_32x32x16_bf16 v[240:255], v[44:47], v[56:59], v[240:255]
    s_waitcnt vmcnt(19)
    ds_read_b64_tr_b16 v[44:45], v31 offset:12288
    ds_read_b64_tr_b16 v[46:47], v31 offset:13312
    v_add_u32 v31, 16384, v31
    s_waitcnt lgkmcnt(6)
    v_mfma_f32_32x32x16_bf16 v[144:159], v[32:35], v[60:63], v[144:159]
    ds_read_b64_tr_b16 v[32:33], v28 offset:0
    ds_read_b64_tr_b16 v[34:35], v28 offset:1024
    s_waitcnt lgkmcnt(6)
    v_mfma_f32_32x32x16_bf16 v[176:191], v[36:39], v[60:63], v[176:191]
    ds_read_b64_tr_b16 v[36:37], v29 offset:0
    ds_read_b64_tr_b16 v[38:39], v29 offset:1024
    s_waitcnt lgkmcnt(6)
    v_mfma_f32_32x32x16_bf16 v[208:223], v[40:43], v[60:63], v[208:223]
    ds_read_b64_tr_b16 v[40:41], v30 offset:0
    ds_read_b64_tr_b16 v[42:43], v30 offset:1024
    s_waitcnt lgkmcnt(6)
    v_mfma_f32_32x32x16_bf16 v[240:255], v[44:47], v[60:63], v[240:255]
    s_cmp_eq_u32 s67, 1
    s_cbranch_scc1 L_k12_sv1
    s_add_u32 s68, s66, 512
    buffer_store_dwordx4 v[132:135], v13, s[28:31], s68 offen sc1
    s_branch L_k12_sd1
L_k12_sv1:
    s_add_u32 s68, s66, 8192
    buffer_store_dwordx4 v[132:135], v12, s[28:31], s68 offen sc1
L_k12_sd1:
    s_barrier
    s_add_u32 m0, s51, 81920
    s_mov_b32 s52, 2621440
    buffer_load_dwordx4 v24, s[16:19], s52 offen lds
    s_add_u32 m0, m0, 1024
    s_nop 0
    buffer_load_dwordx4 v25, s[16:19], s52 offen lds
    s_add_u32 s50, s50, 4096
    buffer_load_dwordx4 v[48:51], v27, s[20:23], s50 offen offset:0
    buffer_load_dwordx4 v[52:55], v27, s[20:23], s50 offen offset:1024
    buffer_load_dwordx4 v[56:59], v27, s[20:23], s50 offen offset:2048
    buffer_load_dwordx4 v[60:63], v27, s[20:23], s50 offen offset:3072
    s_waitcnt vmcnt(25)
    ds_read_b64_tr_b16 v[44:45], v31 offset:0
    ds_read_b64_tr_b16 v[46:47], v31 offset:1024
    s_waitcnt lgkmcnt(6)
    v_mfma_f32_32x32x16_bf16 v[144:159], v[32:35], v[64:67], v[144:159]
    ds_read_b64_tr_b16 v[32:33], v28 offset:4096
    ds_read_b64_tr_b16 v[34:35], v28 offset:5120
    s_waitcnt lgkmcnt(6)
    v_mfma_f32_32x32x16_bf16 v[176:191], v[36:39], v[64:67], v[176:191]
    ds_read_b64_tr_b16 v[36:37], v29 offset:4096
    ds_read_b64_tr_b16 v[38:39], v29 offset:5120
    s_waitcnt lgkmcnt(6)
    v_mfma_f32_32x32x16_bf16 v[208:223], v[40:43], v[64:67], v[208:223]
    ds_read_b64_tr_b16 v[40:41], v30 offset:4096
    ds_read_b64_tr_b16 v[42:43], v30 offset:5120
    s_waitcnt lgkmcnt(6)
    v_mfma_f32_32x32x16_bf16 v[240:255], v[44:47], v[64:67], v[240:255]
    s_waitcnt vmcnt(24)
    ds_read_b64_tr_b16 v[44:45], v31 offset:4096
    ds_read_b64_tr_b16 v[46:47], v31 offset:5120
    s_waitcnt lgkmcnt(6)
    v_mfma_f32_32x32x16_bf16 v[144:159], v[32:35], v[68:71], v[144:159]
    ds_read_b64_tr_b16 v[32:33], v28 offset:8192
    ds_read_b64_tr_b16 v[34:35], v28 offset:9216
    s_waitcnt lgkmcnt(6)
    v_mfma_f32_32x32x16_bf16 v[176:191], v[36:39], v[68:71], v[176:191]
    ds_read_b64_tr_b16 v[36:37], v29 offset:8192
    ds_read_b64_tr_b16 v[38:39], v29 offset:9216
    s_waitcnt lgkmcnt(6)
    v_mfma_f32_32x32x16_bf16 v[208:223], v[40:43], v[68:71], v[208:223]
    ds_read_b64_tr_b16 v[40:41], v30 offset:8192
    ds_read_b64_tr_b16 v[42:43], v30 offset:9216
    s_waitcnt lgkmcnt(6)
    v_mfma_f32_32x32x16_bf16 v[240:255], v[44:47], v[68:71], v[240:255]
    s_cmp_eq_u32 s67, 1
    s_cbranch_scc1 L_k12_sv2
    s_add_u32 s68, s66, 8192
    buffer_store_dwordx4 v[136:139], v12, s[28:31], s68 offen sc1
    s_branch L_k12_sd2
L_k12_sv2:
    s_add_u32 s68, s66, 512
    buffer_store_dwordx4 v[136:139], v13, s[28:31], s68 offen sc1
L_k12_sd2:
    s_waitcnt vmcnt(24)
    ds_read_b64_tr_b16 v[44:45], v31 offset:8192
    ds_read_b64_tr_b16 v[46:47], v31 offset:9216
    s_waitcnt lgkmcnt(6)
    v_mfma_f32_32x32x16_bf16 v[144:159], v[32:35], v[72:75], v[144:159]
    ds_read_b64_tr_b16 v[32:33], v28 offset:12288
    ds_read_b64_tr_b16 v[34:35], v28 offset:13312
    v_add_u32 v28, 16384, v28
    s_waitcnt lgkmcnt(6)
    v_mfma_f32_32x32x16_bf16 v[176:191], v[36:39], v[72:75], v[176:191]
    ds_read_b64_tr_b16 v[36:37], v29 offset:12288
    ds_read_b64_tr_b16 v[38:39], v29 offset:13312
    v_add_u32 v29, 16384, v29
    s_waitcnt lgkmcnt(6)
    v_mfma_f32_32x32x16_bf16 v[208:223], v[40:43], v[72:75], v[208:223]
    ds_read_b64_tr_b16 v[40:41], v30 offset:12288
    ds_read_b64_tr_b16 v[42:43], v30 offset:13312
    v_add_u32 v30, 16384, v30
    s_waitcnt lgkmcnt(6)
    v_mfma_f32_32x32x16_bf16 v[240:255], v[44:47], v[72:75], v[240:255]
    s_waitcnt vmcnt(23)
    ds_read_b64_tr_b16 v[44:45], v31 offset:12288
    ds_read_b64_tr_b16 v[46:47], v31 offset:13312
    v_add_u32 v31, 16384, v31
    s_waitcnt lgkmcnt(6)
    v_mfma_f32_32x32x16_bf16 v[144:159], v[32:35], v[76:79], v[144:159]
    ds_read_b64_tr_b16 v[32:33], v28 offset:0
    ds_read_b64_tr_b16 v[34:35], v28 offset:1024
    s_waitcnt lgkmcnt(6)
    v_mfma_f32_32x32x16_bf16 v[176:191], v[36:39], v[76:79], v[176:191]
    ds_read_b64_tr_b16 v[36:37], v29 offset:0
    ds_read_b64_tr_b16 v[38:39], v29 offset:1024
    s_waitcnt lgkmcnt(6)
    v_mfma_f32_32x32x16_bf16 v[208:223], v[40:43], v[76:79], v[208:223]
    ds_read_b64_tr_b16 v[40:41], v30 offset:0
    ds_read_b64_tr_b16 v[42:43], v30 offset:1024
    s_waitcnt lgkmcnt(6)
    v_mfma_f32_32x32x16_bf16 v[240:255], v[44:47], v[76:79], v[240:255]
    s_cmp_eq_u32 s67, 1
    s_cbranch_scc1 L_k12_sv3
    s_add_u32 s68, s66, 8704
    buffer_store_dwordx4 v[140:143], v13, s[28:31], s68 offen sc1
    s_branch L_k12_sd3
L_k12_sv3:
    s_add_u32 s68, s66, 8704
    buffer_store_dwordx4 v[140:143], v13, s[28:31], s68 offen sc1
L_k12_sd3:
    s_barrier
    s_add_u32 m0, s51, 0
    s_mov_b32 s52, 3145728
    buffer_load_dwordx4 v24, s[16:19], s52 offen lds
    s_add_u32 m0, m0, 1024
    s_nop 0
    buffer_load_dwordx4 v25, s[16:19], s52 offen lds
    s_add_u32 s50, s50, 4096
    buffer_load_dwordx4 v[64:67], v27, s[20:23], s50 offen offset:0
    buffer_load_dwordx4 v[68:71], v27, s[20:23], s50 offen offset:1024
    buffer_load_dwordx4 v[72:75], v27, s[20:23], s50 offen offset:2048
    buffer_load_dwordx4 v[76:79], v27, s[20:23], s50 offen offset:3072
    s_waitcnt vmcnt(29)
    ds_read_b64_tr_b16 v[44:45], v31 offset:0
    ds_read_b64_tr_b16 v[46:47], v31 offset:1024
    s_waitcnt lgkmcnt(6)
    v_mfma_f32_32x32x16_bf16 v[144:159], v[32:35], v[80:83], v[144:159]
    ds_read_b64_tr_b16 v[32:33], v28 offset:4096
    ds_read_b64_tr_b16 v[34:35], v28 offset:5120
    s_waitcnt lgkmcnt(6)
    v_mfma_f32_32x32x16_bf16 v[176:191], v[36:39], v[80:83], v[176:191]
    ds_read_b64_tr_b16 v[36:37], v29 offset:4096
    ds_read_b64_tr_b16 v[38:39], v29 offset:5120
    s_waitcnt lgkmcnt(6)
    v_mfma_f32_32x32x16_bf16 v[208:223], v[40:43], v[80:83], v[208:223]
    ds_read_b64_tr_b16 v[40:41], v30 offset:4096
    ds_read_b64_tr_b16 v[42:43], v30 offset:5120
    s_waitcnt lgkmcnt(6)
    v_mfma_f32_32x32x16_bf16 v[240:255], v[44:47], v[80:83], v[240:255]
    s_waitcnt vmcnt(28)
    ds_read_b64_tr_b16 v[44:45], v31 offset:4096
    ds_read_b64_tr_b16 v[46:47], v31 offset:5120
    s_waitcnt lgkmcnt(6)
    v_mfma_f32_32x32x16_bf16 v[144:159], v[32:35], v[84:87], v[144:159]
    ds_read_b64_tr_b16 v[32:33], v28 offset:8192
    ds_read_b64_tr_b16 v[34:35], v28 offset:9216
    s_waitcnt lgkmcnt(6)
    v_mfma_f32_32x32x16_bf16 v[176:191], v[36:39], v[84:87], v[176:191]
    ds_read_b64_tr_b16 v[36:37], v29 offset:8192
    ds_read_b64_tr_b16 v[38:39], v29 offset:9216
    s_waitcnt lgkmcnt(6)
    v_mfma_f32_32x32x16_bf16 v[208:223], v[40:43], v[84:87], v[208:223]
    ds_read_b64_tr_b16 v[40:41], v30 offset:8192
    ds_read_b64_tr_b16 v[42:43], v30 offset:9216
    s_waitcnt lgkmcnt(6)
    v_mfma_f32_32x32x16_bf16 v[240:255], v[44:47], v[84:87], v[240:255]
    s_cmp_eq_u32 s67, 1
    s_cbranch_scc1 L_k12_sv4
    s_add_u32 s68, s66, 2048
    buffer_store_dwordx4 v[160:163], v12, s[28:31], s68 offen sc1
    s_branch L_k12_sd4
L_k12_sv4:
    s_add_u32 s68, s66, 2048
    buffer_store_dwordx4 v[160:163], v12, s[28:31], s68 offen sc1
L_k12_sd4:
    s_waitcnt vmcnt(28)
    ds_read_b64_tr_b16 v[44:45], v31 offset:8192
    ds_read_b64_tr_b16 v[46:47], v31 offset:9216
    s_waitcnt lgkmcnt(6)
    v_mfma_f32_32x32x16_bf16 v[144:159], v[32:35], v[88:91], v[144:159]
    ds_read_b64_tr_b16 v[32:33], v28 offset:12288
    ds_read_b64_tr_b16 v[34:35], v28 offset:13312
    v_add_u32 v28, 16384, v28
    s_waitcnt lgkmcnt(6)
    v_mfma_f32_32x32x16_bf16 v[176:191], v[36:39], v[88:91], v[176:191]
    ds_read_b64_tr_b16 v[36:37], v29 offset:12288
    ds_read_b64_tr_b16 v[38:39], v29 offset:13312
    v_add_u32 v29, 16384, v29
    s_waitcnt lgkmcnt(6)
    v_mfma_f32_32x32x16_bf16 v[208:223], v[40:43], v[88:91], v[208:223]
    ds_read_b64_tr_b16 v[40:41], v30 offset:12288
    ds_read_b64_tr_b16 v[42:43], v30 offset:13312
    v_add_u32 v30, 16384, v30
    s_waitcnt lgkmcnt(6)
    v_mfma_f32_32x32x16_bf16 v[240:255], v[44:47], v[88:91], v[240:255]
    s_waitcnt vmcnt(27)
    ds_read_b64_tr_b16 v[44:45], v31 offset:12288
    ds_read_b64_tr_b16 v[46:47], v31 offset:13312
    v_add_u32 v31, 16384, v31
    s_waitcnt lgkmcnt(6)
    v_mfma_f32_32x32x16_bf16 v[144:159], v[32:35], v[92:95], v[144:159]
    ds_read_b64_tr_b16 v[32:33], v28 offset:0
    ds_read_b64_tr_b16 v[34:35], v28 offset:1024
    s_waitcnt lgkmcnt(6)
    v_mfma_f32_32x32x16_bf16 v[176:191], v[36:39], v[92:95], v[176:191]
    ds_read_b64_tr_b16 v[36:37], v29 offset:0
    ds_read_b64_tr_b16 v[38:39], v29 offset:1024
    s_waitcnt lgkmcnt(6)
    v_mfma_f32_32x32x16_bf16 v[208:223], v[40:43], v[92:95], v[208:223]
    ds_read_b64_tr_b16 v[40:41], v30 offset:0
    ds_read_b64_tr_b16 v[42:43], v30 offset:1024
    s_waitcnt lgkmcnt(6)
    v_mfma_f32_32x32x16_bf16 v[240:255], v[44:47], v[92:95], v[240:255]
    s_cmp_eq_u32 s67, 1
    s_cbranch_scc1 L_k12_sv5
    s_add_u32 s68, s66, 2560
    buffer_store_dwordx4 v[164:167], v13, s[28:31], s68 offen sc1
    s_branch L_k12_sd5
L_k12_sv5:
    s_add_u32 s68, s66, 10240
    buffer_store_dwordx4 v[164:167], v12, s[28:31], s68 offen sc1
L_k12_sd5:
    s_waitcnt vmcnt(22)
    s_barrier
    s_add_u32 m0, s51, 16384
    s_mov_b32 s52, 3670016
    buffer_load_dwordx4 v24, s[16:19], s52 offen lds
    s_add_u32 m0, m0, 1024
    s_nop 0
    buffer_load_dwordx4 v25, s[16:19], s52 offen lds
    s_add_u32 s50, s50, 4096
    buffer_load_dwordx4 v[80:83], v27, s[20:23], s50 offen offset:0
    buffer_load_dwordx4 v[84:87], v27, s[20:23], s50 offen offset:1024
    buffer_load_dwordx4 v[88:91], v27, s[20:23], s50 offen offset:2048
    buffer_load_dwordx4 v[92:95], v27, s[20:23], s50 offen offset:3072
    ds_read_b64_tr_b16 v[44:45], v31 offset:0
    ds_read_b64_tr_b16 v[46:47], v31 offset:1024
    s_waitcnt lgkmcnt(6)
    v_mfma_f32_32x32x16_bf16 v[144:159], v[32:35], v[96:99], v[144:159]
    ds_read_b64_tr_b16 v[32:33], v28 offset:4096
    ds_read_b64_tr_b16 v[34:35], v28 offset:5120
    s_waitcnt lgkmcnt(6)
    v_mfma_f32_32x32x16_bf16 v[176:191], v[36:39], v[96:99], v[176:191]
    ds_read_b64_tr_b16 v[36:37], v29 offset:4096
    ds_read_b64_tr_b16 v[38:39], v29 offset:5120
    s_waitcnt lgkmcnt(6)
    v_mfma_f32_32x32x16_bf16 v[208:223], v[40:43], v[96:99], v[208:223]
    ds_read_b64_tr_b16 v[40:41], v30 offset:4096
    ds_read_b64_tr_b16 v[42:43], v30 offset:5120
    s_waitcnt lgkmcnt(6)
    v_mfma_f32_32x32x16_bf16 v[240:255], v[44:47], v[96:99], v[240:255]
    ds_read_b64_tr_b16 v[44:45], v31 offset:4096
    ds_read_b64_tr_b16 v[46:47], v31 offset:5120
    s_waitcnt lgkmcnt(6)
    v_mfma_f32_32x32x16_bf16 v[144:159], v[32:35], v[100:103], v[144:159]
    ds_read_b64_tr_b16 v[32:33], v28 offset:8192
    ds_read_b64_tr_b16 v[34:35], v28 offset:9216
    s_waitcnt lgkmcnt(6)
    v_mfma_f32_32x32x16_bf16 v[176:191], v[36:39], v[100:103], v[176:191]
    ds_read_b64_tr_b16 v[36:37], v29 offset:8192
    ds_read_b64_tr_b16 v[38:39], v29 offset:9216
    s_waitcnt lgkmcnt(6)
    v_mfma_f32_32x32x16_bf16 v[208:223], v[40:43], v[100:103], v[208:223]
    ds_read_b64_tr_b16 v[40:41], v30 offset:8192
    ds_read_b64_tr_b16 v[42:43], v30 offset:9216
    s_waitcnt lgkmcnt(6)
    v_mfma_f32_32x32x16_bf16 v[240:255], v[44:47], v[100:103], v[240:255]
    s_cmp_eq_u32 s67, 1
    s_cbranch_scc1 L_k12_sv6
    s_add_u32 s68, s66, 10240
    buffer_store_dwordx4 v[168:171], v12, s[28:31], s68 offen sc1
    s_branch L_k12_sd6
L_k12_sv6:
    s_add_u32 s68, s66, 2560
    buffer_store_dwordx4 v[168:171], v13, s[28:31], s68 offen sc1
L_k12_sd6:
    ds_read_b64_tr_b16 v[44:45], v31 offset:8192
    ds_read_b64_tr_b16 v[46:47], v31 offset:9216
    s_waitcnt lgkmcnt(6)
    v_mfma_f32_32x32x16_bf16 v[144:159], v[32:35], v[104:107], v[144:159]
    ds_read_b64_tr_b16 v[32:33], v28 offset:12288
    ds_read_b64_tr_b16 v[34:35], v28 offset:13312
    v_add_u32 v28, 16384, v28
    s_waitcnt lgkmcnt(6)
    v_mfma_f32_32x32x16_bf16 v[176:191], v[36:39], v[104:107], v[176:191]
    ds_read_b64_tr_b16 v[36:37], v29 offset:12288
    ds_read_b64_tr_b16 v[38:39], v29 offset:13312
    v_add_u32 v29, 16384, v29
    s_waitcnt lgkmcnt(6)
    v_mfma_f32_32x32x16_bf16 v[208:223], v[40:43], v[104:107], v[208:223]
    ds_read_b64_tr_b16 v[40:41], v30 offset:12288
    ds_read_b64_tr_b16 v[42:43], v30 offset:13312
    v_add_u32 v30, 16384, v30
    s_waitcnt lgkmcnt(6)
    v_mfma_f32_32x32x16_bf16 v[240:255], v[44:47], v[104:107], v[240:255]
    ds_read_b64_tr_b16 v[44:45], v31 offset:12288
    ds_read_b64_tr_b16 v[46:47], v31 offset:13312
    v_add_u32 v31, 16384, v31
    s_waitcnt lgkmcnt(6)
    v_mfma_f32_32x32x16_bf16 v[144:159], v[32:35], v[108:111], v[144:159]
    ds_read_b64_tr_b16 v[32:33], v28 offset:0
    ds_read_b64_tr_b16 v[34:35], v28 offset:1024
    s_waitcnt lgkmcnt(6)
    v_mfma_f32_32x32x16_bf16 v[176:191], v[36:39], v[108:111], v[176:191]
    ds_read_b64_tr_b16 v[36:37], v29 offset:0
    ds_read_b64_tr_b16 v[38:39], v29 offset:1024
    s_waitcnt lgkmcnt(6)
    v_mfma_f32_32x32x16_bf16 v[208:223], v[40:43], v[108:111], v[208:223]
    ds_read_b64_tr_b16 v[40:41], v30 offset:0
    ds_read_b64_tr_b16 v[42:43], v30 offset:1024
    s_waitcnt lgkmcnt(6)
    v_mfma_f32_32x32x16_bf16 v[240:255], v[44:47], v[108:111], v[240:255]
    s_cmp_eq_u32 s67, 1
    s_cbranch_scc1 L_k12_sv7
    s_add_u32 s68, s66, 10752
    buffer_store_dwordx4 v[172:175], v13, s[28:31], s68 offen sc1
    s_branch L_k12_sd7
L_k12_sv7:
    s_add_u32 s68, s66, 10752
    buffer_store_dwordx4 v[172:175], v13, s[28:31], s68 offen sc1
L_k12_sd7:
    s_waitcnt vmcnt(22)
    s_barrier
    s_add_u32 m0, s51, 32768
    s_mov_b32 s52, 4194304
    buffer_load_dwordx4 v24, s[16:19], s52 offen lds
    s_add_u32 m0, m0, 1024
    s_nop 0
    buffer_load_dwordx4 v25, s[16:19], s52 offen lds
    s_add_u32 s50, s50, 4096
    buffer_load_dwordx4 v[96:99], v27, s[20:23], s50 offen offset:0
    buffer_load_dwordx4 v[100:103], v27, s[20:23], s50 offen offset:1024
    buffer_load_dwordx4 v[104:107], v27, s[20:23], s50 offen offset:2048
    buffer_load_dwordx4 v[108:111], v27, s[20:23], s50 offen offset:3072
    ds_read_b64_tr_b16 v[44:45], v31 offset:0
    ds_read_b64_tr_b16 v[46:47], v31 offset:1024
    s_waitcnt lgkmcnt(6)
    v_mfma_f32_32x32x16_bf16 v[144:159], v[32:35], v[112:115], v[144:159]
    ds_read_b64_tr_b16 v[32:33], v28 offset:4096
    ds_read_b64_tr_b16 v[34:35], v28 offset:5120
    s_waitcnt lgkmcnt(6)
    v_mfma_f32_32x32x16_bf16 v[176:191], v[36:39], v[112:115], v[176:191]
    ds_read_b64_tr_b16 v[36:37], v29 offset:4096
    ds_read_b64_tr_b16 v[38:39], v29 offset:5120
    s_waitcnt lgkmcnt(6)
    v_mfma_f32_32x32x16_bf16 v[208:223], v[40:43], v[112:115], v[208:223]
    ds_read_b64_tr_b16 v[40:41], v30 offset:4096
    ds_read_b64_tr_b16 v[42:43], v30 offset:5120
    s_waitcnt lgkmcnt(6)
    v_mfma_f32_32x32x16_bf16 v[240:255], v[44:47], v[112:115], v[240:255]
    ds_read_b64_tr_b16 v[44:45], v31 offset:4096
    ds_read_b64_tr_b16 v[46:47], v31 offset:5120
    s_waitcnt lgkmcnt(6)
    v_mfma_f32_32x32x16_bf16 v[144:159], v[32:35], v[116:119], v[144:159]
    ds_read_b64_tr_b16 v[32:33], v28 offset:8192
    ds_read_b64_tr_b16 v[34:35], v28 offset:9216
    s_waitcnt lgkmcnt(6)
    v_mfma_f32_32x32x16_bf16 v[176:191], v[36:39], v[116:119], v[176:191]
    ds_read_b64_tr_b16 v[36:37], v29 offset:8192
    ds_read_b64_tr_b16 v[38:39], v29 offset:9216
    s_waitcnt lgkmcnt(6)
    v_mfma_f32_32x32x16_bf16 v[208:223], v[40:43], v[116:119], v[208:223]
    ds_read_b64_tr_b16 v[40:41], v30 offset:8192
    ds_read_b64_tr_b16 v[42:43], v30 offset:9216
    s_waitcnt lgkmcnt(6)
    v_mfma_f32_32x32x16_bf16 v[240:255], v[44:47], v[116:119], v[240:255]
    s_cmp_eq_u32 s67, 1
    s_cbranch_scc1 L_k12_sv8
    s_add_u32 s68, s66, 4096
    buffer_store_dwordx4 v[192:195], v12, s[28:31], s68 offen sc1
    s_branch L_k12_sd8
L_k12_sv8:
    s_add_u32 s68, s66, 4096
    buffer_store_dwordx4 v[192:195], v12, s[28:31], s68 offen sc1
L_k12_sd8:
    ds_read_b64_tr_b16 v[44:45], v31 offset:8192
    ds_read_b64_tr_b16 v[46:47], v31 offset:9216
    s_waitcnt lgkmcnt(6)
    v_mfma_f32_32x32x16_bf16 v[144:159], v[32:35], v[120:123], v[144:159]
    ds_read_b64_tr_b16 v[32:33], v28 offset:12288
    ds_read_b64_tr_b16 v[34:35], v28 offset:13312
    v_add_u32 v28, 16384, v28
    s_waitcnt lgkmcnt(6)
    v_mfma_f32_32x32x16_bf16 v[176:191], v[36:39], v[120:123], v[176:191]
    ds_read_b64_tr_b16 v[36:37], v29 offset:12288
    ds_read_b64_tr_b16 v[38:39], v29 offset:13312
    v_add_u32 v29, 16384, v29
    s_waitcnt lgkmcnt(6)
    v_mfma_f32_32x32x16_bf16 v[208:223], v[40:43], v[120:123], v[208:223]
    ds_read_b64_tr_b16 v[40:41], v30 offset:12288
    ds_read_b64_tr_b16 v[42:43], v30 offset:13312
    v_add_u32 v30, 16384, v30
    s_waitcnt lgkmcnt(6)
    v_mfma_f32_32x32x16_bf16 v[240:255], v[44:47], v[120:123], v[240:255]
    ds_read_b64_tr_b16 v[44:45], v31 offset:12288
    ds_read_b64_tr_b16 v[46:47], v31 offset:13312
    v_add_u32 v31, 16384, v31
    s_waitcnt lgkmcnt(6)
    v_mfma_f32_32x32x16_bf16 v[144:159], v[32:35], v[124:127], v[144:159]
    ds_read_b64_tr_b16 v[32:33], v28 offset:0
    ds_read_b64_tr_b16 v[34:35], v28 offset:1024
    s_waitcnt lgkmcnt(6)
    v_mfma_f32_32x32x16_bf16 v[176:191], v[36:39], v[124:127], v[176:191]
    ds_read_b64_tr_b16 v[36:37], v29 offset:0
    ds_read_b64_tr_b16 v[38:39], v29 offset:1024
    s_waitcnt lgkmcnt(6)
    v_mfma_f32_32x32x16_bf16 v[208:223], v[40:43], v[124:127], v[208:223]
    ds_read_b64_tr_b16 v[40:41], v30 offset:0
    ds_read_b64_tr_b16 v[42:43], v30 offset:1024
    s_waitcnt lgkmcnt(6)
    v_mfma_f32_32x32x16_bf16 v[240:255], v[44:47], v[124:127], v[240:255]
    s_cmp_eq_u32 s67, 1
    s_cbranch_scc1 L_k12_sv9
    s_add_u32 s68, s66, 4608
    buffer_store_dwordx4 v[196:199], v13, s[28:31], s68 offen sc1
    s_branch L_k12_sd9
L_k12_sv9:
    s_add_u32 s68, s66, 12288
    buffer_store_dwordx4 v[196:199], v12, s[28:31], s68 offen sc1
L_k12_sd9:
    s_waitcnt vmcnt(22)
    s_barrier
    ds_read_b64_tr_b16 v[44:45], v31 offset:0
    ds_read_b64_tr_b16 v[46:47], v31 offset:1024
    s_waitcnt lgkmcnt(6)
    v_mfma_f32_32x32x16_bf16 v[144:159], v[32:35], v[48:51], v[144:159]
    ds_read_b64_tr_b16 v[32:33], v28 offset:4096
    ds_read_b64_tr_b16 v[34:35], v28 offset:5120
    s_waitcnt lgkmcnt(6)
    v_mfma_f32_32x32x16_bf16 v[176:191], v[36:39], v[48:51], v[176:191]
    ds_read_b64_tr_b16 v[36:37], v29 offset:4096
    ds_read_b64_tr_b16 v[38:39], v29 offset:5120
    s_waitcnt lgkmcnt(6)
    v_mfma_f32_32x32x16_bf16 v[208:223], v[40:43], v[48:51], v[208:223]
    ds_read_b64_tr_b16 v[40:41], v30 offset:4096
    ds_read_b64_tr_b16 v[42:43], v30 offset:5120
    s_waitcnt lgkmcnt(6)
    v_mfma_f32_32x32x16_bf16 v[240:255], v[44:47], v[48:51], v[240:255]
    ds_read_b64_tr_b16 v[44:45], v31 offset:4096
    ds_read_b64_tr_b16 v[46:47], v31 offset:5120
    s_waitcnt lgkmcnt(6)
    v_mfma_f32_32x32x16_bf16 v[144:159], v[32:35], v[52:55], v[144:159]
    ds_read_b64_tr_b16 v[32:33], v28 offset:8192
    ds_read_b64_tr_b16 v[34:35], v28 offset:9216
    s_waitcnt lgkmcnt(6)
    v_mfma_f32_32x32x16_bf16 v[176:191], v[36:39], v[52:55], v[176:191]
    ds_read_b64_tr_b16 v[36:37], v29 offset:8192
    ds_read_b64_tr_b16 v[38:39], v29 offset:9216
    s_waitcnt lgkmcnt(6)
    v_mfma_f32_32x32x16_bf16 v[208:223], v[40:43], v[52:55], v[208:223]
    ds_read_b64_tr_b16 v[40:41], v30 offset:8192
    ds_read_b64_tr_b16 v[42:43], v30 offset:9216
    s_waitcnt lgkmcnt(6)
    v_mfma_f32_32x32x16_bf16 v[240:255], v[44:47], v[52:55], v[240:255]
    s_cmp_eq_u32 s67, 1
    s_cbranch_scc1 L_k12_sv10
    s_add_u32 s68, s66, 12288
    buffer_store_dwordx4 v[200:203], v12, s[28:31], s68 offen sc1
    s_branch L_k12_sd10
L_k12_sv10:
    s_add_u32 s68, s66, 4608
    buffer_store_dwordx4 v[200:203], v13, s[28:31], s68 offen sc1
L_k12_sd10:
    ds_read_b64_tr_b16 v[44:45], v31 offset:8192
    ds_read_b64_tr_b16 v[46:47], v31 offset:9216
    s_waitcnt lgkmcnt(6)
    v_mfma_f32_32x32x16_bf16 v[144:159], v[32:35], v[56:59], v[144:159]
    ds_read_b64_tr_b16 v[32:33], v28 offset:12288
    ds_read_b64_tr_b16 v[34:35], v28 offset:13312
    v_add_u32 v28, 4294885376, v28
    s_waitcnt lgkmcnt(6)
    v_mfma_f32_32x32x16_bf16 v[176:191], v[36:39], v[56:59], v[176:191]
    ds_read_b64_tr_b16 v[36:37], v29 offset:12288
    ds_read_b64_tr_b16 v[38:39], v29 offset:13312
    v_add_u32 v29, 4294885376, v29
    s_waitcnt lgkmcnt(6)
    v_mfma_f32_32x32x16_bf16 v[208:223], v[40:43], v[56:59], v[208:223]
    ds_read_b64_tr_b16 v[40:41], v30 offset:12288
    ds_read_b64_tr_b16 v[42:43], v30 offset:13312
    v_add_u32 v30, 4294885376, v30
    s_waitcnt lgkmcnt(6)
    v_mfma_f32_32x32x16_bf16 v[240:255], v[44:47], v[56:59], v[240:255]
    ds_read_b64_tr_b16 v[44:45], v31 offset:12288
    ds_read_b64_tr_b16 v[46:47], v31 offset:13312
    v_add_u32 v31, 4294885376, v31
    s_waitcnt lgkmcnt(6)
    v_mfma_f32_32x32x16_bf16 v[144:159], v[32:35], v[60:63], v[144:159]
    ds_read_b64_tr_b16 v[32:33], v28 offset:0
    ds_read_b64_tr_b16 v[34:35], v28 offset:1024
    s_waitcnt lgkmcnt(6)
    v_mfma_f32_32x32x16_bf16 v[176:191], v[36:39], v[60:63], v[176:191]
    ds_read_b64_tr_b16 v[36:37], v29 offset:0
    ds_read_b64_tr_b16 v[38:39], v29 offset:1024
    s_waitcnt lgkmcnt(6)
    v_mfma_f32_32x32x16_bf16 v[208:223], v[40:43], v[60:63], v[208:223]
    ds_read_b64_tr_b16 v[40:41], v30 offset:0
    ds_read_b64_tr_b16 v[42:43], v30 offset:1024
    s_waitcnt lgkmcnt(6)
    v_mfma_f32_32x32x16_bf16 v[240:255], v[44:47], v[60:63], v[240:255]
    s_cmp_eq_u32 s67, 1
    s_cbranch_scc1 L_k12_sv11
    s_add_u32 s68, s66, 12800
    buffer_store_dwordx4 v[204:207], v13, s[28:31], s68 offen sc1
    s_branch L_k12_sd11
L_k12_sv11:
    s_add_u32 s68, s66, 12800
    buffer_store_dwordx4 v[204:207], v13, s[28:31], s68 offen sc1
L_k12_sd11:
    s_waitcnt vmcnt(16)
    s_barrier
    ds_read_b64_tr_b16 v[44:45], v31 offset:0
    ds_read_b64_tr_b16 v[46:47], v31 offset:1024
    s_waitcnt lgkmcnt(6)
    v_mfma_f32_32x32x16_bf16 v[144:159], v[32:35], v[64:67], v[144:159]
    ds_read_b64_tr_b16 v[32:33], v28 offset:4096
    ds_read_b64_tr_b16 v[34:35], v28 offset:5120
    s_waitcnt lgkmcnt(6)
    v_mfma_f32_32x32x16_bf16 v[176:191], v[36:39], v[64:67], v[176:191]
    ds_read_b64_tr_b16 v[36:37], v29 offset:4096
    ds_read_b64_tr_b16 v[38:39], v29 offset:5120
    s_waitcnt lgkmcnt(6)
    v_mfma_f32_32x32x16_bf16 v[208:223], v[40:43], v[64:67], v[208:223]
    ds_read_b64_tr_b16 v[40:41], v30 offset:4096
    ds_read_b64_tr_b16 v[42:43], v30 offset:5120
    s_waitcnt lgkmcnt(6)
    v_mfma_f32_32x32x16_bf16 v[240:255], v[44:47], v[64:67], v[240:255]
    ds_read_b64_tr_b16 v[44:45], v31 offset:4096
    ds_read_b64_tr_b16 v[46:47], v31 offset:5120
    s_waitcnt lgkmcnt(6)
    v_mfma_f32_32x32x16_bf16 v[144:159], v[32:35], v[68:71], v[144:159]
    ds_read_b64_tr_b16 v[32:33], v28 offset:8192
    ds_read_b64_tr_b16 v[34:35], v28 offset:9216
    s_waitcnt lgkmcnt(6)
    v_mfma_f32_32x32x16_bf16 v[176:191], v[36:39], v[68:71], v[176:191]
    ds_read_b64_tr_b16 v[36:37], v29 offset:8192
    ds_read_b64_tr_b16 v[38:39], v29 offset:9216
    s_waitcnt lgkmcnt(6)
    v_mfma_f32_32x32x16_bf16 v[208:223], v[40:43], v[68:71], v[208:223]
    ds_read_b64_tr_b16 v[40:41], v30 offset:8192
    ds_read_b64_tr_b16 v[42:43], v30 offset:9216
    s_waitcnt lgkmcnt(6)
    v_mfma_f32_32x32x16_bf16 v[240:255], v[44:47], v[68:71], v[240:255]
    s_cmp_eq_u32 s67, 1
    s_cbranch_scc1 L_k12_sv12
    s_add_u32 s68, s66, 6144
    buffer_store_dwordx4 v[224:227], v12, s[28:31], s68 offen sc1
    s_branch L_k12_sd12
L_k12_sv12:
    s_add_u32 s68, s66, 6144
    buffer_store_dwordx4 v[224:227], v12, s[28:31], s68 offen sc1
L_k12_sd12:
    ds_read_b64_tr_b16 v[44:45], v31 offset:8192
    ds_read_b64_tr_b16 v[46:47], v31 offset:9216
    s_waitcnt lgkmcnt(6)
    v_mfma_f32_32x32x16_bf16 v[144:159], v[32:35], v[72:75], v[144:159]
    ds_read_b64_tr_b16 v[32:33], v28 offset:12288
    ds_read_b64_tr_b16 v[34:35], v28 offset:13312
    v_add_u32 v28, 16384, v28
    s_waitcnt lgkmcnt(6)
    v_mfma_f32_32x32x16_bf16 v[176:191], v[36:39], v[72:75], v[176:191]
    ds_read_b64_tr_b16 v[36:37], v29 offset:12288
    ds_read_b64_tr_b16 v[38:39], v29 offset:13312
    v_add_u32 v29, 16384, v29
    s_waitcnt lgkmcnt(6)
    v_mfma_f32_32x32x16_bf16 v[208:223], v[40:43], v[72:75], v[208:223]
    ds_read_b64_tr_b16 v[40:41], v30 offset:12288
    ds_read_b64_tr_b16 v[42:43], v30 offset:13312
    v_add_u32 v30, 16384, v30
    s_waitcnt lgkmcnt(6)
    v_mfma_f32_32x32x16_bf16 v[240:255], v[44:47], v[72:75], v[240:255]
    ds_read_b64_tr_b16 v[44:45], v31 offset:12288
    ds_read_b64_tr_b16 v[46:47], v31 offset:13312
    v_add_u32 v31, 16384, v31
    s_waitcnt lgkmcnt(6)
    v_mfma_f32_32x32x16_bf16 v[144:159], v[32:35], v[76:79], v[144:159]
    ds_read_b64_tr_b16 v[32:33], v28 offset:0
    ds_read_b64_tr_b16 v[34:35], v28 offset:1024
    s_waitcnt lgkmcnt(6)
    v_mfma_f32_32x32x16_bf16 v[176:191], v[36:39], v[76:79], v[176:191]
    ds_read_b64_tr_b16 v[36:37], v29 offset:0
    ds_read_b64_tr_b16 v[38:39], v29 offset:1024
    s_waitcnt lgkmcnt(6)
    v_mfma_f32_32x32x16_bf16 v[208:223], v[40:43], v[76:79], v[208:223]
    ds_read_b64_tr_b16 v[40:41], v30 offset:0
    ds_read_b64_tr_b16 v[42:43], v30 offset:1024
    s_waitcnt lgkmcnt(6)
    v_mfma_f32_32x32x16_bf16 v[240:255], v[44:47], v[76:79], v[240:255]
    s_cmp_eq_u32 s67, 1
    s_cbranch_scc1 L_k12_sv13
    s_add_u32 s68, s66, 6656
    buffer_store_dwordx4 v[228:231], v13, s[28:31], s68 offen sc1
    s_branch L_k12_sd13
L_k12_sv13:
    s_add_u32 s68, s66, 14336
    buffer_store_dwordx4 v[228:231], v12, s[28:31], s68 offen sc1
L_k12_sd13:
    s_waitcnt vmcnt(10)
    s_barrier
    ds_read_b64_tr_b16 v[44:45], v31 offset:0
    ds_read_b64_tr_b16 v[46:47], v31 offset:1024
    s_waitcnt lgkmcnt(6)
    v_mfma_f32_32x32x16_bf16 v[144:159], v[32:35], v[80:83], v[144:159]
    ds_read_b64_tr_b16 v[32:33], v28 offset:4096
    ds_read_b64_tr_b16 v[34:35], v28 offset:5120
    s_waitcnt lgkmcnt(6)
    v_mfma_f32_32x32x16_bf16 v[176:191], v[36:39], v[80:83], v[176:191]
    ds_read_b64_tr_b16 v[36:37], v29 offset:4096
    ds_read_b64_tr_b16 v[38:39], v29 offset:5120
    s_waitcnt lgkmcnt(6)
    v_mfma_f32_32x32x16_bf16 v[208:223], v[40:43], v[80:83], v[208:223]
    ds_read_b64_tr_b16 v[40:41], v30 offset:4096
    ds_read_b64_tr_b16 v[42:43], v30 offset:5120
    s_waitcnt lgkmcnt(6)
    v_mfma_f32_32x32x16_bf16 v[240:255], v[44:47], v[80:83], v[240:255]
    ds_read_b64_tr_b16 v[44:45], v31 offset:4096
    ds_read_b64_tr_b16 v[46:47], v31 offset:5120
    s_waitcnt lgkmcnt(6)
    v_mfma_f32_32x32x16_bf16 v[144:159], v[32:35], v[84:87], v[144:159]
    ds_read_b64_tr_b16 v[32:33], v28 offset:8192
    ds_read_b64_tr_b16 v[34:35], v28 offset:9216
    s_waitcnt lgkmcnt(6)
    v_mfma_f32_32x32x16_bf16 v[176:191], v[36:39], v[84:87], v[176:191]
    ds_read_b64_tr_b16 v[36:37], v29 offset:8192
    ds_read_b64_tr_b16 v[38:39], v29 offset:9216
    s_waitcnt lgkmcnt(6)
    v_mfma_f32_32x32x16_bf16 v[208:223], v[40:43], v[84:87], v[208:223]
    ds_read_b64_tr_b16 v[40:41], v30 offset:8192
    ds_read_b64_tr_b16 v[42:43], v30 offset:9216
    s_waitcnt lgkmcnt(6)
    v_mfma_f32_32x32x16_bf16 v[240:255], v[44:47], v[84:87], v[240:255]
    s_cmp_eq_u32 s67, 1
    s_cbranch_scc1 L_k12_sv14
    s_add_u32 s68, s66, 14336
    buffer_store_dwordx4 v[232:235], v12, s[28:31], s68 offen sc1
    s_branch L_k12_sd14
L_k12_sv14:
    s_add_u32 s68, s66, 6656
    buffer_store_dwordx4 v[232:235], v13, s[28:31], s68 offen sc1
L_k12_sd14:
    ds_read_b64_tr_b16 v[44:45], v31 offset:8192
    ds_read_b64_tr_b16 v[46:47], v31 offset:9216
    s_waitcnt lgkmcnt(6)
    v_mfma_f32_32x32x16_bf16 v[144:159], v[32:35], v[88:91], v[144:159]
    ds_read_b64_tr_b16 v[32:33], v28 offset:12288
    ds_read_b64_tr_b16 v[34:35], v28 offset:13312
    v_add_u32 v28, 16384, v28
    s_waitcnt lgkmcnt(6)
    v_mfma_f32_32x32x16_bf16 v[176:191], v[36:39], v[88:91], v[176:191]
    ds_read_b64_tr_b16 v[36:37], v29 offset:12288
    ds_read_b64_tr_b16 v[38:39], v29 offset:13312
    v_add_u32 v29, 16384, v29
    s_waitcnt lgkmcnt(6)
    v_mfma_f32_32x32x16_bf16 v[208:223], v[40:43], v[88:91], v[208:223]
    ds_read_b64_tr_b16 v[40:41], v30 offset:12288
    ds_read_b64_tr_b16 v[42:43], v30 offset:13312
    v_add_u32 v30, 16384, v30
    s_waitcnt lgkmcnt(6)
    v_mfma_f32_32x32x16_bf16 v[240:255], v[44:47], v[88:91], v[240:255]
    ds_read_b64_tr_b16 v[44:45], v31 offset:12288
    ds_read_b64_tr_b16 v[46:47], v31 offset:13312
    v_add_u32 v31, 16384, v31
    s_waitcnt lgkmcnt(6)
    v_mfma_f32_32x32x16_bf16 v[144:159], v[32:35], v[92:95], v[144:159]
    ds_read_b64_tr_b16 v[32:33], v28 offset:0
    ds_read_b64_tr_b16 v[34:35], v28 offset:1024
    s_waitcnt lgkmcnt(6)
    v_mfma_f32_32x32x16_bf16 v[176:191], v[36:39], v[92:95], v[176:191]
    ds_read_b64_tr_b16 v[36:37], v29 offset:0
    ds_read_b64_tr_b16 v[38:39], v29 offset:1024
    s_waitcnt lgkmcnt(6)
    v_mfma_f32_32x32x16_bf16 v[208:223], v[40:43], v[92:95], v[208:223]
    ds_read_b64_tr_b16 v[40:41], v30 offset:0
    ds_read_b64_tr_b16 v[42:43], v30 offset:1024
    s_waitcnt lgkmcnt(6)
    v_mfma_f32_32x32x16_bf16 v[240:255], v[44:47], v[92:95], v[240:255]
    s_cmp_eq_u32 s67, 1
    s_cbranch_scc1 L_k12_sv15
    s_add_u32 s68, s66, 14848
    buffer_store_dwordx4 v[236:239], v13, s[28:31], s68 offen sc1
    s_branch L_k12_sd15
L_k12_sv15:
    s_add_u32 s68, s66, 14848
    buffer_store_dwordx4 v[236:239], v13, s[28:31], s68 offen sc1
L_k12_sd15:
    s_waitcnt vmcnt(0)
    s_barrier
    s_cmp_lg_u32 s32, 0
    s_cbranch_scc1 L_ws_kv
    s_lshl_b32 s96, s2, 7
    s_add_u32 s96, s96, 126025728
    v_mov_b32 v16, 1
    v_mov_b32 v17, 0
    s_mov_b64 exec, 1
    buffer_store_dword v16, v17, s[28:31], s96 offen sc1
    s_mov_b64 exec, -1
L_ws_kv:
    ds_read_b64_tr_b16 v[44:45], v31 offset:0
    ds_read_b64_tr_b16 v[46:47], v31 offset:1024
    s_waitcnt lgkmcnt(6)
    v_mfma_f32_32x32x16_bf16 v[144:159], v[32:35], v[96:99], v[144:159]
    ds_read_b64_tr_b16 v[32:33], v28 offset:4096
    ds_read_b64_tr_b16 v[34:35], v28 offset:5120
    s_waitcnt lgkmcnt(6)
    v_mfma_f32_32x32x16_bf16 v[176:191], v[36:39], v[96:99], v[176:191]
    ds_read_b64_tr_b16 v[36:37], v29 offset:4096
    ds_read_b64_tr_b16 v[38:39], v29 offset:5120
    s_waitcnt lgkmcnt(6)
    v_mfma_f32_32x32x16_bf16 v[208:223], v[40:43], v[96:99], v[208:223]
    ds_read_b64_tr_b16 v[40:41], v30 offset:4096
    ds_read_b64_tr_b16 v[42:43], v30 offset:5120
    s_waitcnt lgkmcnt(6)
    v_mfma_f32_32x32x16_bf16 v[240:255], v[44:47], v[96:99], v[240:255]
    ds_read_b64_tr_b16 v[44:45], v31 offset:4096
    ds_read_b64_tr_b16 v[46:47], v31 offset:5120
    s_waitcnt lgkmcnt(6)
    v_mfma_f32_32x32x16_bf16 v[144:159], v[32:35], v[100:103], v[144:159]
    ds_read_b64_tr_b16 v[32:33], v28 offset:8192
    ds_read_b64_tr_b16 v[34:35], v28 offset:9216
    s_waitcnt lgkmcnt(6)
    v_mfma_f32_32x32x16_bf16 v[176:191], v[36:39], v[100:103], v[176:191]
    ds_read_b64_tr_b16 v[36:37], v29 offset:8192
    ds_read_b64_tr_b16 v[38:39], v29 offset:9216
    s_waitcnt lgkmcnt(6)
    v_mfma_f32_32x32x16_bf16 v[208:223], v[40:43], v[100:103], v[208:223]
    ds_read_b64_tr_b16 v[40:41], v30 offset:8192
    ds_read_b64_tr_b16 v[42:43], v30 offset:9216
    s_waitcnt lgkmcnt(6)
    v_mfma_f32_32x32x16_bf16 v[240:255], v[44:47], v[100:103], v[240:255]
    ds_read_b64_tr_b16 v[44:45], v31 offset:8192
    ds_read_b64_tr_b16 v[46:47], v31 offset:9216
    s_waitcnt lgkmcnt(6)
    v_mfma_f32_32x32x16_bf16 v[144:159], v[32:35], v[104:107], v[144:159]
    ds_read_b64_tr_b16 v[32:33], v28 offset:12288
    ds_read_b64_tr_b16 v[34:35], v28 offset:13312
    v_add_u32 v28, 16384, v28
    s_waitcnt lgkmcnt(6)
    v_mfma_f32_32x32x16_bf16 v[176:191], v[36:39], v[104:107], v[176:191]
    ds_read_b64_tr_b16 v[36:37], v29 offset:12288
    ds_read_b64_tr_b16 v[38:39], v29 offset:13312
    v_add_u32 v29, 16384, v29
    s_waitcnt lgkmcnt(6)
    v_mfma_f32_32x32x16_bf16 v[208:223], v[40:43], v[104:107], v[208:223]
    ds_read_b64_tr_b16 v[40:41], v30 offset:12288
    ds_read_b64_tr_b16 v[42:43], v30 offset:13312
    v_add_u32 v30, 16384, v30
    s_waitcnt lgkmcnt(6)
    v_mfma_f32_32x32x16_bf16 v[240:255], v[44:47], v[104:107], v[240:255]
    ds_read_b64_tr_b16 v[44:45], v31 offset:12288
    ds_read_b64_tr_b16 v[46:47], v31 offset:13312
    v_add_u32 v31, 16384, v31
    s_waitcnt lgkmcnt(6)
    v_mfma_f32_32x32x16_bf16 v[144:159], v[32:35], v[108:111], v[144:159]
    s_waitcnt lgkmcnt(4)
    v_mfma_f32_32x32x16_bf16 v[176:191], v[36:39], v[108:111], v[176:191]
    s_waitcnt lgkmcnt(2)
    v_mfma_f32_32x32x16_bf16 v[208:223], v[40:43], v[108:111], v[208:223]
    s_waitcnt lgkmcnt(0)
    v_mfma_f32_32x32x16_bf16 v[240:255], v[44:47], v[108:111], v[240:255]
    s_nop 7
    s_nop 7
    s_cmp_lg_u32 s32, 0
    s_cbranch_scc1 L_ww_kv_done
    v_and_b32 v16, 63, v0
    v_lshrrev_b32 v19, 1, v16
    v_and_b32 v17, 1, v16
    v_lshlrev_b32 v17, 2, v17
    v_lshl_add_u32 v17, v19, 5, v17
    s_bfe_u32 s48, s33, 0x20001
    s_lshl_b32 s48, s48, 3
    s_lshr_b32 s49, s33, 3
    s_add_u32 s48, s48, s49
    v_add_u32 v17, s48, v17
    v_lshlrev_b32 v17, 7, v17
    s_mov_b32 s97, 126025728
    s_mov_b32 s96, 0x100000
    s_mov_b64 exec, 65535
L_ww_kv_loop:
    buffer_load_dword v18, v17, s[28:31], s97 offen sc1
    s_waitcnt vmcnt(0)
    v_cmp_ne_u32 vcc, 1, v18
    s_nop 1
    s_cbranch_vccz L_ww_kv_ok
    s_sleep 2
    s_sub_u32 s96, s96, 1
    s_cmp_lg_u32 s96, 0
    s_cbranch_scc1 L_ww_kv_loop
L_ww_kv_ok:
    s_mov_b64 exec, -1
L_ww_kv_done:
    s_barrier
    s_mov_b32 m0, s42
    s_xor_b32 s42, s42, 65536
    buffer_load_dwordx4 v27, s[24:27], s58 offen offset:0 lds
    buffer_load_dwordx4 v27, s[24:27], s58 offen offset:1024 lds
    buffer_load_dwordx4 v27, s[24:27], s58 offen offset:2048 lds
    buffer_load_dwordx4 v27, s[24:27], s58 offen offset:3072 lds
    s_mov_b32 m0, s45
    s_xor_b32 s45, s45, 65536
    buffer_load_dwordx4 v27, s[24:27], s41 offen offset:0 lds
    buffer_load_dwordx4 v27, s[24:27], s41 offen offset:1024 lds
    buffer_load_dwordx4 v27, s[24:27], s41 offen offset:2048 lds
    buffer_load_dwordx4 v27, s[24:27], s41 offen offset:3072 lds
    s_mov_b32 s48, 0.12751743082459868
    v_mul_f32 v144, s48, v144
    v_mul_f32 v145, s48, v145
    v_mul_f32 v146, s48, v146
    v_mul_f32 v147, s48, v147
    v_mul_f32 v148, s48, v148
    v_mul_f32 v149, s48, v149
    v_mul_f32 v150, s48, v150
    v_mul_f32 v151, s48, v151
    v_mul_f32 v152, s48, v152
    v_mul_f32 v153, s48, v153
    v_mul_f32 v154, s48, v154
    v_mul_f32 v155, s48, v155
    v_mul_f32 v156, s48, v156
    v_mul_f32 v157, s48, v157
    v_mul_f32 v158, s48, v158
    v_mul_f32 v159, s48, v159
    v_mul_f32 v176, s48, v176
    v_mul_f32 v177, s48, v177
    v_mul_f32 v178, s48, v178
    v_mul_f32 v179, s48, v179
    v_mul_f32 v180, s48, v180
    v_mul_f32 v181, s48, v181
    v_mul_f32 v182, s48, v182
    v_mul_f32 v183, s48, v183
    v_mul_f32 v184, s48, v184
    v_mul_f32 v185, s48, v185
    v_mul_f32 v186, s48, v186
    v_mul_f32 v187, s48, v187
    v_mul_f32 v188, s48, v188
    v_mul_f32 v189, s48, v189
    v_mul_f32 v190, s48, v190
    v_mul_f32 v191, s48, v191
    v_mul_f32 v208, s48, v208
    v_mul_f32 v209, s48, v209
    v_mul_f32 v210, s48, v210
    v_mul_f32 v211, s48, v211
    v_mul_f32 v212, s48, v212
    v_mul_f32 v213, s48, v213
    v_mul_f32 v214, s48, v214
    v_mul_f32 v215, s48, v215
    v_mul_f32 v216, s48, v216
    v_mul_f32 v217, s48, v217
    v_mul_f32 v218, s48, v218
    v_mul_f32 v219, s48, v219
    v_mul_f32 v220, s48, v220
    v_mul_f32 v221, s48, v221
    v_mul_f32 v222, s48, v222
    v_mul_f32 v223, s48, v223
    v_mul_f32 v240, s48, v240
    v_mul_f32 v241, s48, v241
    v_mul_f32 v242, s48, v242
    v_mul_f32 v243, s48, v243
    v_mul_f32 v244, s48, v244
    v_mul_f32 v245, s48, v245
    v_mul_f32 v246, s48, v246
    v_mul_f32 v247, s48, v247
    v_mul_f32 v248, s48, v248
    v_mul_f32 v249, s48, v249
    v_mul_f32 v250, s48, v250
    v_mul_f32 v251, s48, v251
    v_mul_f32 v252, s48, v252
    v_mul_f32 v253, s48, v253
    v_mul_f32 v254, s48, v254
    v_mul_f32 v255, s48, v255
    v_cvt_pk_bf16_f32 v128, v144, v145
    v_cvt_pk_bf16_f32 v129, v146, v147
    v_cvt_pk_bf16_f32 v130, v148, v149
    v_cvt_pk_bf16_f32 v131, v150, v151
    v_cvt_pk_bf16_f32 v132, v152, v153
    v_cvt_pk_bf16_f32 v133, v154, v155
    v_cvt_pk_bf16_f32 v134, v156, v157
    v_cvt_pk_bf16_f32 v135, v158, v159
    v_cvt_pk_bf16_f32 v136, v176, v177
    v_cvt_pk_bf16_f32 v137, v178, v179
    v_cvt_pk_bf16_f32 v138, v180, v181
    v_cvt_pk_bf16_f32 v139, v182, v183
    v_cvt_pk_bf16_f32 v140, v184, v185
    v_cvt_pk_bf16_f32 v141, v186, v187
    v_cvt_pk_bf16_f32 v142, v188, v189
    v_cvt_pk_bf16_f32 v143, v190, v191
    v_cvt_pk_bf16_f32 v144, v208, v209
    v_cvt_pk_bf16_f32 v145, v210, v211
    v_cvt_pk_bf16_f32 v146, v212, v213
    v_cvt_pk_bf16_f32 v147, v214, v215
    v_cvt_pk_bf16_f32 v148, v216, v217
    v_cvt_pk_bf16_f32 v149, v218, v219
    v_cvt_pk_bf16_f32 v150, v220, v221
    v_cvt_pk_bf16_f32 v151, v222, v223
    v_cvt_pk_bf16_f32 v152, v240, v241
    v_cvt_pk_bf16_f32 v153, v242, v243
    v_cvt_pk_bf16_f32 v154, v244, v245
    v_cvt_pk_bf16_f32 v155, v246, v247
    v_cvt_pk_bf16_f32 v156, v248, v249
    v_cvt_pk_bf16_f32 v157, v250, v251
    v_cvt_pk_bf16_f32 v158, v252, v253
    v_cvt_pk_bf16_f32 v159, v254, v255
    s_barrier
    s_lshl_b32 s48, s35, 13
    s_add_u32 s48, s48, 131072
    v_add_u32 v22, s48, v27
    s_cmp_eq_u32 s36, 0
    s_cbranch_scc1 L_k2_qw2
    ds_write_b128 v22, v[128:131] offset:0
    ds_write_b128 v22, v[132:135] offset:1024
    ds_write_b128 v22, v[136:139] offset:2048
    ds_write_b128 v22, v[140:143] offset:3072
    ds_write_b128 v22, v[144:147] offset:4096
    ds_write_b128 v22, v[148:151] offset:5120
    ds_write_b128 v22, v[152:155] offset:6144
    ds_write_b128 v22, v[156:159] offset:7168
L_k2_qw2:
    v_and_b32 v3, 31, v2
    v_lshrrev_b32 v4, 5, v2
    s_lshl_b32 s48, s36, 14
    v_bfe_u32 v5, v2, 2, 2
    v_xor_b32 v5, v5, v4
    v_lshlrev_b32 v6, 6, v3
    v_add_u32 v6, s48, v6
    v_lshl_add_u32 v32, v5, 4, v6
    v_xor_b32 v33, 32, v32
    v_add_u32 v40, 32768, v32
    v_add_u32 v41, 32768, v33
    v_lshlrev_b32 v6, 2, v4
    v_sub_u32 v46, v3, v6
    s_sub_u32 s56, 15, s34
    s_lshl_b32 s56, s56, 7
    s_lshl_b32 s48, s35, 5
    s_add_u32 s56, s56, s48
    s_lshl_b32 s39, s34, 7
    s_add_u32 s39, s39, s48
    s_sub_u32 s53, s37, 1
    s_cmp_eq_u32 s36, 1
    s_cselect_b32 s39, s56, s39
    s_cselect_b32 s53, 100, s53
    s_mov_b32 s16, s8
    s_and_b32 s17, s9, 0xffff
    s_mov_b32 s18, 4718592
    s_mov_b32 s19, 0x00020000
    s_lshl_b32 s46, s2, 3
    s_add_u32 s46, s46, s32
    s_mul_i32 s46, s46, 1408
    s_mov_b32 s47, 8
    v_lshlrev_b32 v20, 7, v2
    v_mov_b32 v192, 0
    v_mov_b32 v193, 0
    v_mov_b32 v194, 0
    v_mov_b32 v195, 0
    v_mov_b32 v196, 0
    v_mov_b32 v197, 0
    v_mov_b32 v198, 0
    v_mov_b32 v199, 0
    v_mov_b32 v200, 0
    v_mov_b32 v201, 0
    v_mov_b32 v202, 0
    v_mov_b32 v203, 0
    v_mov_b32 v204, 0
    v_mov_b32 v205, 0
    v_mov_b32 v206, 0
    v_mov_b32 v207, 0
    v_mov_b32 v208, 0
    v_mov_b32 v209, 0
    v_mov_b32 v210, 0
    v_mov_b32 v211, 0
    v_mov_b32 v212, 0
    v_mov_b32 v213, 0
    v_mov_b32 v214, 0
    v_mov_b32 v215, 0
    v_mov_b32 v216, 0
    v_mov_b32 v217, 0
    v_mov_b32 v218, 0
    v_mov_b32 v219, 0
    v_mov_b32 v220, 0
    v_mov_b32 v221, 0
    v_mov_b32 v222, 0
    v_mov_b32 v223, 0
    v_mov_b32 v224, 0
    v_mov_b32 v225, 0
    v_mov_b32 v226, 0
    v_mov_b32 v227, 0
    v_mov_b32 v228, 0
    v_mov_b32 v229, 0
    v_mov_b32 v230, 0
    v_mov_b32 v231, 0
    v_mov_b32 v232, 0
    v_mov_b32 v233, 0
    v_mov_b32 v234, 0
    v_mov_b32 v235, 0
    v_mov_b32 v236, 0
    v_mov_b32 v237, 0
    v_mov_b32 v238, 0
    v_mov_b32 v239, 0
    v_mov_b32 v240, 0
    v_mov_b32 v241, 0
    v_mov_b32 v242, 0
    v_mov_b32 v243, 0
    v_mov_b32 v244, 0
    v_mov_b32 v245, 0
    v_mov_b32 v246, 0
    v_mov_b32 v247, 0
    v_mov_b32 v248, 0
    v_mov_b32 v249, 0
    v_mov_b32 v250, 0
    v_mov_b32 v251, 0
    v_mov_b32 v252, 0
    v_mov_b32 v253, 0
    v_mov_b32 v254, 0
    v_mov_b32 v255, 0
    v_mov_b32 v112, 0
    v_mov_b32 v113, 0
    v_mov_b32 v114, 0
    v_mov_b32 v115, 0
    v_mov_b32 v116, 0
    v_mov_b32 v117, 0
    v_mov_b32 v118, 0
    v_mov_b32 v119, 0
    v_mov_b32 v120, 0
    v_mov_b32 v121, 0
    v_mov_b32 v122, 0
    v_mov_b32 v123, 0
    v_mov_b32 v124, 0
    v_mov_b32 v125, 0
    v_mov_b32 v126, 0
    v_mov_b32 v127, 0
    v_mov_b32 v104, 0
    v_mov_b32 v105, 0
    v_mov_b32 v106, 0
    v_mov_b32 v107, 0
    v_mov_b32 v108, 0
    v_mov_b32 v109, 0
    v_mov_b32 v110, 0
    v_mov_b32 v111, 0
    v_mov_b32 v44, 0
    v_mov_b32 v45, 3769465068
    s_mov_b32 s57, -1.0
    s_mov_b32 s38, -1
    s_mov_b32 s55, 0
    s_waitcnt vmcnt(0) lgkmcnt(0)
    s_barrier
    s_lshl_b32 s50, s59, 14
    s_add_u32 s50, s50, s40
    s_mov_b32 m0, s42
    s_xor_b32 s42, s42, 65536
    buffer_load_dwordx4 v27, s[24:27], s50 offen offset:0 lds
    buffer_load_dwordx4 v27, s[24:27], s50 offen offset:1024 lds
    buffer_load_dwordx4 v27, s[24:27], s50 offen offset:2048 lds
    buffer_load_dwordx4 v27, s[24:27], s50 offen offset:3072 lds
    s_mov_b64 exec, 1
    buffer_load_dword v21, v20, s[20:23], s40 offen
    s_mov_b64 exec, -1
    ds_read_b128 v[64:67], v32 offset:8192
    ds_read_b128 v[68:71], v33 offset:8192
    ds_read_b128 v[72:75], v32 offset:10240
    ds_read_b128 v[76:79], v33 offset:10240
    ds_read_b128 v[80:83], v32 offset:12288
    ds_read_b128 v[84:87], v33 offset:12288
    ds_read_b128 v[88:91], v32 offset:14336
    ds_read_b128 v[92:95], v33 offset:14336
    s_add_u32 s50, s38, s59
    s_add_u32 s50, s50, 2
    s_lshl_b32 s49, s50, 1
    s_sub_u32 s49, s49, s37
    s_add_u32 s49, s49, s36
    s_cmp_lt_u32 s50, s37
    s_cselect_b32 s50, s50, s49
    s_lshl_b32 s50, s50, 14
    s_add_u32 s50, s50, s40
    s_add_u32 s51, s38, 2
    s_lshl_b32 s49, s51, 1
    s_sub_u32 s49, s49, s37
    s_add_u32 s49, s49, s36
    s_cmp_lt_u32 s51, s37
    s_cselect_b32 s51, s51, s49
    s_mov_b32 s43, s51
    s_lshl_b32 s51, s51, 14
    s_add_u32 s51, s51, s41
    s_cmp_lt_i32 s38, 15
    s_cselect_b32 s26, 268435456, 0
    s_waitcnt lgkmcnt(7)
    v_mfma_f32_32x32x16_bf16 v[160:175], v[64:67], v[128:131], v[112:127]
    s_waitcnt lgkmcnt(6)
    v_mfma_f32_32x32x16_bf16 v[160:175], v[68:71], v[132:135], v[160:175]
    s_waitcnt lgkmcnt(5)
    v_mfma_f32_32x32x16_bf16 v[160:175], v[72:75], v[136:139], v[160:175]
    s_waitcnt lgkmcnt(4)
    v_mfma_f32_32x32x16_bf16 v[160:175], v[76:79], v[140:143], v[160:175]
    s_waitcnt lgkmcnt(3)
    v_mfma_f32_32x32x16_bf16 v[160:175], v[80:83], v[144:147], v[160:175]
    s_waitcnt lgkmcnt(2)
    v_mfma_f32_32x32x16_bf16 v[160:175], v[84:87], v[148:151], v[160:175]
    s_waitcnt lgkmcnt(1)
    v_mfma_f32_32x32x16_bf16 v[160:175], v[88:91], v[152:155], v[160:175]
    s_waitcnt lgkmcnt(0)
    v_mfma_f32_32x32x16_bf16 v[160:175], v[92:95], v[156:159], v[160:175]
    v_xor_b32 v32, 0x10000, v32
    v_xor_b32 v33, 0x10000, v33
    s_nop 7
    s_lshl_b32 s48, s55, 6
    s_sub_i32 s48, s39, s48
    s_cmp_lt_i32 s48, 31
    s_cbranch_scc1 L_k2_p0_mask
L_k2_p0_nomask:
L_k2_loop:
    s_waitcnt vmcnt(1)
    s_barrier
    ds_read_b128 v[64:67], v32 offset:0
    ds_read_b128 v[68:71], v33 offset:0
    v_mfma_f32_32x32x16_bf16 v[224:239], v[72:75], v[104:107], v[224:239]
    ds_read_b128 v[72:75], v32 offset:2048
    v_exp_f32 v48, v160
    v_exp_f32 v49, v161
    v_exp_f32 v50, v162
    v_exp_f32 v51, v163
    s_mov_b32 m0, s42
    s_xor_b32 s42, s42, 65536
    buffer_load_dwordx4 v27, s[24:27], s50 offen lds
    v_mfma_f32_32x32x16_bf16 v[240:255], v[76:79], v[104:107], v[240:255]
    ds_read_b128 v[76:79], v33 offset:2048
    v_add_f32 v8, v48, v49
    v_cvt_pk_bf16_f32 v96, v48, v49
    v_exp_f32 v52, v164
    v_mfma_f32_32x32x16_bf16 v[192:207], v[80:83], v[108:111], v[192:207]
    ds_read_b128 v[80:83], v32 offset:4096
    v_add_f32 v8, v8, v50
    v_add_f32 v8, v8, v51
    v_exp_f32 v53, v165
    buffer_load_dwordx4 v27, s[24:27], s50 offen offset:1024 lds
    v_mfma_f32_32x32x16_bf16 v[208:223], v[84:87], v[108:111], v[208:223]
    ds_read_b128 v[84:87], v33 offset:4096
    v_cvt_pk_bf16_f32 v97, v50, v51
    v_add_f32 v8, v8, v52
    v_exp_f32 v54, v166
    v_mfma_f32_32x32x16_bf16 v[224:239], v[88:91], v[108:111], v[224:239]
    ds_read_b128 v[88:91], v32 offset:6144
    v_add_f32 v8, v8, v53
    v_cvt_pk_bf16_f32 v98, v52, v53
    v_exp_f32 v55, v167
    buffer_load_dwordx4 v27, s[24:27], s50 offen offset:2048 lds
    v_mfma_f32_32x32x16_bf16 v[240:255], v[92:95], v[108:111], v[240:255]
    ds_read_b128 v[92:95], v33 offset:6144
    v_add_f32 v8, v8, v54
    v_add_f32 v8, v8, v55
    v_cvt_pk_bf16_f32 v99, v54, v55
    s_cmp_eq_u32 s38, s53
    s_cbranch_scc1 L_k2_fin_small
L_k2_fin_small_done:
    s_mov_b32 s54, s55
    s_mov_b32 s55, s43
    s_add_u32 s38, s38, 1
    s_waitcnt lgkmcnt(7)
    v_mfma_f32_32x32x16_bf16 v[176:191], v[64:67], v[128:131], v[112:127]
    ds_read_b128 v[64:67], v40 offset:0
    v_exp_f32 v48, v168
    v_exp_f32 v49, v169
    v_exp_f32 v50, v170
    buffer_load_dwordx4 v27, s[24:27], s50 offen offset:3072 lds
    s_waitcnt lgkmcnt(7)
    v_mfma_f32_32x32x16_bf16 v[176:191], v[68:71], v[132:135], v[176:191]
    ds_read_b128 v[68:71], v40 offset:2048
    v_exp_f32 v51, v171
    v_add_f32 v8, v8, v48
    v_add_f32 v8, v8, v49
    s_waitcnt lgkmcnt(7)
    v_mfma_f32_32x32x16_bf16 v[176:191], v[72:75], v[136:139], v[176:191]
    ds_read_b128 v[72:75], v40 offset:4096
    v_exp_f32 v52, v172
    v_cvt_pk_bf16_f32 v100, v48, v49
    v_add_f32 v8, v8, v50
    s_mov_b32 m0, s45
    s_xor_b32 s45, s45, 65536
    buffer_load_dwordx4 v27, s[24:27], s51 offen lds
    s_waitcnt lgkmcnt(7)
    v_mfma_f32_32x32x16_bf16 v[176:191], v[76:79], v[140:143], v[176:191]
    ds_read_b128 v[76:79], v40 offset:6144
    v_exp_f32 v53, v173
    v_add_f32 v8, v8, v51
    v_cvt_pk_bf16_f32 v101, v50, v51
    s_waitcnt lgkmcnt(7)
    v_mfma_f32_32x32x16_bf16 v[176:191], v[80:83], v[144:147], v[176:191]
    ds_read_b128 v[80:83], v41 offset:0
    v_exp_f32 v54, v174
    v_add_f32 v8, v8, v52
    buffer_load_dwordx4 v27, s[24:27], s51 offen offset:1024 lds
    s_waitcnt lgkmcnt(7)
    v_mfma_f32_32x32x16_bf16 v[176:191], v[84:87], v[148:151], v[176:191]
    ds_read_b128 v[84:87], v41 offset:2048
    v_add_f32 v8, v8, v53
    v_exp_f32 v55, v175
    s_waitcnt lgkmcnt(7)
    v_mfma_f32_32x32x16_bf16 v[176:191], v[88:91], v[152:155], v[176:191]
    ds_read_b128 v[88:91], v41 offset:4096
    v_cvt_pk_bf16_f32 v102, v52, v53
    v_add_f32 v8, v8, v54
    buffer_load_dwordx4 v27, s[24:27], s51 offen offset:2048 lds
    s_waitcnt lgkmcnt(7)
    v_mfma_f32_32x32x16_bf16 v[176:191], v[92:95], v[156:159], v[176:191]
    ds_read_b128 v[92:95], v41 offset:6144
    v_add_f32 v8, v8, v55
    v_cvt_pk_bf16_f32 v103, v54, v55
    s_lshl_b32 s48, s54, 6
    s_sub_i32 s48, s39, s48
    s_cmp_lt_i32 s48, 63
    s_cbranch_scc1 L_k2_m1_mask
L_k2_m1_nomask:
    v_cmp_nge_f32 vcc, s57, v8
    s_cbranch_vccnz L_k2_a_rare
L_k2_a_go:
    v_add_f32 v44, v44, v8
    s_cmp_eq_u32 s38, s53
    s_cbranch_scc1 L_k2_sw1
L_k2_sw1_done:
    s_waitcnt lgkmcnt(7)
    v_mfma_f32_32x32x16_bf16 v[192:207], v[64:67], v[96:99], v[192:207]
    ds_read_b128 v[64:67], v32 offset:8192
    s_nop 1
    s_nop 1
    v_exp_f32 v48, v176
    buffer_load_dwordx4 v27, s[24:27], s51 offen offset:3072 lds
    s_mov_b64 exec, 0x7ff
    buffer_load_dword v21, v20, s[16:19], s46 offen
    s_mov_b64 exec, -1
    s_sub_u32 s47, s47, 1
    s_add_u32 s46, s46, 2883584
    s_bitcmp1_b32 s47, 0
    s_cbranch_scc0 L_k2_pfrot
L_k2_pfdone:
    s_waitcnt lgkmcnt(7)
    v_mfma_f32_32x32x16_bf16 v[208:223], v[68:71], v[96:99], v[208:223]
    ds_read_b128 v[68:71], v33 offset:8192
    v_exp_f32 v49, v177
    v_exp_f32 v50, v178
    v_exp_f32 v51, v179
    s_waitcnt lgkmcnt(7)
    v_mfma_f32_32x32x16_bf16 v[224:239], v[72:75], v[96:99], v[224:239]
    ds_read_b128 v[72:75], v32 offset:10240
    v_add_f32 v9, v48, v49
    v_cvt_pk_bf16_f32 v104, v48, v49
    v_exp_f32 v52, v180
    s_waitcnt lgkmcnt(7)
    v_mfma_f32_32x32x16_bf16 v[240:255], v[76:79], v[96:99], v[240:255]
    ds_read_b128 v[76:79], v33 offset:10240
    v_add_f32 v9, v9, v50
    v_add_f32 v9, v9, v51
    v_exp_f32 v53, v181
    s_waitcnt lgkmcnt(7)
    v_mfma_f32_32x32x16_bf16 v[192:207], v[80:83], v[100:103], v[192:207]
    ds_read_b128 v[80:83], v32 offset:12288
    v_cvt_pk_bf16_f32 v105, v50, v51
    v_add_f32 v9, v9, v52
    v_exp_f32 v54, v182
    s_waitcnt lgkmcnt(7)
    v_mfma_f32_32x32x16_bf16 v[208:223], v[84:87], v[100:103], v[208:223]
    ds_read_b128 v[84:87], v33 offset:12288
    v_add_f32 v9, v9, v53
    v_cvt_pk_bf16_f32 v106, v52, v53
    s_waitcnt lgkmcnt(7)
    v_mfma_f32_32x32x16_bf16 v[224:239], v[88:91], v[100:103], v[224:239]
    ds_read_b128 v[88:91], v32 offset:14336
    v_exp_f32 v55, v183
    v_add_f32 v9, v9, v54
    s_waitcnt lgkmcnt(7)
    v_mfma_f32_32x32x16_bf16 v[240:255], v[92:95], v[100:103], v[240:255]
    ds_read_b128 v[92:95], v33 offset:14336
    v_add_f32 v9, v9, v55
    v_cvt_pk_bf16_f32 v107, v54, v55
    v_xor_b32 v32, 0x10000, v32
    v_xor_b32 v33, 0x10000, v33
    s_waitcnt lgkmcnt(7)
    v_mfma_f32_32x32x16_bf16 v[160:175], v[64:67], v[128:131], v[112:127]
    ds_read_b128 v[64:67], v40 offset:8192
    v_exp_f32 v48, v184
    v_exp_f32 v49, v185
    v_exp_f32 v50, v186
    s_waitcnt lgkmcnt(7)
    v_mfma_f32_32x32x16_bf16 v[160:175], v[68:71], v[132:135], v[160:175]
    ds_read_b128 v[68:71], v40 offset:10240
    v_exp_f32 v51, v187
    v_add_f32 v9, v9, v48
    v_add_f32 v9, v9, v49
    s_waitcnt lgkmcnt(7)
    v_mfma_f32_32x32x16_bf16 v[160:175], v[72:75], v[136:139], v[160:175]
    ds_read_b128 v[72:75], v40 offset:12288
    v_exp_f32 v52, v188
    v_cvt_pk_bf16_f32 v108, v48, v49
    v_add_f32 v9, v9, v50
    s_waitcnt lgkmcnt(7)
    v_mfma_f32_32x32x16_bf16 v[160:175], v[76:79], v[140:143], v[160:175]
    ds_read_b128 v[76:79], v40 offset:14336
    v_exp_f32 v53, v189
    v_add_f32 v9, v9, v51
    v_cvt_pk_bf16_f32 v109, v50, v51
    s_waitcnt lgkmcnt(7)
    v_mfma_f32_32x32x16_bf16 v[160:175], v[80:83], v[144:147], v[160:175]
    ds_read_b128 v[80:83], v41 offset:8192
    v_exp_f32 v54, v190
    v_add_f32 v9, v9, v52
    s_waitcnt lgkmcnt(7)
    v_mfma_f32_32x32x16_bf16 v[160:175], v[84:87], v[148:151], v[160:175]
    ds_read_b128 v[84:87], v41 offset:10240
    v_add_f32 v9, v9, v53
    v_exp_f32 v55, v191
    s_waitcnt lgkmcnt(7)
    v_mfma_f32_32x32x16_bf16 v[160:175], v[88:91], v[152:155], v[160:175]
    ds_read_b128 v[88:91], v41 offset:12288
    v_cvt_pk_bf16_f32 v110, v52, v53
    v_add_f32 v9, v9, v54
    s_waitcnt lgkmcnt(7)
    v_mfma_f32_32x32x16_bf16 v[160:175], v[92:95], v[156:159], v[160:175]
    ds_read_b128 v[92:95], v41 offset:14336
    v_add_f32 v9, v9, v55
    v_cvt_pk_bf16_f32 v111, v54, v55
    v_xor_b32 v40, 0x10000, v40
    v_xor_b32 v41, 0x10000, v41
    s_lshl_b32 s48, s55, 6
    s_sub_i32 s48, s39, s48
    s_cmp_lt_i32 s48, 31
    s_cbranch_scc1 L_k2_m0_mask
L_k2_m0_nomask:
    v_cmp_nge_f32 vcc, s57, v9
    s_cbranch_vccnz L_k2_b_rare
L_k2_b_go:
    v_add_f32 v44, v44, v9
    s_waitcnt lgkmcnt(7)
    v_mfma_f32_32x32x16_bf16 v[192:207], v[64:67], v[104:107], v[192:207]
    s_add_u32 s50, s38, s59
    s_add_u32 s50, s50, 2
    s_lshl_b32 s49, s50, 1
    s_sub_u32 s49, s49, s37
    s_add_u32 s49, s49, s36
    s_cmp_lt_u32 s50, s37
    s_cselect_b32 s50, s50, s49
    s_lshl_b32 s50, s50, 14
    s_add_u32 s50, s50, s40
    s_add_u32 s51, s38, 2
    s_lshl_b32 s49, s51, 1
    s_sub_u32 s49, s49, s37
    s_add_u32 s49, s49, s36
    s_cmp_lt_u32 s51, s37
    s_cselect_b32 s51, s51, s49
    s_mov_b32 s43, s51
    s_lshl_b32 s51, s51, 14
    s_add_u32 s51, s51, s41
    s_cmp_lt_i32 s38, 15
    s_cselect_b32 s26, 268435456, 0
    s_waitcnt lgkmcnt(6)
    v_mfma_f32_32x32x16_bf16 v[208:223], v[68:71], v[104:107], v[208:223]
    s_waitcnt lgkmcnt(0)
    s_cmp_lt_i32 s38, 16
    s_cbranch_scc1 L_k2_loop
    v_mfma_f32_32x32x16_bf16 v[224:239], v[72:75], v[104:107], v[224:239]
    v_mfma_f32_32x32x16_bf16 v[240:255], v[76:79], v[104:107], v[240:255]
    v_mfma_f32_32x32x16_bf16 v[192:207], v[80:83], v[108:111], v[192:207]
    v_mfma_f32_32x32x16_bf16 v[208:223], v[84:87], v[108:111], v[208:223]
    v_mfma_f32_32x32x16_bf16 v[224:239], v[88:91], v[108:111], v[224:239]
    v_mfma_f32_32x32x16_bf16 v[240:255], v[92:95], v[108:111], v[240:255]
    v_mov_b32 v12, v112
    v_mov_b32 v10, v44
    v_mov_b32 v11, v44
    s_nop 1
    v_permlane32_swap_b32 v10, v11
    s_nop 1
    v_add_f32 v13, v10, v11
    s_barrier
    s_and_b32 s48, s42, 0x10000
    s_and_b32 s49, s45, 0x18000
    s_lshl_b32 s50, s35, 13
    s_add_u32 s48, s48, s50
    s_add_u32 s49, s49, s50
    s_cmp_eq_u32 s36, 1
    s_cselect_b32 s50, s48, s49
    s_cselect_b32 s49, s49, s48
    v_add_u32 v3, s49, v27
    v_add_u32 v4, s50, v27
    s_lshl_b32 s49, s32, 9
    s_add_u32 s49, s49, 131072
    s_xor_b32 s50, s49, 2048
    v_lshlrev_b32 v5, 3, v2
    v_add_u32 v6, s50, v5
    v_add_u32 v5, s49, v5
    ds_write_b64 v5, v[12:13]
    s_cmp_eq_u32 s36, 1
    s_cbranch_scc1 L_k2_m1
    ds_write_b128 v3, v[224:227] offset:0
    ds_write_b128 v3, v[228:231] offset:1024
    ds_write_b128 v3, v[232:235] offset:2048
    ds_write_b128 v3, v[236:239] offset:3072
    ds_write_b128 v3, v[240:243] offset:4096
    ds_write_b128 v3, v[244:247] offset:5120
    ds_write_b128 v3, v[248:251] offset:6144
    ds_write_b128 v3, v[252:255] offset:7168
    s_branch L_k2_m2
L_k2_m1:
    ds_write_b128 v3, v[192:195] offset:0
    ds_write_b128 v3, v[196:199] offset:1024
    ds_write_b128 v3, v[200:203] offset:2048
    ds_write_b128 v3, v[204:207] offset:3072
    ds_write_b128 v3, v[208:211] offset:4096
    ds_write_b128 v3, v[212:215] offset:5120
    ds_write_b128 v3, v[216:219] offset:6144
    ds_write_b128 v3, v[220:223] offset:7168
    v_mov_b32 v192, v224
    v_mov_b32 v193, v225
    v_mov_b32 v194, v226
    v_mov_b32 v195, v227
    v_mov_b32 v196, v228
    v_mov_b32 v197, v229
    v_mov_b32 v198, v230
    v_mov_b32 v199, v231
    v_mov_b32 v200, v232
    v_mov_b32 v201, v233
    v_mov_b32 v202, v234
    v_mov_b32 v203, v235
    v_mov_b32 v204, v236
    v_mov_b32 v205, v237
    v_mov_b32 v206, v238
    v_mov_b32 v207, v239
    v_mov_b32 v208, v240
    v_mov_b32 v209, v241
    v_mov_b32 v210, v242
    v_mov_b32 v211, v243
    v_mov_b32 v212, v244
    v_mov_b32 v213, v245
    v_mov_b32 v214, v246
    v_mov_b32 v215, v247
    v_mov_b32 v216, v248
    v_mov_b32 v217, v249
    v_mov_b32 v218, v250
    v_mov_b32 v219, v251
    v_mov_b32 v220, v252
    v_mov_b32 v221, v253
    v_mov_b32 v222, v254
    v_mov_b32 v223, v255
L_k2_m2:
    s_waitcnt lgkmcnt(0)
    s_barrier
    ds_read_b64 v[14:15], v6
    ds_read_b128 v[224:227], v4 offset:0
    ds_read_b128 v[228:231], v4 offset:1024
    ds_read_b128 v[232:235], v4 offset:2048
    ds_read_b128 v[236:239], v4 offset:3072
    ds_read_b128 v[240:243], v4 offset:4096
    ds_read_b128 v[244:247], v4 offset:5120
    ds_read_b128 v[248:251], v4 offset:6144
    ds_read_b128 v[252:255], v4 offset:7168
    s_waitcnt lgkmcnt(8)
    v_min_f32 v16, v12, v14
    v_sub_f32 v17, v16, v12
    v_sub_f32 v18, v16, v14
    v_exp_f32 v17, v17
    v_exp_f32 v18, v18
    s_nop 0
    v_mul_f32 v19, v13, v17
    v_fmac_f32 v19, v15, v18
    v_rcp_f32 v19, v19
    s_nop 0
    v_mul_f32 v17, v17, v19
    v_mul_f32 v18, v18, v19
    s_waitcnt lgkmcnt(0)
    v_mul_f32 v192, v192, v17
    v_fmac_f32 v192, v224, v18
    v_mul_f32 v193, v193, v17
    v_fmac_f32 v193, v225, v18
    v_mul_f32 v194, v194, v17
    v_fmac_f32 v194, v226, v18
    v_mul_f32 v195, v195, v17
    v_fmac_f32 v195, v227, v18
    v_mul_f32 v196, v196, v17
    v_fmac_f32 v196, v228, v18
    v_mul_f32 v197, v197, v17
    v_fmac_f32 v197, v229, v18
    v_mul_f32 v198, v198, v17
    v_fmac_f32 v198, v230, v18
    v_mul_f32 v199, v199, v17
    v_fmac_f32 v199, v231, v18
    v_mul_f32 v200, v200, v17
    v_fmac_f32 v200, v232, v18
    v_mul_f32 v201, v201, v17
    v_fmac_f32 v201, v233, v18
    v_mul_f32 v202, v202, v17
    v_fmac_f32 v202, v234, v18
    v_mul_f32 v203, v203, v17
    v_fmac_f32 v203, v235, v18
    v_mul_f32 v204, v204, v17
    v_fmac_f32 v204, v236, v18
    v_mul_f32 v205, v205, v17
    v_fmac_f32 v205, v237, v18
    v_mul_f32 v206, v206, v17
    v_fmac_f32 v206, v238, v18
    v_mul_f32 v207, v207, v17
    v_fmac_f32 v207, v239, v18
    v_mul_f32 v208, v208, v17
    v_fmac_f32 v208, v240, v18
    v_mul_f32 v209, v209, v17
    v_fmac_f32 v209, v241, v18
    v_mul_f32 v210, v210, v17
    v_fmac_f32 v210, v242, v18
    v_mul_f32 v211, v211, v17
    v_fmac_f32 v211, v243, v18
    v_mul_f32 v212, v212, v17
    v_fmac_f32 v212, v244, v18
    v_mul_f32 v213, v213, v17
    v_fmac_f32 v213, v245, v18
    v_mul_f32 v214, v214, v17
    v_fmac_f32 v214, v246, v18
    v_mul_f32 v215, v215, v17
    v_fmac_f32 v215, v247, v18
    v_mul_f32 v216, v216, v17
    v_fmac_f32 v216, v248, v18
    v_mul_f32 v217, v217, v17
    v_fmac_f32 v217, v249, v18
    v_mul_f32 v218, v218, v17
    v_fmac_f32 v218, v250, v18
    v_mul_f32 v219, v219, v17
    v_fmac_f32 v219, v251, v18
    v_mul_f32 v220, v220, v17
    v_fmac_f32 v220, v252, v18
    v_mul_f32 v221, v221, v17
    v_fmac_f32 v221, v253, v18
    v_mul_f32 v222, v222, v17
    v_fmac_f32 v222, v254, v18
    v_mul_f32 v223, v223, v17
    v_fmac_f32 v223, v255, v18
    v_cvt_pk_bf16_f32 v160, v192, v193
    v_cvt_pk_bf16_f32 v161, v194, v195
    v_cvt_pk_bf16_f32 v162, v196, v197
    v_cvt_pk_bf16_f32 v163, v198, v199
    v_cvt_pk_bf16_f32 v164, v200, v201
    v_cvt_pk_bf16_f32 v165, v202, v203
    v_cvt_pk_bf16_f32 v166, v204, v205
    v_cvt_pk_bf16_f32 v167, v206, v207
    v_cvt_pk_bf16_f32 v168, v208, v209
    v_cvt_pk_bf16_f32 v169, v210, v211
    v_cvt_pk_bf16_f32 v170, v212, v213
    v_cvt_pk_bf16_f32 v171, v214, v215
    v_cvt_pk_bf16_f32 v172, v216, v217
    v_cvt_pk_bf16_f32 v173, v218, v219
    v_cvt_pk_bf16_f32 v174, v220, v221
    v_cvt_pk_bf16_f32 v175, v222, v223
    s_lshl_b32 s48, s33, 14
    s_add_u32 s48, s48, s56
    s_lshl_b32 s48, s48, 5
    s_add_u32 s48, s48, 37748736
    v_and_b32 v3, 31, v2
    v_lshrrev_b32 v4, 5, v2
    v_lshlrev_b32 v3, 5, v3
    v_lshl_add_u32 v3, v4, 4, v3
    s_lshl_b32 s49, s36, 18
    s_add_u32 s48, s48, s49
    buffer_store_dwordx4 v[160:163], v3, s[20:23], s48 offen sc1
    s_add_u32 s48, s48, 65536
    buffer_store_dwordx4 v[164:167], v3, s[20:23], s48 offen sc1
    s_add_u32 s48, s48, 65536
    buffer_store_dwordx4 v[168:171], v3, s[20:23], s48 offen sc1
    s_add_u32 s48, s48, 65536
    buffer_store_dwordx4 v[172:175], v3, s[20:23], s48 offen sc1
    s_add_u32 s48, s48, 65536
L_k2_fin:
    s_waitcnt vmcnt(0)
    s_barrier
    s_cmp_lg_u32 s32, 0
    s_cbranch_scc1 L_ws_k2out
    s_lshl_b32 s96, s2, 7
    s_add_u32 s96, s96, 125960192
    v_mov_b32 v16, 1
    v_mov_b32 v17, 0
    s_mov_b64 exec, 1
    buffer_store_dword v16, v17, s[28:31], s96 offen sc1
    s_mov_b64 exec, -1
L_ws_k2out:
    s_load_dwordx2 s[8:9], s[0:1], 40
    s_load_dwordx2 s[12:13], s[0:1], 96
    s_load_dwordx2 s[90:91], s[0:1], 88
    s_load_dwordx2 s[4:5], s[0:1], 0
    v_lshrrev_b32 v1, 6, v0
    v_and_b32 v2, 63, v0
    s_nop 0
    v_readfirstlane_b32 s32, v1
    s_and_b32 s48, s2, 7
    s_lshr_b32 s49, s2, 3
    s_lshr_b32 s33, s48, 1
    s_lshr_b32 s50, s49, 2
    s_sub_u32 s34, 15, s50
    s_bitcmp1_b32 s48, 0
    s_cselect_b32 s34, s34, s50
    s_and_b32 s35, s49, 3
    s_and_b32 s36, s32, 3
    s_lshr_b32 s37, s32, 2
    s_waitcnt lgkmcnt(0)
    s_mov_b32 s20, s8
    s_and_b32 s21, s9, 0xffff
    s_mov_b32 s22, 4718592
    s_mov_b32 s23, 0x00020000
    s_mov_b32 s47, 4718592
    s_mov_b32 s16, s12
    s_and_b32 s17, s13, 0xffff
    s_mov_b32 s18, 268435456
    s_mov_b32 s19, 0x00020000
    s_mov_b32 s46, 268435456
    s_mov_b32 s28, s12
    s_and_b32 s29, s13, 0xffff
    s_mov_b32 s30, 268435456
    s_mov_b32 s31, 0x00020000
    s_mov_b32 s92, s90
    s_and_b32 s93, s91, 0xffff
    s_mov_b32 s94, 256
    s_mov_b32 s95, 0x00020000
    s_lshr_b32 s48, s32, 1
    s_lshl_b32 s48, s48, 16
    s_and_b32 s49, s32, 1
    s_lshl_b32 s49, s49, 11
    s_add_u32 s48, s48, s49
    v_lshlrev_b32 v20, 4, v2
    v_add_u32 v64, s48, v20
    s_mul_i32 s38, s33, 4194304
    s_lshl_b32 s48, s34, 12
    s_add_u32 s38, s38, s48
    s_add_u32 s38, s38, 37748736
    v_add_u32 v20, 0, v2
    v_mul_u32_u24 v21, 3641, v20
    v_lshrrev_b32 v21, 16, v21
    v_mul_u32_u24 v23, 18, v21
    v_sub_u32 v22, v20, v23
    v_and_b32 v23, 1, v22
    v_bfe_u32 v24, v22, 1, 1
    v_lshl_or_b32 v23, v23, 1, v24
    v_and_b32 v24, 28, v22
    v_or_b32 v23, v23, v24
    v_cmp_gt_u32 vcc, 16, v22
    s_nop 1
    v_cndmask_b32 v22, v22, v23, vcc
    s_lshl_b32 s48, s32, 3
    v_add_u32 v21, s48, v21
    v_mul_u32_u24 v21, 1152, v21
    v_lshl_add_u32 v66, v22, 4, v21
    v_add_u32 v20, 64, v2
    v_mul_u32_u24 v21, 3641, v20
    v_lshrrev_b32 v21, 16, v21
    v_mul_u32_u24 v23, 18, v21
    v_sub_u32 v22, v20, v23
    v_and_b32 v23, 1, v22
    v_bfe_u32 v24, v22, 1, 1
    v_lshl_or_b32 v23, v23, 1, v24
    v_and_b32 v24, 28, v22
    v_or_b32 v23, v23, v24
    v_cmp_gt_u32 vcc, 16, v22
    s_nop 1
    v_cndmask_b32 v22, v22, v23, vcc
    s_lshl_b32 s48, s32, 3
    v_add_u32 v21, s48, v21
    v_mul_u32_u24 v21, 1152, v21
    v_lshl_add_u32 v67, v22, 4, v21
    v_add_u32 v20, 128, v2
    v_mul_u32_u24 v21, 3641, v20
    v_lshrrev_b32 v21, 16, v21
    v_mul_u32_u24 v23, 18, v21
    v_sub_u32 v22, v20, v23
    v_and_b32 v23, 1, v22
    v_bfe_u32 v24, v22, 1, 1
    v_lshl_or_b32 v23, v23, 1, v24
    v_and_b32 v24, 28, v22
    v_or_b32 v23, v23, v24
    v_cmp_gt_u32 vcc, 16, v22
    s_nop 1
    v_cndmask_b32 v22, v22, v23, vcc
    s_lshl_b32 s48, s32, 3
    v_add_u32 v21, s48, v21
    v_mul_u32_u24 v21, 1152, v21
    v_lshl_add_u32 v68, v22, 4, v21
    s_mul_i32 s39, s33, 1179648
    s_mul_i32 s48, s35, 288
    s_add_u32 s39, s39, s48
    s_lshl_b32 s40, s32, 11
    s_mul_i32 s41, s32, 2304
    s_add_u32 s41, s41, 65536
    v_and_b32 v62, 15, v2
    v_lshrrev_b32 v61, 4, v2
    v_lshrrev_b32 v20, 1, v61
    s_lshl_b32 s48, s37, 1
    v_add_u32 v20, s48, v20
    v_lshlrev_b32 v20, 12, v20
    s_lshl_b32 s48, s36, 5
    v_add_u32 v21, s48, v62
    v_lshl_add_u32 v20, v21, 5, v20
    v_and_b32 v21, 1, v61
    v_lshl_add_u32 v70, v21, 4, v20
    v_lshrrev_b32 v20, 5, v2
    v_lshlrev_b32 v20, 4, v20
    v_bfe_u32 v21, v2, 2, 3
    v_add_u32 v20, v20, v21
    s_lshl_b32 s48, s37, 5
    v_add_u32 v20, s48, v20
    v_mul_u32_u24 v20, 288, v20
    v_add_u32 v20, 65536, v20
    v_and_b32 v21, 3, v2
    v_lshl_add_u32 v71, v21, 3, v20
    v_and_b32 v22, 1, v2
    v_lshl_add_u32 v20, v22, 4, v20
    v_bfe_u32 v22, v2, 1, 1
    v_lshl_add_u32 v69, v22, 3, v20
    s_mov_b32 s44, 0
    s_mov_b32 s53, 0
    s_mov_b32 s57, 0
    s_add_u32 m0, s53, s41
    s_nop 0
    buffer_load_dwordx4 v66, s[20:23], s39 offen lds
    s_add_u32 m0, m0, 1024
    s_nop 0
    buffer_load_dwordx4 v67, s[20:23], s39 offen lds
    s_add_u32 m0, m0, 1024
    s_mov_b64 exec, 0xffff
    buffer_load_dwordx4 v68, s[20:23], s39 offen lds
    s_mov_b64 exec, -1
    s_add_u32 s39, s39, 73728
    s_add_u32 s53, s53, 18432
    s_cmp_eq_u32 s53, 73728
    s_cselect_b32 s53, 0, s53
    s_add_u32 m0, s53, s41
    s_nop 0
    buffer_load_dwordx4 v66, s[20:23], s39 offen lds
    s_add_u32 m0, m0, 1024
    s_nop 0
    buffer_load_dwordx4 v67, s[20:23], s39 offen lds
    s_add_u32 m0, m0, 1024
    s_mov_b64 exec, 0xffff
    buffer_load_dwordx4 v68, s[20:23], s39 offen lds
    s_mov_b64 exec, -1
    s_add_u32 s39, s39, 73728
    s_add_u32 s53, s53, 18432
    s_cmp_eq_u32 s53, 73728
    s_cselect_b32 s53, 0, s53
    s_add_u32 m0, s53, s41
    s_nop 0
    buffer_load_dwordx4 v66, s[20:23], s39 offen lds
    s_add_u32 m0, m0, 1024
    s_nop 0
    buffer_load_dwordx4 v67, s[20:23], s39 offen lds
    s_add_u32 m0, m0, 1024
    s_mov_b64 exec, 0xffff
    buffer_load_dwordx4 v68, s[20:23], s39 offen lds
    s_mov_b64 exec, -1
    s_add_u32 s39, s39, 73728
    s_add_u32 s53, s53, 18432
    s_cmp_eq_u32 s53, 73728
    s_cselect_b32 s53, 0, s53
    s_cmp_lg_u32 s32, 0
    s_cbranch_scc1 L_ww_k34c_in_done
    v_and_b32 v16, 63, v0
    v_and_b32 v19, 3, v16
    v_lshrrev_b32 v17, 2, v16
    v_lshl_add_u32 v17, v19, 3, v17
    s_andn2_b32 s48, s2, 31
    s_lshl_b32 s49, s33, 1
    s_add_u32 s48, s48, s49
    v_add_u32 v17, s48, v17
    v_lshlrev_b32 v17, 7, v17
    s_mov_b32 s97, 125960192
    s_mov_b32 s96, 0x100000
    s_mov_b64 exec, 255
L_ww_k34c_in_loop:
    buffer_load_dword v18, v17, s[28:31], s97 offen sc1
    s_waitcnt vmcnt(0)
    v_cmp_ne_u32 vcc, 1, v18
    s_nop 1
    s_cbranch_vccz L_ww_k34c_in_ok
    s_sleep 2
    s_sub_u32 s96, s96, 1
    s_cmp_lg_u32 s96, 0
    s_cbranch_scc1 L_ww_k34c_in_loop
L_ww_k34c_in_ok:
    s_mov_b64 exec, -1
L_ww_k34c_in_done:
    s_barrier
    s_add_u32 m0, s57, s40
    s_nop 0
    buffer_load_dwordx4 v64, s[16:19], s38 offen lds
    buffer_load_dwordx4 v64, s[16:19], s38 offen offset:1024 lds
    s_add_u32 s38, s38, 262144
    s_add_u32 s44, s44, 1
    s_cmp_lt_u32 s44, 16
    s_cselect_b32 s18, s46, 0
    s_cselect_b32 s22, s47, 0
    s_add_u32 s57, s57, 16384
    s_cmp_eq_u32 s57, 65536
    s_cselect_b32 s57, 0, s57
    s_add_u32 m0, s57, s40
    s_nop 0
    buffer_load_dwordx4 v64, s[16:19], s38 offen lds
    buffer_load_dwordx4 v64, s[16:19], s38 offen offset:1024 lds
    s_add_u32 s38, s38, 262144
    s_add_u32 s44, s44, 1
    s_cmp_lt_u32 s44, 16
    s_cselect_b32 s18, s46, 0
    s_cselect_b32 s22, s47, 0
    s_add_u32 s57, s57, 16384
    s_cmp_eq_u32 s57, 65536
    s_cselect_b32 s57, 0, s57
    s_add_u32 m0, s57, s40
    s_nop 0
    buffer_load_dwordx4 v64, s[16:19], s38 offen lds
    buffer_load_dwordx4 v64, s[16:19], s38 offen offset:1024 lds
    s_add_u32 s38, s38, 262144
    s_add_u32 s44, s44, 1
    s_cmp_lt_u32 s44, 16
    s_cselect_b32 s18, s46, 0
    s_cselect_b32 s22, s47, 0
    s_add_u32 s57, s57, 16384
    s_cmp_eq_u32 s57, 65536
    s_cselect_b32 s57, 0, s57
    v_mov_b32 v128, 0
    v_mov_b32 v129, 0
    v_mov_b32 v130, 0
    v_mov_b32 v131, 0
    v_mov_b32 v132, 0
    v_mov_b32 v133, 0
    v_mov_b32 v134, 0
    v_mov_b32 v135, 0
    v_mov_b32 v136, 0
    v_mov_b32 v137, 0
    v_mov_b32 v138, 0
    v_mov_b32 v139, 0
    v_mov_b32 v140, 0
    v_mov_b32 v141, 0
    v_mov_b32 v142, 0
    v_mov_b32 v143, 0
    v_mov_b32 v144, 0
    v_mov_b32 v145, 0
    v_mov_b32 v146, 0
    v_mov_b32 v147, 0
    v_mov_b32 v148, 0
    v_mov_b32 v149, 0
    v_mov_b32 v150, 0
    v_mov_b32 v151, 0
    v_mov_b32 v152, 0
    v_mov_b32 v153, 0
    v_mov_b32 v154, 0
    v_mov_b32 v155, 0
    v_mov_b32 v156, 0
    v_mov_b32 v157, 0
    v_mov_b32 v158, 0
    v_mov_b32 v159, 0
    v_mov_b32 v160, 0
    v_mov_b32 v161, 0
    v_mov_b32 v162, 0
    v_mov_b32 v163, 0
    v_mov_b32 v164, 0
    v_mov_b32 v165, 0
    v_mov_b32 v166, 0
    v_mov_b32 v167, 0
    v_mov_b32 v168, 0
    v_mov_b32 v169, 0
    v_mov_b32 v170, 0
    v_mov_b32 v171, 0
    v_mov_b32 v172, 0
    v_mov_b32 v173, 0
    v_mov_b32 v174, 0
    v_mov_b32 v175, 0
    v_mov_b32 v176, 0
    v_mov_b32 v177, 0
    v_mov_b32 v178, 0
    v_mov_b32 v179, 0
    v_mov_b32 v180, 0
    v_mov_b32 v181, 0
    v_mov_b32 v182, 0
    v_mov_b32 v183, 0
    v_mov_b32 v184, 0
    v_mov_b32 v185, 0
    v_mov_b32 v186, 0
    v_mov_b32 v187, 0
    v_mov_b32 v188, 0
    v_mov_b32 v189, 0
    v_mov_b32 v190, 0
    v_mov_b32 v191, 0
    v_mov_b32 v192, 0
    v_mov_b32 v193, 0
    v_mov_b32 v194, 0
    v_mov_b32 v195, 0
    v_mov_b32 v196, 0
    v_mov_b32 v197, 0
    v_mov_b32 v198, 0
    v_mov_b32 v199, 0
    s_mov_b32 s51, 18432
    s_mov_b32 s54, 18432
    s_mov_b32 s52, 0
    s_mov_b32 s55, 16384
    s_mov_b32 s58, 16384
    s_mov_b32 s56, 0
    s_waitcnt vmcnt(2)
    s_barrier
    ds_read_b128 v[112:115], v70 offset:0
    ds_read_b128 v[116:119], v70 offset:512
    v_add_u32 v70, s55, v70
    ds_read_b64_tr_b16 v[200:201], v71 offset:0
    ds_read_b64_tr_b16 v[202:203], v71 offset:2304
    ds_read_b64_tr_b16 v[204:205], v71 offset:32
    ds_read_b64_tr_b16 v[206:207], v71 offset:2336
    ds_read_b64_tr_b16 v[208:209], v71 offset:64
    ds_read_b64_tr_b16 v[210:211], v71 offset:2368
    ds_read_b64_tr_b16 v[212:213], v71 offset:96
    ds_read_b64_tr_b16 v[214:215], v71 offset:2400
    ds_read_b64_tr_b16 v[216:217], v71 offset:128
    ds_read_b64_tr_b16 v[218:219], v71 offset:2432
    s_mov_b32 s45, 8
L_k34c_loop:
    s_waitcnt vmcnt(5)
    s_barrier
    s_mov_b32 s50, s51
    s_add_u32 s52, s52, 1
    s_cmp_eq_u32 s52, 4
    s_cselect_b32 s52, 0, s52
    s_cmp_eq_u32 s52, 3
    s_cselect_b32 s51, 4294912000, s54
    s_add_u32 s56, s56, 1
    s_cmp_eq_u32 s56, 4
    s_cselect_b32 s56, 0, s56
    s_cmp_eq_u32 s56, 3
    s_cselect_b32 s55, 4294918144, s58
    ds_read_b64_tr_b16 v[220:221], v71 offset:160
    ds_read_b64_tr_b16 v[222:223], v71 offset:2464
    ds_read_b128 v[120:123], v70 offset:0
    s_waitcnt lgkmcnt(11)
    v_mfma_f32_16x16x32_bf16 v[128:131], v[200:203], v[112:115], v[128:131]
    s_add_u32 m0, s53, s41
    s_nop 0
    buffer_load_dwordx4 v66, s[20:23], s39 offen lds
    v_mfma_f32_16x16x32_bf16 v[132:135], v[200:203], v[116:119], v[132:135]
    ds_read_b64_tr_b16 v[200:201], v71 offset:192
    ds_read_b64_tr_b16 v[202:203], v71 offset:2496
    ds_read_b128 v[124:127], v70 offset:512
    v_add_u32 v70, s55, v70
    s_waitcnt lgkmcnt(12)
    v_mfma_f32_16x16x32_bf16 v[136:139], v[204:207], v[112:115], v[136:139]
    s_add_u32 m0, m0, 1024
    s_nop 0
    buffer_load_dwordx4 v67, s[20:23], s39 offen lds
    v_mfma_f32_16x16x32_bf16 v[140:143], v[204:207], v[116:119], v[140:143]
    ds_read_b64_tr_b16 v[204:205], v71 offset:224
    ds_read_b64_tr_b16 v[206:207], v71 offset:2528
    v_add_u32 v71, s50, v71
    s_waitcnt lgkmcnt(12)
    v_mfma_f32_16x16x32_bf16 v[144:147], v[208:211], v[112:115], v[144:147]
    v_mfma_f32_16x16x32_bf16 v[148:151], v[208:211], v[116:119], v[148:151]
    s_add_u32 m0, m0, 1024
    s_mov_b64 exec, 0xffff
    buffer_load_dwordx4 v68, s[20:23], s39 offen lds
    s_mov_b64 exec, -1
    s_add_u32 s39, s39, 73728
    s_add_u32 s53, s53, 18432
    s_cmp_eq_u32 s53, 73728
    s_cselect_b32 s53, 0, s53
    ds_read_b64_tr_b16 v[208:209], v69 offset:256
    ds_read_b64_tr_b16 v[210:211], v69 offset:2560
    v_add_u32 v69, s50, v69
    s_waitcnt lgkmcnt(12)
    v_mfma_f32_16x16x32_bf16 v[152:155], v[212:215], v[112:115], v[152:155]
    v_mfma_f32_16x16x32_bf16 v[156:159], v[212:215], v[116:119], v[156:159]
    ds_read_b64_tr_b16 v[212:213], v71 offset:0
    ds_read_b64_tr_b16 v[214:215], v71 offset:2304
    s_waitcnt lgkmcnt(12)
    v_mfma_f32_16x16x32_bf16 v[160:163], v[216:219], v[112:115], v[160:163]
    s_add_u32 m0, s57, s40
    s_nop 0
    buffer_load_dwordx4 v64, s[16:19], s38 offen lds
    v_mfma_f32_16x16x32_bf16 v[164:167], v[216:219], v[116:119], v[164:167]
    ds_read_b64_tr_b16 v[216:217], v71 offset:32
    ds_read_b64_tr_b16 v[218:219], v71 offset:2336
    s_waitcnt lgkmcnt(12)
    v_mfma_f32_16x16x32_bf16 v[168:171], v[220:223], v[112:115], v[168:171]
    v_mfma_f32_16x16x32_bf16 v[172:175], v[220:223], v[116:119], v[172:175]
    buffer_load_dwordx4 v64, s[16:19], s38 offen offset:1024 lds
    s_add_u32 s38, s38, 262144
    s_add_u32 s44, s44, 1
    s_cmp_lt_u32 s44, 16
    s_cselect_b32 s18, s46, 0
    s_cselect_b32 s22, s47, 0
    s_add_u32 s57, s57, 16384
    s_cmp_eq_u32 s57, 65536
    s_cselect_b32 s57, 0, s57
    ds_read_b64_tr_b16 v[220:221], v71 offset:64
    ds_read_b64_tr_b16 v[222:223], v71 offset:2368
    s_waitcnt lgkmcnt(11)
    v_mfma_f32_16x16x32_bf16 v[176:179], v[200:203], v[112:115], v[176:179]
    v_mfma_f32_16x16x32_bf16 v[180:183], v[200:203], v[116:119], v[180:183]
    ds_read_b64_tr_b16 v[200:201], v71 offset:96
    ds_read_b64_tr_b16 v[202:203], v71 offset:2400
    s_waitcnt lgkmcnt(10)
    v_mfma_f32_16x16x32_bf16 v[184:187], v[204:207], v[112:115], v[184:187]
    v_mfma_f32_16x16x32_bf16 v[188:191], v[204:207], v[116:119], v[188:191]
    ds_read_b64_tr_b16 v[204:205], v71 offset:128
    ds_read_b64_tr_b16 v[206:207], v71 offset:2432
    s_waitcnt lgkmcnt(10)
    v_mfma_f32_16x16x32_bf16 v[192:195], v[208:211], v[112:115], v[192:195]
    v_mfma_f32_16x16x32_bf16 v[196:199], v[208:211], v[116:119], v[196:199]
    s_waitcnt vmcnt(5)
    s_barrier
    s_mov_b32 s50, s51
    s_add_u32 s52, s52, 1
    s_cmp_eq_u32 s52, 4
    s_cselect_b32 s52, 0, s52
    s_cmp_eq_u32 s52, 3
    s_cselect_b32 s51, 4294912000, s54
    s_add_u32 s56, s56, 1
    s_cmp_eq_u32 s56, 4
    s_cselect_b32 s56, 0, s56
    s_cmp_eq_u32 s56, 3
    s_cselect_b32 s55, 4294918144, s58
    ds_read_b64_tr_b16 v[208:209], v71 offset:160
    ds_read_b64_tr_b16 v[210:211], v71 offset:2464
    ds_read_b128 v[112:115], v70 offset:0
    s_waitcnt lgkmcnt(11)
    v_mfma_f32_16x16x32_bf16 v[128:131], v[212:215], v[120:123], v[128:131]
    s_add_u32 m0, s53, s41
    s_nop 0
    buffer_load_dwordx4 v66, s[20:23], s39 offen lds
    v_mfma_f32_16x16x32_bf16 v[132:135], v[212:215], v[124:127], v[132:135]
    ds_read_b64_tr_b16 v[212:213], v71 offset:192
    ds_read_b64_tr_b16 v[214:215], v71 offset:2496
    ds_read_b128 v[116:119], v70 offset:512
    v_add_u32 v70, s55, v70
    s_waitcnt lgkmcnt(12)
    v_mfma_f32_16x16x32_bf16 v[136:139], v[216:219], v[120:123], v[136:139]
    s_add_u32 m0, m0, 1024
    s_nop 0
    buffer_load_dwordx4 v67, s[20:23], s39 offen lds
    v_mfma_f32_16x16x32_bf16 v[140:143], v[216:219], v[124:127], v[140:143]
    ds_read_b64_tr_b16 v[216:217], v71 offset:224
    ds_read_b64_tr_b16 v[218:219], v71 offset:2528
    v_add_u32 v71, s50, v71
    s_waitcnt lgkmcnt(12)
    v_mfma_f32_16x16x32_bf16 v[144:147], v[220:223], v[120:123], v[144:147]
    v_mfma_f32_16x16x32_bf16 v[148:151], v[220:223], v[124:127], v[148:151]
    s_add_u32 m0, m0, 1024
    s_mov_b64 exec, 0xffff
    buffer_load_dwordx4 v68, s[20:23], s39 offen lds
    s_mov_b64 exec, -1
    s_add_u32 s39, s39, 73728
    s_add_u32 s53, s53, 18432
    s_cmp_eq_u32 s53, 73728
    s_cselect_b32 s53, 0, s53
    ds_read_b64_tr_b16 v[220:221], v69 offset:256
    ds_read_b64_tr_b16 v[222:223], v69 offset:2560
    v_add_u32 v69, s50, v69
    s_waitcnt lgkmcnt(12)
    v_mfma_f32_16x16x32_bf16 v[152:155], v[200:203], v[120:123], v[152:155]
    v_mfma_f32_16x16x32_bf16 v[156:159], v[200:203], v[124:127], v[156:159]
    ds_read_b64_tr_b16 v[200:201], v71 offset:0
    ds_read_b64_tr_b16 v[202:203], v71 offset:2304
    s_waitcnt lgkmcnt(12)
    v_mfma_f32_16x16x32_bf16 v[160:163], v[204:207], v[120:123], v[160:163]
    s_add_u32 m0, s57, s40
    s_nop 0
    buffer_load_dwordx4 v64, s[16:19], s38 offen lds
    v_mfma_f32_16x16x32_bf16 v[164:167], v[204:207], v[124:127], v[164:167]
    ds_read_b64_tr_b16 v[204:205], v71 offset:32
    ds_read_b64_tr_b16 v[206:207], v71 offset:2336
    s_waitcnt lgkmcnt(12)
    v_mfma_f32_16x16x32_bf16 v[168:171], v[208:211], v[120:123], v[168:171]
    v_mfma_f32_16x16x32_bf16 v[172:175], v[208:211], v[124:127], v[172:175]
    buffer_load_dwordx4 v64, s[16:19], s38 offen offset:1024 lds
    s_add_u32 s38, s38, 262144
    s_add_u32 s44, s44, 1
    s_cmp_lt_u32 s44, 16
    s_cselect_b32 s18, s46, 0
    s_cselect_b32 s22, s47, 0
    s_add_u32 s57, s57, 16384
    s_cmp_eq_u32 s57, 65536
    s_cselect_b32 s57, 0, s57
    ds_read_b64_tr_b16 v[208:209], v71 offset:64
    ds_read_b64_tr_b16 v[210:211], v71 offset:2368
    s_waitcnt lgkmcnt(11)
    v_mfma_f32_16x16x32_bf16 v[176:179], v[212:215], v[120:123], v[176:179]
    v_mfma_f32_16x16x32_bf16 v[180:183], v[212:215], v[124:127], v[180:183]
    ds_read_b64_tr_b16 v[212:213], v71 offset:96
    ds_read_b64_tr_b16 v[214:215], v71 offset:2400
    s_waitcnt lgkmcnt(10)
    v_mfma_f32_16x16x32_bf16 v[184:187], v[216:219], v[120:123], v[184:187]
    v_mfma_f32_16x16x32_bf16 v[188:191], v[216:219], v[124:127], v[188:191]
    ds_read_b64_tr_b16 v[216:217], v71 offset:128
    ds_read_b64_tr_b16 v[218:219], v71 offset:2432
    s_waitcnt lgkmcnt(10)
    v_mfma_f32_16x16x32_bf16 v[192:195], v[220:223], v[120:123], v[192:195]
    v_mfma_f32_16x16x32_bf16 v[196:199], v[220:223], v[124:127], v[196:199]
    s_sub_u32 s45, s45, 1
    s_cmp_lg_u32 s45, 0
    s_cbranch_scc1 L_k34c_loop
    s_waitcnt lgkmcnt(0)
    s_nop 7
    s_nop 7
    s_waitcnt vmcnt(0)
    s_barrier
    s_mul_i32 s48, s32, 9216
    s_xor_b32 s49, s32, 4
    s_mul_i32 s49, s49, 9216
    v_lshlrev_b32 v3, 4, v2
    v_add_u32 v4, s49, v3
    v_add_u32 v3, s48, v3
    s_cmp_eq_u32 s37, 1
    s_cbranch_scc1 L_k34c_e1
    ds_write_b128 v3, v[132:135] offset:0
    ds_write_b128 v3, v[140:143] offset:1024
    ds_write_b128 v3, v[148:151] offset:2048
    ds_write_b128 v3, v[156:159] offset:3072
    ds_write_b128 v3, v[164:167] offset:4096
    ds_write_b128 v3, v[172:175] offset:5120
    ds_write_b128 v3, v[180:183] offset:6144
    ds_write_b128 v3, v[188:191] offset:7168
    ds_write_b128 v3, v[196:199] offset:8192
    s_branch L_k34c_e2
L_k34c_e1:
    ds_write_b128 v3, v[128:131] offset:0
    ds_write_b128 v3, v[136:139] offset:1024
    ds_write_b128 v3, v[144:147] offset:2048
    ds_write_b128 v3, v[152:155] offset:3072
    ds_write_b128 v3, v[160:163] offset:4096
    ds_write_b128 v3, v[168:171] offset:5120
    ds_write_b128 v3, v[176:179] offset:6144
    ds_write_b128 v3, v[184:187] offset:7168
    ds_write_b128 v3, v[192:195] offset:8192
    v_mov_b32 v128, v132
    v_mov_b32 v129, v133
    v_mov_b32 v130, v134
    v_mov_b32 v131, v135
    v_mov_b32 v136, v140
    v_mov_b32 v137, v141
    v_mov_b32 v138, v142
    v_mov_b32 v139, v143
    v_mov_b32 v144, v148
    v_mov_b32 v145, v149
    v_mov_b32 v146, v150
    v_mov_b32 v147, v151
    v_mov_b32 v152, v156
    v_mov_b32 v153, v157
    v_mov_b32 v154, v158
    v_mov_b32 v155, v159
    v_mov_b32 v160, v164
    v_mov_b32 v161, v165
    v_mov_b32 v162, v166
    v_mov_b32 v163, v167
    v_mov_b32 v168, v172
    v_mov_b32 v169, v173
    v_mov_b32 v170, v174
    v_mov_b32 v171, v175
    v_mov_b32 v176, v180
    v_mov_b32 v177, v181
    v_mov_b32 v178, v182
    v_mov_b32 v179, v183
    v_mov_b32 v184, v188
    v_mov_b32 v185, v189
    v_mov_b32 v186, v190
    v_mov_b32 v187, v191
    v_mov_b32 v192, v196
    v_mov_b32 v193, v197
    v_mov_b32 v194, v198
    v_mov_b32 v195, v199
L_k34c_e2:
    s_waitcnt lgkmcnt(0)
    s_barrier
    ds_read_b128 v[132:135], v4 offset:0
    ds_read_b128 v[140:143], v4 offset:1024
    ds_read_b128 v[148:151], v4 offset:2048
    ds_read_b128 v[156:159], v4 offset:3072
    ds_read_b128 v[164:167], v4 offset:4096
    ds_read_b128 v[172:175], v4 offset:5120
    ds_read_b128 v[180:183], v4 offset:6144
    ds_read_b128 v[188:191], v4 offset:7168
    ds_read_b128 v[196:199], v4 offset:8192
    s_mul_i32 s48, s33, 2621440
    s_lshl_b32 s49, s34, 7
    s_lshl_b32 s50, s36, 5
    s_add_u32 s49, s49, s50
    s_lshl_b32 s50, s37, 4
    s_add_u32 s49, s49, s50
    s_mul_i32 s49, s49, 1280
    s_add_u32 s48, s48, s49
    s_mul_i32 s49, s35, 320
    s_add_u32 s48, s48, s49
    s_add_u32 s48, s48, 54525952
    v_mul_u32_u24 v5, 1280, v62
    v_lshl_add_u32 v6, v61, 3, v5
    v_lshl_add_u32 v5, v61, 4, v5
    s_waitcnt lgkmcnt(8)
    v_add_f32 v128, v128, v132
    v_add_f32 v129, v129, v133
    v_add_f32 v130, v130, v134
    v_add_f32 v131, v131, v135
    v_cvt_pk_bf16_f32 v8, v128, v129
    v_cvt_pk_bf16_f32 v9, v130, v131
    s_waitcnt lgkmcnt(7)
    v_add_f32 v136, v136, v140
    v_add_f32 v137, v137, v141
    v_add_f32 v138, v138, v142
    v_add_f32 v139, v139, v143
    v_cvt_pk_bf16_f32 v10, v136, v137
    v_cvt_pk_bf16_f32 v11, v138, v139
    buffer_store_dwordx4 v[8:11], v5, s[28:31], s48 offen offset:0 sc1
    s_waitcnt lgkmcnt(6)
    v_add_f32 v144, v144, v148
    v_add_f32 v145, v145, v149
    v_add_f32 v146, v146, v150
    v_add_f32 v147, v147, v151
    v_cvt_pk_bf16_f32 v12, v144, v145
    v_cvt_pk_bf16_f32 v13, v146, v147
    s_waitcnt lgkmcnt(5)
    v_add_f32 v152, v152, v156
    v_add_f32 v153, v153, v157
    v_add_f32 v154, v154, v158
    v_add_f32 v155, v155, v159
    v_cvt_pk_bf16_f32 v14, v152, v153
    v_cvt_pk_bf16_f32 v15, v154, v155
    buffer_store_dwordx4 v[12:15], v5, s[28:31], s48 offen offset:64 sc1
    s_waitcnt lgkmcnt(4)
    v_add_f32 v160, v160, v164
    v_add_f32 v161, v161, v165
    v_add_f32 v162, v162, v166
    v_add_f32 v163, v163, v167
    v_cvt_pk_bf16_f32 v16, v160, v161
    v_cvt_pk_bf16_f32 v17, v162, v163
    s_waitcnt lgkmcnt(3)
    v_add_f32 v168, v168, v172
    v_add_f32 v169, v169, v173
    v_add_f32 v170, v170, v174
    v_add_f32 v171, v171, v175
    v_cvt_pk_bf16_f32 v18, v168, v169
    v_cvt_pk_bf16_f32 v19, v170, v171
    buffer_store_dwordx4 v[16:19], v5, s[28:31], s48 offen offset:128 sc1
    s_waitcnt lgkmcnt(2)
    v_add_f32 v176, v176, v180
    v_add_f32 v177, v177, v181
    v_add_f32 v178, v178, v182
    v_add_f32 v179, v179, v183
    v_cvt_pk_bf16_f32 v20, v176, v177
    v_cvt_pk_bf16_f32 v21, v178, v179
    s_waitcnt lgkmcnt(1)
    v_add_f32 v184, v184, v188
    v_add_f32 v185, v185, v189
    v_add_f32 v186, v186, v190
    v_add_f32 v187, v187, v191
    v_cvt_pk_bf16_f32 v22, v184, v185
    v_cvt_pk_bf16_f32 v23, v186, v187
    buffer_store_dwordx4 v[20:23], v5, s[28:31], s48 offen offset:192 sc1
    s_waitcnt lgkmcnt(0)
    v_add_f32 v192, v192, v196
    v_add_f32 v193, v193, v197
    v_add_f32 v194, v194, v198
    v_add_f32 v195, v195, v199
    v_cvt_pk_bf16_f32 v24, v192, v193
    v_cvt_pk_bf16_f32 v25, v194, v195
    buffer_store_dwordx2 v[24:25], v6, s[28:31], s48 offen offset:256 sc1
    s_waitcnt vmcnt(0)
    s_barrier
    s_cmp_lg_u32 s32, 0
    s_cbranch_scc1 L_ws_k34c
    s_lshl_b32 s96, s2, 7
    s_add_u32 s96, s96, 125829120
    v_mov_b32 v16, 1
    v_mov_b32 v17, 0
    s_mov_b64 exec, 1
    buffer_store_dword v16, v17, s[28:31], s96 offen sc1
    s_mov_b64 exec, -1
L_ws_k34c:
    s_cmp_lg_u32 s32, 0
    s_cbranch_scc1 L_ww_k34c_done
    v_and_b32 v16, 63, v0
    v_lshrrev_b32 v19, 2, v16
    v_and_b32 v17, 3, v16
    v_lshlrev_b32 v17, 1, v17
    v_lshl_add_u32 v17, v19, 3, v17
    s_andn2_b32 s48, s2, 31
    s_lshr_b32 s49, s34, 3
    s_add_u32 s48, s48, s49
    v_add_u32 v17, s48, v17
    v_lshlrev_b32 v17, 7, v17
    s_mov_b32 s97, 125829120
    s_mov_b32 s96, 0x100000
    s_mov_b64 exec, 65535
L_ww_k34c_loop:
    buffer_load_dword v18, v17, s[28:31], s97 offen sc1
    s_waitcnt vmcnt(0)
    v_cmp_ne_u32 vcc, 1, v18
    s_nop 1
    s_cbranch_vccz L_ww_k34c_ok
    s_sleep 2
    s_sub_u32 s96, s96, 1
    s_cmp_lg_u32 s96, 0
    s_cbranch_scc1 L_ww_k34c_loop
L_ww_k34c_ok:
    s_mov_b64 exec, -1
L_ww_k34c_done:
    s_barrier
    s_lshl_b32 s49, s35, 2
    s_add_u32 s49, s49, s33
    s_lshl_b32 s49, s49, 3
    s_add_u32 s49, s49, s32
    s_lshl_b32 s48, s34, 7
    s_add_u32 s49, s49, s48
    v_lshrrev_b32 v3, 1, v2
    v_lshlrev_b32 v3, 4, v3
    v_and_b32 v4, 1, v2
    v_lshl_add_u32 v3, v4, 2, v3
    v_mul_u32_u24 v6, 3641, v2
    v_lshrrev_b32 v6, 16, v6
    v_mul_u32_u24 v8, 18, v6
    v_sub_u32 v7, v2, v8
    v_mul_u32_u24 v6, 320, v6
    v_lshl_add_u32 v4, v7, 4, v6
    v_add_u32 v8, 64, v2
    v_lshlrev_b32 v9, 4, v2
    v_add_u32 v9, 1120, v9
    v_lshlrev_b32 v5, 1, v3
    s_mul_i32 s50, s49, 1280
    s_add_u32 s50, s50, 54525952
    s_mul_i32 s51, s49, 1152
    s_waitcnt lgkmcnt(0)
    s_mov_b32 s24, s4
    s_and_b32 s25, s5, 0xffff
    s_mov_b32 s26, 2359296
    s_mov_b32 s27, 0x00020000
    s_mov_b32 s28, s12
    s_and_b32 s29, s13, 0xffff
    s_mov_b32 s30, 268435456
    s_mov_b32 s31, 0x00020000
    v_mov_b32 v80, 0
    v_mov_b32 v81, 0
    v_mov_b32 v82, 0
    v_mov_b32 v83, 0
    v_mov_b32 v84, 0
    v_mov_b32 v85, 0
    v_mov_b32 v86, 0
    v_mov_b32 v87, 0
    v_mov_b32 v88, 0
    v_mov_b32 v89, 0
    v_mov_b32 v90, 0
    v_mov_b32 v91, 0
    v_mov_b32 v92, 0
    v_mov_b32 v93, 0
    v_mov_b32 v94, 0
    v_mov_b32 v95, 0
    v_mov_b32 v96, 0
    v_mov_b32 v97, 0
    v_mov_b32 v98, 0
    v_mov_b32 v99, 0
    v_mov_b32 v100, 0
    v_mov_b32 v101, 0
    v_mov_b32 v102, 0
    v_mov_b32 v103, 0
    v_mov_b32 v104, 0
    v_mov_b32 v105, 0
    v_mov_b32 v106, 0
    v_mov_b32 v107, 0
    v_mov_b32 v108, 0
    v_mov_b32 v109, 0
    v_mov_b32 v110, 0
    v_mov_b32 v111, 0
    v_mov_b32 v112, 0
    v_mov_b32 v113, 0
    v_mov_b32 v114, 0
    v_mov_b32 v115, 0
    v_mov_b32 v116, 0
    v_mov_b32 v117, 0
    v_mov_b32 v118, 0
    v_mov_b32 v119, 0
    buffer_load_dwordx4 v[88:91], v4, s[28:31], s50 offen sc1
    s_mov_b64 exec, 0xff
    buffer_load_dwordx4 v[92:95], v9, s[28:31], s50 offen sc1
    s_mov_b64 exec, -1
    s_add_u32 s50, s50, 2621440
    buffer_load_dwordx4 v[96:99], v4, s[28:31], s50 offen sc1
    s_mov_b64 exec, 0xff
    buffer_load_dwordx4 v[100:103], v9, s[28:31], s50 offen sc1
    s_mov_b64 exec, -1
    s_add_u32 s50, s50, 2621440
    buffer_load_dwordx4 v[104:107], v4, s[28:31], s50 offen sc1
    s_mov_b64 exec, 0xff
    buffer_load_dwordx4 v[108:111], v9, s[28:31], s50 offen sc1
    s_mov_b64 exec, -1
    s_add_u32 s50, s50, 2621440
    buffer_load_dwordx4 v[112:115], v4, s[28:31], s50 offen sc1
    s_mov_b64 exec, 0xff
    buffer_load_dwordx4 v[116:119], v9, s[28:31], s50 offen sc1
    s_mov_b64 exec, -1
    buffer_load_dwordx2 v[80:81], v5, s[24:27], s51 offen
    buffer_load_dwordx2 v[82:83], v5, s[24:27], s51 offen offset:16
    s_mov_b64 exec, 0xff
    buffer_load_dwordx2 v[84:85], v5, s[24:27], s51 offen offset:1024
    buffer_load_dwordx2 v[86:87], v5, s[24:27], s51 offen offset:1040
    s_mov_b64 exec, -1
    s_waitcnt vmcnt(0)
    v_lshlrev_b32 v16, 16, v88
    v_and_b32 v17, 0xffff0000, v88
    v_lshlrev_b32 v18, 16, v89
    v_and_b32 v19, 0xffff0000, v89
    v_lshlrev_b32 v20, 16, v90
    v_and_b32 v21, 0xffff0000, v90
    v_lshlrev_b32 v22, 16, v91
    v_and_b32 v23, 0xffff0000, v91
    v_lshlrev_b32 v24, 16, v92
    v_and_b32 v25, 0xffff0000, v92
    v_lshlrev_b32 v26, 16, v93
    v_and_b32 v27, 0xffff0000, v93
    v_lshlrev_b32 v28, 16, v94
    v_and_b32 v29, 0xffff0000, v94
    v_lshlrev_b32 v30, 16, v95
    v_and_b32 v31, 0xffff0000, v95
    v_lshlrev_b32 v32, 16, v96
    v_and_b32 v33, 0xffff0000, v96
    v_lshlrev_b32 v34, 16, v97
    v_and_b32 v35, 0xffff0000, v97
    v_lshlrev_b32 v36, 16, v98
    v_and_b32 v37, 0xffff0000, v98
    v_lshlrev_b32 v38, 16, v99
    v_and_b32 v39, 0xffff0000, v99
    v_lshlrev_b32 v40, 16, v100
    v_and_b32 v41, 0xffff0000, v100
    v_lshlrev_b32 v42, 16, v101
    v_and_b32 v43, 0xffff0000, v101
    v_lshlrev_b32 v44, 16, v102
    v_and_b32 v45, 0xffff0000, v102
    v_lshlrev_b32 v46, 16, v103
    v_and_b32 v47, 0xffff0000, v103
    v_lshlrev_b32 v48, 16, v104
    v_and_b32 v49, 0xffff0000, v104
    v_lshlrev_b32 v50, 16, v105
    v_and_b32 v51, 0xffff0000, v105
    v_lshlrev_b32 v52, 16, v106
    v_and_b32 v53, 0xffff0000, v106
    v_lshlrev_b32 v54, 16, v107
    v_and_b32 v55, 0xffff0000, v107
    v_lshlrev_b32 v56, 16, v108
    v_and_b32 v57, 0xffff0000, v108
    v_lshlrev_b32 v58, 16, v109
    v_and_b32 v59, 0xffff0000, v109
    v_lshlrev_b32 v60, 16, v110
    v_and_b32 v61, 0xffff0000, v110
    v_lshlrev_b32 v62, 16, v111
    v_and_b32 v63, 0xffff0000, v111
    v_lshlrev_b32 v64, 16, v112
    v_and_b32 v65, 0xffff0000, v112
    v_lshlrev_b32 v66, 16, v113
    v_and_b32 v67, 0xffff0000, v113
    v_lshlrev_b32 v68, 16, v114
    v_and_b32 v69, 0xffff0000, v114
    v_lshlrev_b32 v70, 16, v115
    v_and_b32 v71, 0xffff0000, v115
    v_lshlrev_b32 v72, 16, v116
    v_and_b32 v73, 0xffff0000, v116
    v_lshlrev_b32 v74, 16, v117
    v_and_b32 v75, 0xffff0000, v117
    v_lshlrev_b32 v76, 16, v118
    v_and_b32 v77, 0xffff0000, v118
    v_lshlrev_b32 v78, 16, v119
    v_and_b32 v79, 0xffff0000, v119
    v_add_f32 v16, v16, v32
    v_add_f32 v48, v48, v64
    v_add_f32 v17, v17, v33
    v_add_f32 v49, v49, v65
    v_add_f32 v18, v18, v34
    v_add_f32 v50, v50, v66
    v_add_f32 v19, v19, v35
    v_add_f32 v51, v51, v67
    v_add_f32 v20, v20, v36
    v_add_f32 v52, v52, v68
    v_add_f32 v21, v21, v37
    v_add_f32 v53, v53, v69
    v_add_f32 v22, v22, v38
    v_add_f32 v54, v54, v70
    v_add_f32 v23, v23, v39
    v_add_f32 v55, v55, v71
    v_add_f32 v24, v24, v40
    v_add_f32 v56, v56, v72
    v_add_f32 v25, v25, v41
    v_add_f32 v57, v57, v73
    v_add_f32 v26, v26, v42
    v_add_f32 v58, v58, v74
    v_add_f32 v27, v27, v43
    v_add_f32 v59, v59, v75
    v_add_f32 v28, v28, v44
    v_add_f32 v60, v60, v76
    v_add_f32 v29, v29, v45
    v_add_f32 v61, v61, v77
    v_add_f32 v30, v30, v46
    v_add_f32 v62, v62, v78
    v_add_f32 v31, v31, v47
    v_add_f32 v63, v63, v79
    v_add_f32 v16, v16, v48
    v_add_f32 v17, v17, v49
    v_add_f32 v18, v18, v50
    v_add_f32 v19, v19, v51
    v_add_f32 v20, v20, v52
    v_add_f32 v21, v21, v53
    v_add_f32 v22, v22, v54
    v_add_f32 v23, v23, v55
    v_add_f32 v24, v24, v56
    v_add_f32 v25, v25, v57
    v_add_f32 v26, v26, v58
    v_add_f32 v27, v27, v59
    v_add_f32 v28, v28, v60
    v_add_f32 v29, v29, v61
    v_add_f32 v30, v30, v62
    v_add_f32 v31, v31, v63
    v_cvt_pk_bf16_f32 v6, v16, v17
    v_lshlrev_b32 v16, 16, v6
    v_and_b32 v17, 0xffff0000, v6
    v_lshlrev_b32 v6, 16, v80
    v_and_b32 v7, 0xffff0000, v80
    v_add_f32 v16, v16, v6
    v_add_f32 v17, v17, v7
    v_cvt_pk_bf16_f32 v80, v16, v17
    v_cvt_pk_bf16_f32 v6, v18, v19
    v_lshlrev_b32 v18, 16, v6
    v_and_b32 v19, 0xffff0000, v6
    v_lshlrev_b32 v6, 16, v81
    v_and_b32 v7, 0xffff0000, v81
    v_add_f32 v18, v18, v6
    v_add_f32 v19, v19, v7
    v_cvt_pk_bf16_f32 v81, v18, v19
    v_cvt_pk_bf16_f32 v6, v20, v21
    v_lshlrev_b32 v20, 16, v6
    v_and_b32 v21, 0xffff0000, v6
    v_lshlrev_b32 v6, 16, v82
    v_and_b32 v7, 0xffff0000, v82
    v_add_f32 v20, v20, v6
    v_add_f32 v21, v21, v7
    v_cvt_pk_bf16_f32 v82, v20, v21
    v_cvt_pk_bf16_f32 v6, v22, v23
    v_lshlrev_b32 v22, 16, v6
    v_and_b32 v23, 0xffff0000, v6
    v_lshlrev_b32 v6, 16, v83
    v_and_b32 v7, 0xffff0000, v83
    v_add_f32 v22, v22, v6
    v_add_f32 v23, v23, v7
    v_cvt_pk_bf16_f32 v83, v22, v23
    v_cvt_pk_bf16_f32 v6, v24, v25
    v_lshlrev_b32 v24, 16, v6
    v_and_b32 v25, 0xffff0000, v6
    v_lshlrev_b32 v6, 16, v84
    v_and_b32 v7, 0xffff0000, v84
    v_add_f32 v24, v24, v6
    v_add_f32 v25, v25, v7
    v_cvt_pk_bf16_f32 v84, v24, v25
    v_cvt_pk_bf16_f32 v6, v26, v27
    v_lshlrev_b32 v26, 16, v6
    v_and_b32 v27, 0xffff0000, v6
    v_lshlrev_b32 v6, 16, v85
    v_and_b32 v7, 0xffff0000, v85
    v_add_f32 v26, v26, v6
    v_add_f32 v27, v27, v7
    v_cvt_pk_bf16_f32 v85, v26, v27
    v_cvt_pk_bf16_f32 v6, v28, v29
    v_lshlrev_b32 v28, 16, v6
    v_and_b32 v29, 0xffff0000, v6
    v_lshlrev_b32 v6, 16, v86
    v_and_b32 v7, 0xffff0000, v86
    v_add_f32 v28, v28, v6
    v_add_f32 v29, v29, v7
    v_cvt_pk_bf16_f32 v86, v28, v29
    v_cvt_pk_bf16_f32 v6, v30, v31
    v_lshlrev_b32 v30, 16, v6
    v_and_b32 v31, 0xffff0000, v6
    v_lshlrev_b32 v6, 16, v87
    v_and_b32 v7, 0xffff0000, v87
    v_add_f32 v30, v30, v6
    v_add_f32 v31, v31, v7
    v_cvt_pk_bf16_f32 v87, v30, v31
    s_add_u32 s52, s51, 75497472
    buffer_store_dwordx2 v[80:81], v5, s[28:31], s52 offen
    buffer_store_dwordx2 v[82:83], v5, s[28:31], s52 offen offset:16
    s_mov_b64 exec, 0xff
    buffer_store_dwordx2 v[84:85], v5, s[28:31], s52 offen offset:1024
    buffer_store_dwordx2 v[86:87], v5, s[28:31], s52 offen offset:1040
    s_mov_b64 exec, -1
    v_lshlrev_b32 v20, 16, v80
    v_and_b32 v21, 0xffff0000, v80
    v_lshlrev_b32 v22, 16, v81
    v_and_b32 v23, 0xffff0000, v81
    v_lshlrev_b32 v24, 16, v82
    v_and_b32 v25, 0xffff0000, v82
    v_lshlrev_b32 v26, 16, v83
    v_and_b32 v27, 0xffff0000, v83
    v_lshlrev_b32 v28, 16, v84
    v_and_b32 v29, 0xffff0000, v84
    v_lshlrev_b32 v30, 16, v85
    v_and_b32 v31, 0xffff0000, v85
    v_lshlrev_b32 v32, 16, v86
    v_and_b32 v33, 0xffff0000, v86
    v_lshlrev_b32 v34, 16, v87
    v_and_b32 v35, 0xffff0000, v87
    v_add_f32 v36, v20, v21
    v_add_f32 v36, v36, v22
    v_add_f32 v36, v36, v23
    v_add_f32 v36, v36, v24
    v_add_f32 v36, v36, v25
    v_add_f32 v36, v36, v26
    v_add_f32 v36, v36, v27
    v_add_f32 v36, v36, v28
    v_add_f32 v36, v36, v29
    v_add_f32 v36, v36, v30
    v_add_f32 v36, v36, v31
    v_add_f32 v36, v36, v32
    v_add_f32 v36, v36, v33
    v_add_f32 v36, v36, v34
    v_add_f32 v36, v36, v35
    s_nop 1
    v_add_f32_dpp v36, v36, v36 quad_perm:[1,0,3,2] row_mask:0xf bank_mask:0xf
    s_nop 1
    v_add_f32_dpp v36, v36, v36 quad_perm:[2,3,0,1] row_mask:0xf bank_mask:0xf
    s_nop 1
    v_add_f32_dpp v36, v36, v36 row_half_mirror row_mask:0xf bank_mask:0xf
    s_nop 1
    v_add_f32_dpp v36, v36, v36 row_mirror row_mask:0xf bank_mask:0xf
    v_mov_b32 v37, v36
    s_nop 1
    v_permlane16_swap_b32 v36, v37
    s_nop 1
    v_add_f32 v36, v36, v37
    v_mov_b32 v37, v36
    s_nop 1
    v_permlane32_swap_b32 v36, v37
    s_nop 1
    v_add_f32 v36, v36, v37
    v_mul_f32 v36, 0.001736111111111111, v36
    v_mov_b32 v39, 0
    v_sub_f32 v37, v20, v36
    v_fmac_f32 v39, v37, v37
    v_sub_f32 v37, v21, v36
    v_fmac_f32 v39, v37, v37
    v_sub_f32 v37, v22, v36
    v_fmac_f32 v39, v37, v37
    v_sub_f32 v37, v23, v36
    v_fmac_f32 v39, v37, v37
    v_sub_f32 v37, v24, v36
    v_fmac_f32 v39, v37, v37
    v_sub_f32 v37, v25, v36
    v_fmac_f32 v39, v37, v37
    v_sub_f32 v37, v26, v36
    v_fmac_f32 v39, v37, v37
    v_sub_f32 v37, v27, v36
    v_fmac_f32 v39, v37, v37
    s_mov_b64 exec, 0xff
    v_sub_f32 v37, v28, v36
    v_fmac_f32 v39, v37, v37
    v_sub_f32 v37, v29, v36
    v_fmac_f32 v39, v37, v37
    v_sub_f32 v37, v30, v36
    v_fmac_f32 v39, v37, v37
    v_sub_f32 v37, v31, v36
    v_fmac_f32 v39, v37, v37
    v_sub_f32 v37, v32, v36
    v_fmac_f32 v39, v37, v37
    v_sub_f32 v37, v33, v36
    v_fmac_f32 v39, v37, v37
    v_sub_f32 v37, v34, v36
    v_fmac_f32 v39, v37, v37
    v_sub_f32 v37, v35, v36
    v_fmac_f32 v39, v37, v37
    s_mov_b64 exec, -1
    s_nop 1
    v_add_f32_dpp v39, v39, v39 quad_perm:[1,0,3,2] row_mask:0xf bank_mask:0xf
    s_nop 1
    v_add_f32_dpp v39, v39, v39 quad_perm:[2,3,0,1] row_mask:0xf bank_mask:0xf
    s_nop 1
    v_add_f32_dpp v39, v39, v39 row_half_mirror row_mask:0xf bank_mask:0xf
    s_nop 1
    v_add_f32_dpp v39, v39, v39 row_mirror row_mask:0xf bank_mask:0xf
    v_mov_b32 v37, v39
    s_nop 1
    v_permlane16_swap_b32 v39, v37
    s_nop 1
    v_add_f32 v39, v39, v37
    v_mov_b32 v37, v39
    s_nop 1
    v_permlane32_swap_b32 v39, v37
    s_nop 1
    v_add_f32 v39, v39, v37
    v_mul_f32 v39, 0.001736111111111111, v39
    v_cvt_pk_bf16_f32 v37, v39, v39
    v_lshlrev_b32 v39, 16, v37
    v_add_f32 v39, 0x3727c5ac, v39
    v_cvt_pk_bf16_f32 v37, v39, v39
    v_lshlrev_b32 v39, 16, v37
    v_sqrt_f32 v39, v39
    s_nop 0
    v_cvt_pk_bf16_f32 v37, v39, v39
    v_lshlrev_b32 v39, 16, v37
    v_rcp_f32 v39, v39
    v_cvt_pk_bf16_f32 v37, v36, v36
    v_lshlrev_b32 v36, 16, v37
    v_sub_f32 v20, v20, v36
    v_sub_f32 v21, v21, v36
    v_cvt_pk_bf16_f32 v37, v20, v21
    v_lshlrev_b32 v20, 16, v37
    v_and_b32 v21, 0xffff0000, v37
    v_mul_f32 v20, v20, v39
    v_mul_f32 v21, v21, v39
    v_cvt_pk_bf16_f32 v8, v20, v21
    v_sub_f32 v22, v22, v36
    v_sub_f32 v23, v23, v36
    v_cvt_pk_bf16_f32 v37, v22, v23
    v_lshlrev_b32 v22, 16, v37
    v_and_b32 v23, 0xffff0000, v37
    v_mul_f32 v22, v22, v39
    v_mul_f32 v23, v23, v39
    v_cvt_pk_bf16_f32 v9, v22, v23
    v_sub_f32 v24, v24, v36
    v_sub_f32 v25, v25, v36
    v_cvt_pk_bf16_f32 v37, v24, v25
    v_lshlrev_b32 v24, 16, v37
    v_and_b32 v25, 0xffff0000, v37
    v_mul_f32 v24, v24, v39
    v_mul_f32 v25, v25, v39
    v_cvt_pk_bf16_f32 v10, v24, v25
    v_sub_f32 v26, v26, v36
    v_sub_f32 v27, v27, v36
    v_cvt_pk_bf16_f32 v37, v26, v27
    v_lshlrev_b32 v26, 16, v37
    v_and_b32 v27, 0xffff0000, v37
    v_mul_f32 v26, v26, v39
    v_mul_f32 v27, v27, v39
    v_cvt_pk_bf16_f32 v11, v26, v27
    v_sub_f32 v28, v28, v36
    v_sub_f32 v29, v29, v36
    v_cvt_pk_bf16_f32 v37, v28, v29
    v_lshlrev_b32 v28, 16, v37
    v_and_b32 v29, 0xffff0000, v37
    v_mul_f32 v28, v28, v39
    v_mul_f32 v29, v29, v39
    v_cvt_pk_bf16_f32 v12, v28, v29
    v_sub_f32 v30, v30, v36
    v_sub_f32 v31, v31, v36
    v_cvt_pk_bf16_f32 v37, v30, v31
    v_lshlrev_b32 v30, 16, v37
    v_and_b32 v31, 0xffff0000, v37
    v_mul_f32 v30, v30, v39
    v_mul_f32 v31, v31, v39
    v_cvt_pk_bf16_f32 v13, v30, v31
    v_sub_f32 v32, v32, v36
    v_sub_f32 v33, v33, v36
    v_cvt_pk_bf16_f32 v37, v32, v33
    v_lshlrev_b32 v32, 16, v37
    v_and_b32 v33, 0xffff0000, v37
    v_mul_f32 v32, v32, v39
    v_mul_f32 v33, v33, v39
    v_cvt_pk_bf16_f32 v14, v32, v33
    v_sub_f32 v34, v34, v36
    v_sub_f32 v35, v35, v36
    v_cvt_pk_bf16_f32 v37, v34, v35
    v_lshlrev_b32 v34, 16, v37
    v_and_b32 v35, 0xffff0000, v37
    v_mul_f32 v34, v34, v39
    v_mul_f32 v35, v35, v39
    v_cvt_pk_bf16_f32 v15, v34, v35
    v_lshrrev_b32 v37, 2, v2
    v_lshlrev_b32 v37, 17, v37
    v_and_b32 v38, 3, v2
    v_lshl_add_u32 v37, v38, 4, v37
    s_lshl_b32 s50, s49, 6
    s_add_u32 s50, s50, 79691776
    buffer_store_dwordx4 v[8:11], v37, s[28:31], s50 offen sc1
    s_add_u32 s50, s50, 2097152
    s_mov_b64 exec, 0xff
    buffer_store_dwordx4 v[12:15], v37, s[28:31], s50 offen sc1
    s_mov_b64 exec, -1
    s_waitcnt vmcnt(0)
    s_barrier
    s_cmp_lg_u32 s32, 0
    s_cbranch_scc1 L_ws_k34c_out
    s_lshl_b32 s96, s2, 7
    s_add_u32 s96, s96, 125894656
    v_mov_b32 v16, 1
    v_mov_b32 v17, 0
    s_mov_b64 exec, 1
    buffer_store_dword v16, v17, s[28:31], s96 offen sc1
    s_mov_b64 exec, -1
L_ws_k34c_out:
    s_load_dwordx4 s[8:11], s[0:1], 56
    s_load_dwordx2 s[12:13], s[0:1], 96
    v_lshrrev_b32 v1, 6, v0
    v_and_b32 v2, 63, v0
    s_nop 0
    v_readfirstlane_b32 s32, v1
    s_and_b32 s35, s2, 7
    s_lshl_b32 s35, s35, 2
    s_lshr_b32 s48, s2, 3
    s_and_b32 s48, s48, 3
    s_add_u32 s35, s35, s48
    s_lshr_b32 s34, s2, 5
    s_and_b32 s36, s32, 3
    s_lshr_b32 s37, s32, 2
    s_waitcnt lgkmcnt(0)
    s_cmp_eq_u32 s37, 1
    s_cselect_b32 s8, s10, s8
    s_cselect_b32 s9, s11, s9
    s_mov_b32 s20, s8
    s_and_b32 s21, s9, 0xffff
    s_mov_b32 s22, 5308416
    s_mov_b32 s23, 0x00020000
    s_mov_b32 s47, 5308416
    s_mov_b32 s16, s12
    s_and_b32 s17, s13, 0xffff
    s_mov_b32 s18, 268435456
    s_mov_b32 s19, 0x00020000
    s_mov_b32 s46, 268435456
    s_mov_b32 s28, s12
    s_and_b32 s29, s13, 0xffff
    s_mov_b32 s30, 268435456
    s_mov_b32 s31, 0x00020000
    s_sub_u32 s59, 15, s34
    s_cmp_eq_u32 s37, 1
    s_cselect_b32 s59, s59, s34
    s_lshl_b32 s59, s59, 7
    s_lshl_b32 s48, s36, 5
    s_add_u32 s59, s59, s48
    v_lshrrev_b32 v20, 2, v2
    v_add_u32 v20, s59, v20
    v_lshlrev_b32 v20, 6, v20
    v_lshrrev_b32 v21, 4, v2
    v_sub_u32 v21, 0, v21
    v_and_b32 v21, 3, v21
    v_and_b32 v22, 3, v2
    v_xor_b32 v21, v21, v22
    v_lshl_add_u32 v64, v21, 4, v20
    s_mov_b32 s38, 79691776
    v_add_u32 v20, 0, v2
    v_mul_u32_u24 v21, 3641, v20
    v_lshrrev_b32 v21, 16, v21
    v_mul_u32_u24 v23, 18, v21
    v_sub_u32 v22, v20, v23
    v_and_b32 v23, 1, v22
    v_bfe_u32 v24, v22, 1, 1
    v_lshl_or_b32 v23, v23, 1, v24
    v_and_b32 v24, 28, v22
    v_or_b32 v23, v23, v24
    v_cmp_gt_u32 vcc, 16, v22
    s_nop 1
    v_cndmask_b32 v22, v22, v23, vcc
    s_lshl_b32 s48, s36, 3
    v_add_u32 v21, s48, v21
    v_mul_u32_u24 v21, 9216, v21
    v_lshl_add_u32 v66, v22, 4, v21
    v_add_u32 v20, 64, v2
    v_mul_u32_u24 v21, 3641, v20
    v_lshrrev_b32 v21, 16, v21
    v_mul_u32_u24 v23, 18, v21
    v_sub_u32 v22, v20, v23
    v_and_b32 v23, 1, v22
    v_bfe_u32 v24, v22, 1, 1
    v_lshl_or_b32 v23, v23, 1, v24
    v_and_b32 v24, 28, v22
    v_or_b32 v23, v23, v24
    v_cmp_gt_u32 vcc, 16, v22
    s_nop 1
    v_cndmask_b32 v22, v22, v23, vcc
    s_lshl_b32 s48, s36, 3
    v_add_u32 v21, s48, v21
    v_mul_u32_u24 v21, 9216, v21
    v_lshl_add_u32 v67, v22, 4, v21
    v_add_u32 v20, 128, v2
    v_mul_u32_u24 v21, 3641, v20
    v_lshrrev_b32 v21, 16, v21
    v_mul_u32_u24 v23, 18, v21
    v_sub_u32 v22, v20, v23
    v_and_b32 v23, 1, v22
    v_bfe_u32 v24, v22, 1, 1
    v_lshl_or_b32 v23, v23, 1, v24
    v_and_b32 v24, 28, v22
    v_or_b32 v23, v23, v24
    v_cmp_gt_u32 vcc, 16, v22
    s_nop 1
    v_cndmask_b32 v22, v22, v23, vcc
    s_lshl_b32 s48, s36, 3
    v_add_u32 v21, s48, v21
    v_mul_u32_u24 v21, 9216, v21
    v_lshl_add_u32 v68, v22, 4, v21
    s_mul_i32 s39, s35, 288
    s_lshl_b32 s40, s32, 11
    s_mul_i32 s41, s32, 2304
    s_add_u32 s41, s41, 65536
    v_and_b32 v62, 15, v2
    v_lshrrev_b32 v61, 4, v2
    v_lshrrev_b32 v20, 2, v62
    v_sub_u32 v20, 0, v20
    v_and_b32 v20, 3, v20
    v_xor_b32 v20, v20, v61
    s_lshl_b32 s48, s32, 5
    v_add_u32 v21, s48, v62
    v_lshlrev_b32 v21, 6, v21
    v_lshl_add_u32 v69, v20, 4, v21
    v_lshrrev_b32 v20, 5, v2
    v_lshlrev_b32 v20, 4, v20
    v_bfe_u32 v21, v2, 2, 3
    v_add_u32 v20, v20, v21
    v_mul_u32_u24 v20, 288, v20
    v_add_u32 v20, 65536, v20
    v_and_b32 v21, 3, v2
    v_lshl_add_u32 v70, v21, 3, v20
    v_and_b32 v22, 1, v2
    v_lshl_add_u32 v20, v22, 4, v20
    v_bfe_u32 v22, v2, 1, 1
    v_lshl_add_u32 v71, v22, 3, v20
    s_mov_b32 s44, 0
    s_mov_b32 s53, 0
    s_mov_b32 s57, 0
    s_add_u32 m0, s53, s41
    s_nop 0
    buffer_load_dwordx4 v66, s[20:23], s39 offen lds
    s_add_u32 m0, m0, 1024
    s_nop 0
    buffer_load_dwordx4 v67, s[20:23], s39 offen lds
    s_add_u32 m0, m0, 1024
    s_mov_b64 exec, 0xffff
    buffer_load_dwordx4 v68, s[20:23], s39 offen lds
    s_mov_b64 exec, -1
    s_add_u32 s39, s39, 294912
    s_add_u32 s53, s53, 18432
    s_cmp_eq_u32 s53, 73728
    s_cselect_b32 s53, 0, s53
    s_add_u32 m0, s53, s41
    s_nop 0
    buffer_load_dwordx4 v66, s[20:23], s39 offen lds
    s_add_u32 m0, m0, 1024
    s_nop 0
    buffer_load_dwordx4 v67, s[20:23], s39 offen lds
    s_add_u32 m0, m0, 1024
    s_mov_b64 exec, 0xffff
    buffer_load_dwordx4 v68, s[20:23], s39 offen lds
    s_mov_b64 exec, -1
    s_add_u32 s39, s39, 294912
    s_add_u32 s53, s53, 18432
    s_cmp_eq_u32 s53, 73728
    s_cselect_b32 s53, 0, s53
    s_add_u32 m0, s53, s41
    s_nop 0
    buffer_load_dwordx4 v66, s[20:23], s39 offen lds
    s_add_u32 m0, m0, 1024
    s_nop 0
    buffer_load_dwordx4 v67, s[20:23], s39 offen lds
    s_add_u32 m0, m0, 1024
    s_mov_b64 exec, 0xffff
    buffer_load_dwordx4 v68, s[20:23], s39 offen lds
    s_mov_b64 exec, -1
    s_add_u32 s39, s39, 294912
    s_add_u32 s53, s53, 18432
    s_cmp_eq_u32 s53, 73728
    s_cselect_b32 s53, 0, s53
    s_cmp_lg_u32 s32, 0
    s_cbranch_scc1 L_ww_k5_ffn1_kernel_in_done
    v_and_b32 v16, 63, v0
    s_andn2_b32 s48, s2, 31
    v_add_u32 v17, s48, v16
    v_lshlrev_b32 v17, 7, v17
    s_mov_b32 s97, 125894656
    s_mov_b32 s96, 0x100000
    s_mov_b64 exec, 4294967295
L_ww_k5_ffn1_kernel_in_loop:
    buffer_load_dword v18, v17, s[28:31], s97 offen sc1
    s_waitcnt vmcnt(0)
    v_cmp_ne_u32 vcc, 1, v18
    s_nop 1
    s_cbranch_vccz L_ww_k5_ffn1_kernel_in_ok
    s_sleep 2
    s_sub_u32 s96, s96, 1
    s_cmp_lg_u32 s96, 0
    s_cbranch_scc1 L_ww_k5_ffn1_kernel_in_loop
L_ww_k5_ffn1_kernel_in_ok:
    s_mov_b64 exec, -1
L_ww_k5_ffn1_kernel_in_done:
    s_barrier
    s_add_u32 m0, s57, s40
    s_nop 0
    buffer_load_dwordx4 v64, s[16:19], s38 offen lds
    buffer_load_dwordx4 v64, s[16:19], s38 offen offset:1024 lds
    s_add_u32 s38, s38, 131072
    s_add_u32 s44, s44, 1
    s_cmp_lt_u32 s44, 18
    s_cselect_b32 s18, s46, 0
    s_cselect_b32 s22, s47, 0
    s_add_u32 s57, s57, 16384
    s_cmp_eq_u32 s57, 65536
    s_cselect_b32 s57, 0, s57
    s_add_u32 m0, s57, s40
    s_nop 0
    buffer_load_dwordx4 v64, s[16:19], s38 offen lds
    buffer_load_dwordx4 v64, s[16:19], s38 offen offset:1024 lds
    s_add_u32 s38, s38, 131072
    s_add_u32 s44, s44, 1
    s_cmp_lt_u32 s44, 18
    s_cselect_b32 s18, s46, 0
    s_cselect_b32 s22, s47, 0
    s_add_u32 s57, s57, 16384
    s_cmp_eq_u32 s57, 65536
    s_cselect_b32 s57, 0, s57
    s_add_u32 m0, s57, s40
    s_nop 0
    buffer_load_dwordx4 v64, s[16:19], s38 offen lds
    buffer_load_dwordx4 v64, s[16:19], s38 offen offset:1024 lds
    s_add_u32 s38, s38, 131072
    s_add_u32 s44, s44, 1
    s_cmp_lt_u32 s44, 18
    s_cselect_b32 s18, s46, 0
    s_cselect_b32 s22, s47, 0
    s_add_u32 s57, s57, 16384
    s_cmp_eq_u32 s57, 65536
    s_cselect_b32 s57, 0, s57
    v_mov_b32 v112, 0
    v_mov_b32 v113, 0
    v_mov_b32 v114, 0
    v_mov_b32 v115, 0
    v_mov_b32 v116, 0
    v_mov_b32 v117, 0
    v_mov_b32 v118, 0
    v_mov_b32 v119, 0
    v_mov_b32 v120, 0
    v_mov_b32 v121, 0
    v_mov_b32 v122, 0
    v_mov_b32 v123, 0
    v_mov_b32 v124, 0
    v_mov_b32 v125, 0
    v_mov_b32 v126, 0
    v_mov_b32 v127, 0
    v_mov_b32 v128, 0
    v_mov_b32 v129, 0
    v_mov_b32 v130, 0
    v_mov_b32 v131, 0
    v_mov_b32 v132, 0
    v_mov_b32 v133, 0
    v_mov_b32 v134, 0
    v_mov_b32 v135, 0
    v_mov_b32 v136, 0
    v_mov_b32 v137, 0
    v_mov_b32 v138, 0
    v_mov_b32 v139, 0
    v_mov_b32 v140, 0
    v_mov_b32 v141, 0
    v_mov_b32 v142, 0
    v_mov_b32 v143, 0
    v_mov_b32 v144, 0
    v_mov_b32 v145, 0
    v_mov_b32 v146, 0
    v_mov_b32 v147, 0
    v_mov_b32 v148, 0
    v_mov_b32 v149, 0
    v_mov_b32 v150, 0
    v_mov_b32 v151, 0
    v_mov_b32 v152, 0
    v_mov_b32 v153, 0
    v_mov_b32 v154, 0
    v_mov_b32 v155, 0
    v_mov_b32 v156, 0
    v_mov_b32 v157, 0
    v_mov_b32 v158, 0
    v_mov_b32 v159, 0
    v_mov_b32 v160, 0
    v_mov_b32 v161, 0
    v_mov_b32 v162, 0
    v_mov_b32 v163, 0
    v_mov_b32 v164, 0
    v_mov_b32 v165, 0
    v_mov_b32 v166, 0
    v_mov_b32 v167, 0
    v_mov_b32 v168, 0
    v_mov_b32 v169, 0
    v_mov_b32 v170, 0
    v_mov_b32 v171, 0
    v_mov_b32 v172, 0
    v_mov_b32 v173, 0
    v_mov_b32 v174, 0
    v_mov_b32 v175, 0
    v_mov_b32 v176, 0
    v_mov_b32 v177, 0
    v_mov_b32 v178, 0
    v_mov_b32 v179, 0
    v_mov_b32 v180, 0
    v_mov_b32 v181, 0
    v_mov_b32 v182, 0
    v_mov_b32 v183, 0
    v_mov_b32 v184, 0
    v_mov_b32 v185, 0
    v_mov_b32 v186, 0
    v_mov_b32 v187, 0
    v_mov_b32 v188, 0
    v_mov_b32 v189, 0
    v_mov_b32 v190, 0
    v_mov_b32 v191, 0
    v_mov_b32 v192, 0
    v_mov_b32 v193, 0
    v_mov_b32 v194, 0
    v_mov_b32 v195, 0
    v_mov_b32 v196, 0
    v_mov_b32 v197, 0
    v_mov_b32 v198, 0
    v_mov_b32 v199, 0
    v_mov_b32 v200, 0
    v_mov_b32 v201, 0
    v_mov_b32 v202, 0
    v_mov_b32 v203, 0
    v_mov_b32 v204, 0
    v_mov_b32 v205, 0
    v_mov_b32 v206, 0
    v_mov_b32 v207, 0
    v_mov_b32 v208, 0
    v_mov_b32 v209, 0
    v_mov_b32 v210, 0
    v_mov_b32 v211, 0
    v_mov_b32 v212, 0
    v_mov_b32 v213, 0
    v_mov_b32 v214, 0
    v_mov_b32 v215, 0
    v_mov_b32 v216, 0
    v_mov_b32 v217, 0
    v_mov_b32 v218, 0
    v_mov_b32 v219, 0
    v_mov_b32 v220, 0
    v_mov_b32 v221, 0
    v_mov_b32 v222, 0
    v_mov_b32 v223, 0
    v_mov_b32 v224, 0
    v_mov_b32 v225, 0
    v_mov_b32 v226, 0
    v_mov_b32 v227, 0
    v_mov_b32 v228, 0
    v_mov_b32 v229, 0
    v_mov_b32 v230, 0
    v_mov_b32 v231, 0
    v_mov_b32 v232, 0
    v_mov_b32 v233, 0
    v_mov_b32 v234, 0
    v_mov_b32 v235, 0
    v_mov_b32 v236, 0
    v_mov_b32 v237, 0
    v_mov_b32 v238, 0
    v_mov_b32 v239, 0
    v_mov_b32 v240, 0
    v_mov_b32 v241, 0
    v_mov_b32 v242, 0
    v_mov_b32 v243, 0
    v_mov_b32 v244, 0
    v_mov_b32 v245, 0
    v_mov_b32 v246, 0
    v_mov_b32 v247, 0
    v_mov_b32 v248, 0
    v_mov_b32 v249, 0
    v_mov_b32 v250, 0
    v_mov_b32 v251, 0
    v_mov_b32 v252, 0
    v_mov_b32 v253, 0
    v_mov_b32 v254, 0
    v_mov_b32 v255, 0
    s_mov_b32 s51, 18432
    s_mov_b32 s54, 18432
    s_mov_b32 s52, 0
    s_mov_b32 s55, 16384
    s_mov_b32 s58, 16384
    s_mov_b32 s56, 0
    s_waitcnt vmcnt(2)
    s_barrier
    ds_read_b128 v[96:99], v69 offset:0
    ds_read_b128 v[100:103], v69 offset:1024
    v_add_u32 v69, s55, v69
    ds_read_b64_tr_b16 v[72:73], v70 offset:0
    ds_read_b64_tr_b16 v[74:75], v70 offset:2304
    ds_read_b64_tr_b16 v[76:77], v70 offset:32
    ds_read_b64_tr_b16 v[78:79], v70 offset:2336
    ds_read_b64_tr_b16 v[80:81], v70 offset:64
    ds_read_b64_tr_b16 v[82:83], v70 offset:2368
    ds_read_b64_tr_b16 v[84:85], v70 offset:96
    ds_read_b64_tr_b16 v[86:87], v70 offset:2400
    ds_read_b64_tr_b16 v[88:89], v70 offset:128
    ds_read_b64_tr_b16 v[90:91], v70 offset:2432
    s_mov_b32 s45, 9
L_k5_ffn1_kernel_loop:
    s_waitcnt vmcnt(5)
    s_barrier
    s_mov_b32 s50, s51
    s_add_u32 s52, s52, 1
    s_cmp_eq_u32 s52, 4
    s_cselect_b32 s52, 0, s52
    s_cmp_eq_u32 s52, 3
    s_cselect_b32 s51, 4294912000, s54
    s_add_u32 s56, s56, 1
    s_cmp_eq_u32 s56, 4
    s_cselect_b32 s56, 0, s56
    s_cmp_eq_u32 s56, 3
    s_cselect_b32 s55, 4294918144, s58
    ds_read_b64_tr_b16 v[92:93], v70 offset:160
    ds_read_b64_tr_b16 v[94:95], v70 offset:2464
    ds_read_b128 v[104:107], v69 offset:0
    s_waitcnt lgkmcnt(11)
    v_mfma_f32_16x16x32_bf16 v[112:115], v[72:75], v[96:99], v[112:115]
    s_add_u32 m0, s53, s41
    s_nop 0
    buffer_load_dwordx4 v66, s[20:23], s39 offen lds
    v_mfma_f32_16x16x32_bf16 v[116:119], v[72:75], v[100:103], v[116:119]
    ds_read_b64_tr_b16 v[72:73], v70 offset:192
    ds_read_b64_tr_b16 v[74:75], v70 offset:2496
    ds_read_b128 v[108:111], v69 offset:1024
    v_add_u32 v69, s55, v69
    s_waitcnt lgkmcnt(12)
    v_mfma_f32_16x16x32_bf16 v[120:123], v[76:79], v[96:99], v[120:123]
    v_mfma_f32_16x16x32_bf16 v[124:127], v[76:79], v[100:103], v[124:127]
    s_add_u32 m0, m0, 1024
    s_nop 0
    buffer_load_dwordx4 v67, s[20:23], s39 offen lds
    ds_read_b64_tr_b16 v[76:77], v70 offset:224
    ds_read_b64_tr_b16 v[78:79], v70 offset:2528
    s_waitcnt lgkmcnt(12)
    v_mfma_f32_16x16x32_bf16 v[128:131], v[80:83], v[96:99], v[128:131]
    v_mfma_f32_16x16x32_bf16 v[132:135], v[80:83], v[100:103], v[132:135]
    ds_read_b64_tr_b16 v[80:81], v71 offset:256
    ds_read_b64_tr_b16 v[82:83], v71 offset:2560
    s_waitcnt lgkmcnt(12)
    v_mfma_f32_16x16x32_bf16 v[136:139], v[84:87], v[96:99], v[136:139]
    v_mfma_f32_16x16x32_bf16 v[140:143], v[84:87], v[100:103], v[140:143]
    s_add_u32 m0, m0, 1024
    s_mov_b64 exec, 0xffff
    buffer_load_dwordx4 v68, s[20:23], s39 offen lds
    s_mov_b64 exec, -1
    s_add_u32 s39, s39, 294912
    s_add_u32 s53, s53, 18432
    s_cmp_eq_u32 s53, 73728
    s_cselect_b32 s53, 0, s53
    ds_read_b64_tr_b16 v[84:85], v70 offset:9216
    ds_read_b64_tr_b16 v[86:87], v70 offset:11520
    s_waitcnt lgkmcnt(12)
    v_mfma_f32_16x16x32_bf16 v[144:147], v[88:91], v[96:99], v[144:147]
    v_mfma_f32_16x16x32_bf16 v[148:151], v[88:91], v[100:103], v[148:151]
    ds_read_b64_tr_b16 v[88:89], v70 offset:9248
    ds_read_b64_tr_b16 v[90:91], v70 offset:11552
    s_waitcnt lgkmcnt(12)
    v_mfma_f32_16x16x32_bf16 v[152:155], v[92:95], v[96:99], v[152:155]
    s_add_u32 m0, s57, s40
    s_nop 0
    buffer_load_dwordx4 v64, s[16:19], s38 offen lds
    v_mfma_f32_16x16x32_bf16 v[156:159], v[92:95], v[100:103], v[156:159]
    ds_read_b64_tr_b16 v[92:93], v70 offset:9280
    ds_read_b64_tr_b16 v[94:95], v70 offset:11584
    s_waitcnt lgkmcnt(11)
    v_mfma_f32_16x16x32_bf16 v[160:163], v[72:75], v[96:99], v[160:163]
    v_mfma_f32_16x16x32_bf16 v[164:167], v[72:75], v[100:103], v[164:167]
    ds_read_b64_tr_b16 v[72:73], v70 offset:9312
    ds_read_b64_tr_b16 v[74:75], v70 offset:11616
    s_waitcnt lgkmcnt(10)
    v_mfma_f32_16x16x32_bf16 v[168:171], v[76:79], v[96:99], v[168:171]
    buffer_load_dwordx4 v64, s[16:19], s38 offen offset:1024 lds
    s_add_u32 s38, s38, 131072
    s_add_u32 s44, s44, 1
    s_cmp_lt_u32 s44, 18
    s_cselect_b32 s18, s46, 0
    s_cselect_b32 s22, s47, 0
    s_add_u32 s57, s57, 16384
    s_cmp_eq_u32 s57, 65536
    s_cselect_b32 s57, 0, s57
    v_mfma_f32_16x16x32_bf16 v[172:175], v[76:79], v[100:103], v[172:175]
    ds_read_b64_tr_b16 v[76:77], v70 offset:9344
    ds_read_b64_tr_b16 v[78:79], v70 offset:11648
    s_waitcnt lgkmcnt(10)
    v_mfma_f32_16x16x32_bf16 v[176:179], v[80:83], v[96:99], v[176:179]
    v_mfma_f32_16x16x32_bf16 v[180:183], v[80:83], v[100:103], v[180:183]
    ds_read_b64_tr_b16 v[80:81], v70 offset:9376
    ds_read_b64_tr_b16 v[82:83], v70 offset:11680
    s_waitcnt lgkmcnt(10)
    v_mfma_f32_16x16x32_bf16 v[184:187], v[84:87], v[96:99], v[184:187]
    v_mfma_f32_16x16x32_bf16 v[188:191], v[84:87], v[100:103], v[188:191]
    ds_read_b64_tr_b16 v[84:85], v70 offset:9408
    ds_read_b64_tr_b16 v[86:87], v70 offset:11712
    s_waitcnt lgkmcnt(10)
    v_mfma_f32_16x16x32_bf16 v[192:195], v[88:91], v[96:99], v[192:195]
    v_mfma_f32_16x16x32_bf16 v[196:199], v[88:91], v[100:103], v[196:199]
    ds_read_b64_tr_b16 v[88:89], v70 offset:9440
    ds_read_b64_tr_b16 v[90:91], v70 offset:11744
    v_add_u32 v70, s50, v70
    s_waitcnt lgkmcnt(10)
    v_mfma_f32_16x16x32_bf16 v[200:203], v[92:95], v[96:99], v[200:203]
    v_mfma_f32_16x16x32_bf16 v[204:207], v[92:95], v[100:103], v[204:207]
    ds_read_b64_tr_b16 v[92:93], v71 offset:9472
    ds_read_b64_tr_b16 v[94:95], v71 offset:11776
    v_add_u32 v71, s50, v71
    s_waitcnt lgkmcnt(10)
    v_mfma_f32_16x16x32_bf16 v[208:211], v[72:75], v[96:99], v[208:211]
    v_mfma_f32_16x16x32_bf16 v[212:215], v[72:75], v[100:103], v[212:215]
    ds_read_b64_tr_b16 v[72:73], v70 offset:0
    ds_read_b64_tr_b16 v[74:75], v70 offset:2304
    s_waitcnt lgkmcnt(10)
    v_mfma_f32_16x16x32_bf16 v[216:219], v[76:79], v[96:99], v[216:219]
    v_mfma_f32_16x16x32_bf16 v[220:223], v[76:79], v[100:103], v[220:223]
    ds_read_b64_tr_b16 v[76:77], v70 offset:32
    ds_read_b64_tr_b16 v[78:79], v70 offset:2336
    s_waitcnt lgkmcnt(10)
    v_mfma_f32_16x16x32_bf16 v[224:227], v[80:83], v[96:99], v[224:227]
    v_mfma_f32_16x16x32_bf16 v[228:231], v[80:83], v[100:103], v[228:231]
    ds_read_b64_tr_b16 v[80:81], v70 offset:64
    ds_read_b64_tr_b16 v[82:83], v70 offset:2368
    s_waitcnt lgkmcnt(10)
    v_mfma_f32_16x16x32_bf16 v[232:235], v[84:87], v[96:99], v[232:235]
    v_mfma_f32_16x16x32_bf16 v[236:239], v[84:87], v[100:103], v[236:239]
    ds_read_b64_tr_b16 v[84:85], v70 offset:96
    ds_read_b64_tr_b16 v[86:87], v70 offset:2400
    s_waitcnt lgkmcnt(10)
    v_mfma_f32_16x16x32_bf16 v[240:243], v[88:91], v[96:99], v[240:243]
    v_mfma_f32_16x16x32_bf16 v[244:247], v[88:91], v[100:103], v[244:247]
    ds_read_b64_tr_b16 v[88:89], v70 offset:128
    ds_read_b64_tr_b16 v[90:91], v70 offset:2432
    s_waitcnt lgkmcnt(10)
    v_mfma_f32_16x16x32_bf16 v[248:251], v[92:95], v[96:99], v[248:251]
    v_mfma_f32_16x16x32_bf16 v[252:255], v[92:95], v[100:103], v[252:255]
    s_waitcnt vmcnt(5)
    s_barrier
    s_mov_b32 s50, s51
    s_add_u32 s52, s52, 1
    s_cmp_eq_u32 s52, 4
    s_cselect_b32 s52, 0, s52
    s_cmp_eq_u32 s52, 3
    s_cselect_b32 s51, 4294912000, s54
    s_add_u32 s56, s56, 1
    s_cmp_eq_u32 s56, 4
    s_cselect_b32 s56, 0, s56
    s_cmp_eq_u32 s56, 3
    s_cselect_b32 s55, 4294918144, s58
    ds_read_b64_tr_b16 v[92:93], v70 offset:160
    ds_read_b64_tr_b16 v[94:95], v70 offset:2464
    ds_read_b128 v[96:99], v69 offset:0
    s_waitcnt lgkmcnt(11)
    v_mfma_f32_16x16x32_bf16 v[112:115], v[72:75], v[104:107], v[112:115]
    s_add_u32 m0, s53, s41
    s_nop 0
    buffer_load_dwordx4 v66, s[20:23], s39 offen lds
    v_mfma_f32_16x16x32_bf16 v[116:119], v[72:75], v[108:111], v[116:119]
    ds_read_b64_tr_b16 v[72:73], v70 offset:192
    ds_read_b64_tr_b16 v[74:75], v70 offset:2496
    ds_read_b128 v[100:103], v69 offset:1024
    v_add_u32 v69, s55, v69
    s_waitcnt lgkmcnt(12)
    v_mfma_f32_16x16x32_bf16 v[120:123], v[76:79], v[104:107], v[120:123]
    v_mfma_f32_16x16x32_bf16 v[124:127], v[76:79], v[108:111], v[124:127]
    s_add_u32 m0, m0, 1024
    s_nop 0
    buffer_load_dwordx4 v67, s[20:23], s39 offen lds
    ds_read_b64_tr_b16 v[76:77], v70 offset:224
    ds_read_b64_tr_b16 v[78:79], v70 offset:2528
    s_waitcnt lgkmcnt(12)
    v_mfma_f32_16x16x32_bf16 v[128:131], v[80:83], v[104:107], v[128:131]
    v_mfma_f32_16x16x32_bf16 v[132:135], v[80:83], v[108:111], v[132:135]
    ds_read_b64_tr_b16 v[80:81], v71 offset:256
    ds_read_b64_tr_b16 v[82:83], v71 offset:2560
    s_waitcnt lgkmcnt(12)
    v_mfma_f32_16x16x32_bf16 v[136:139], v[84:87], v[104:107], v[136:139]
    v_mfma_f32_16x16x32_bf16 v[140:143], v[84:87], v[108:111], v[140:143]
    s_add_u32 m0, m0, 1024
    s_mov_b64 exec, 0xffff
    buffer_load_dwordx4 v68, s[20:23], s39 offen lds
    s_mov_b64 exec, -1
    s_add_u32 s39, s39, 294912
    s_add_u32 s53, s53, 18432
    s_cmp_eq_u32 s53, 73728
    s_cselect_b32 s53, 0, s53
    ds_read_b64_tr_b16 v[84:85], v70 offset:9216
    ds_read_b64_tr_b16 v[86:87], v70 offset:11520
    s_waitcnt lgkmcnt(12)
    v_mfma_f32_16x16x32_bf16 v[144:147], v[88:91], v[104:107], v[144:147]
    v_mfma_f32_16x16x32_bf16 v[148:151], v[88:91], v[108:111], v[148:151]
    ds_read_b64_tr_b16 v[88:89], v70 offset:9248
    ds_read_b64_tr_b16 v[90:91], v70 offset:11552
    s_waitcnt lgkmcnt(12)
    v_mfma_f32_16x16x32_bf16 v[152:155], v[92:95], v[104:107], v[152:155]
    s_add_u32 m0, s57, s40
    s_nop 0
    buffer_load_dwordx4 v64, s[16:19], s38 offen lds
    v_mfma_f32_16x16x32_bf16 v[156:159], v[92:95], v[108:111], v[156:159]
    ds_read_b64_tr_b16 v[92:93], v70 offset:9280
    ds_read_b64_tr_b16 v[94:95], v70 offset:11584
    s_waitcnt lgkmcnt(11)
    v_mfma_f32_16x16x32_bf16 v[160:163], v[72:75], v[104:107], v[160:163]
    v_mfma_f32_16x16x32_bf16 v[164:167], v[72:75], v[108:111], v[164:167]
    ds_read_b64_tr_b16 v[72:73], v70 offset:9312
    ds_read_b64_tr_b16 v[74:75], v70 offset:11616
    s_waitcnt lgkmcnt(10)
    v_mfma_f32_16x16x32_bf16 v[168:171], v[76:79], v[104:107], v[168:171]
    buffer_load_dwordx4 v64, s[16:19], s38 offen offset:1024 lds
    s_add_u32 s38, s38, 131072
    s_add_u32 s44, s44, 1
    s_cmp_lt_u32 s44, 18
    s_cselect_b32 s18, s46, 0
    s_cselect_b32 s22, s47, 0
    s_add_u32 s57, s57, 16384
    s_cmp_eq_u32 s57, 65536
    s_cselect_b32 s57, 0, s57
    v_mfma_f32_16x16x32_bf16 v[172:175], v[76:79], v[108:111], v[172:175]
    ds_read_b64_tr_b16 v[76:77], v70 offset:9344
    ds_read_b64_tr_b16 v[78:79], v70 offset:11648
    s_waitcnt lgkmcnt(10)
    v_mfma_f32_16x16x32_bf16 v[176:179], v[80:83], v[104:107], v[176:179]
    v_mfma_f32_16x16x32_bf16 v[180:183], v[80:83], v[108:111], v[180:183]
    ds_read_b64_tr_b16 v[80:81], v70 offset:9376
    ds_read_b64_tr_b16 v[82:83], v70 offset:11680
    s_waitcnt lgkmcnt(10)
    v_mfma_f32_16x16x32_bf16 v[184:187], v[84:87], v[104:107], v[184:187]
    v_mfma_f32_16x16x32_bf16 v[188:191], v[84:87], v[108:111], v[188:191]
    ds_read_b64_tr_b16 v[84:85], v70 offset:9408
    ds_read_b64_tr_b16 v[86:87], v70 offset:11712
    s_waitcnt lgkmcnt(10)
    v_mfma_f32_16x16x32_bf16 v[192:195], v[88:91], v[104:107], v[192:195]
    v_mfma_f32_16x16x32_bf16 v[196:199], v[88:91], v[108:111], v[196:199]
    ds_read_b64_tr_b16 v[88:89], v70 offset:9440
    ds_read_b64_tr_b16 v[90:91], v70 offset:11744
    v_add_u32 v70, s50, v70
    s_waitcnt lgkmcnt(10)
    v_mfma_f32_16x16x32_bf16 v[200:203], v[92:95], v[104:107], v[200:203]
    v_mfma_f32_16x16x32_bf16 v[204:207], v[92:95], v[108:111], v[204:207]
    ds_read_b64_tr_b16 v[92:93], v71 offset:9472
    ds_read_b64_tr_b16 v[94:95], v71 offset:11776
    v_add_u32 v71, s50, v71
    s_waitcnt lgkmcnt(10)
    v_mfma_f32_16x16x32_bf16 v[208:211], v[72:75], v[104:107], v[208:211]
    v_mfma_f32_16x16x32_bf16 v[212:215], v[72:75], v[108:111], v[212:215]
    ds_read_b64_tr_b16 v[72:73], v70 offset:0
    ds_read_b64_tr_b16 v[74:75], v70 offset:2304
    s_waitcnt lgkmcnt(10)
    v_mfma_f32_16x16x32_bf16 v[216:219], v[76:79], v[104:107], v[216:219]
    v_mfma_f32_16x16x32_bf16 v[220:223], v[76:79], v[108:111], v[220:223]
    ds_read_b64_tr_b16 v[76:77], v70 offset:32
    ds_read_b64_tr_b16 v[78:79], v70 offset:2336
    s_waitcnt lgkmcnt(10)
    v_mfma_f32_16x16x32_bf16 v[224:227], v[80:83], v[104:107], v[224:227]
    v_mfma_f32_16x16x32_bf16 v[228:231], v[80:83], v[108:111], v[228:231]
    ds_read_b64_tr_b16 v[80:81], v70 offset:64
    ds_read_b64_tr_b16 v[82:83], v70 offset:2368
    s_waitcnt lgkmcnt(10)
    v_mfma_f32_16x16x32_bf16 v[232:235], v[84:87], v[104:107], v[232:235]
    v_mfma_f32_16x16x32_bf16 v[236:239], v[84:87], v[108:111], v[236:239]
    ds_read_b64_tr_b16 v[84:85], v70 offset:96
    ds_read_b64_tr_b16 v[86:87], v70 offset:2400
    s_waitcnt lgkmcnt(10)
    v_mfma_f32_16x16x32_bf16 v[240:243], v[88:91], v[104:107], v[240:243]
    v_mfma_f32_16x16x32_bf16 v[244:247], v[88:91], v[108:111], v[244:247]
    ds_read_b64_tr_b16 v[88:89], v70 offset:128
    ds_read_b64_tr_b16 v[90:91], v70 offset:2432
    s_waitcnt lgkmcnt(10)
    v_mfma_f32_16x16x32_bf16 v[248:251], v[92:95], v[104:107], v[248:251]
    v_mfma_f32_16x16x32_bf16 v[252:255], v[92:95], v[108:111], v[252:255]
    s_sub_u32 s45, s45, 1
    s_cmp_lg_u32 s45, 0
    s_cbranch_scc1 L_k5_ffn1_kernel_loop
    s_waitcnt lgkmcnt(0)
    s_nop 7
    s_nop 7
    s_mov_b32 s48, -1.4426950408889634
    s_lshl_b32 s49, s59, 5
    s_mul_i32 s50, s35, 9
    s_lshl_b32 s50, s50, 16
    s_add_u32 s49, s49, s50
    s_add_u32 s49, s49, 83886080
    v_lshlrev_b32 v3, 5, v62
    v_lshrrev_b32 v4, 1, v61
    v_and_b32 v5, 1, v61
    v_lshl_add_u32 v6, v5, 4, v3
    v_lshl_add_u32 v6, v4, 16, v6
    v_lshl_add_u32 v7, v61, 3, v3
    v_mul_f32 v20, s48, v112
    v_mul_f32 v21, s48, v113
    v_mul_f32 v22, s48, v114
    v_mul_f32 v23, s48, v115
    v_exp_f32 v20, v20
    v_exp_f32 v21, v21
    v_exp_f32 v22, v22
    v_exp_f32 v23, v23
    v_add_f32 v20, 1.0, v20
    v_add_f32 v21, 1.0, v21
    v_add_f32 v22, 1.0, v22
    v_add_f32 v23, 1.0, v23
    v_rcp_f32 v20, v20
    v_rcp_f32 v21, v21
    v_rcp_f32 v22, v22
    v_rcp_f32 v23, v23
    v_mul_f32 v112, v112, v184
    v_mul_f32 v113, v113, v185
    v_mul_f32 v114, v114, v186
    v_mul_f32 v115, v115, v187
    v_mul_f32 v112, v112, v20
    v_mul_f32 v113, v113, v21
    v_mul_f32 v114, v114, v22
    v_mul_f32 v115, v115, v23
    v_cvt_pk_bf16_f32 v32, v112, v113
    v_cvt_pk_bf16_f32 v33, v114, v115
    v_mul_f32 v20, s48, v120
    v_mul_f32 v21, s48, v121
    v_mul_f32 v22, s48, v122
    v_mul_f32 v23, s48, v123
    v_exp_f32 v20, v20
    v_exp_f32 v21, v21
    v_exp_f32 v22, v22
    v_exp_f32 v23, v23
    v_add_f32 v20, 1.0, v20
    v_add_f32 v21, 1.0, v21
    v_add_f32 v22, 1.0, v22
    v_add_f32 v23, 1.0, v23
    v_rcp_f32 v20, v20
    v_rcp_f32 v21, v21
    v_rcp_f32 v22, v22
    v_rcp_f32 v23, v23
    v_mul_f32 v120, v120, v192
    v_mul_f32 v121, v121, v193
    v_mul_f32 v122, v122, v194
    v_mul_f32 v123, v123, v195
    v_mul_f32 v120, v120, v20
    v_mul_f32 v121, v121, v21
    v_mul_f32 v122, v122, v22
    v_mul_f32 v123, v123, v23
    v_cvt_pk_bf16_f32 v34, v120, v121
    v_cvt_pk_bf16_f32 v35, v122, v123
    buffer_store_dwordx4 v[32:35], v6, s[28:31], s49 offen offset:0 sc1
    v_mul_f32 v20, s48, v116
    v_mul_f32 v21, s48, v117
    v_mul_f32 v22, s48, v118
    v_mul_f32 v23, s48, v119
    v_exp_f32 v20, v20
    v_exp_f32 v21, v21
    v_exp_f32 v22, v22
    v_exp_f32 v23, v23
    v_add_f32 v20, 1.0, v20
    v_add_f32 v21, 1.0, v21
    v_add_f32 v22, 1.0, v22
    v_add_f32 v23, 1.0, v23
    v_rcp_f32 v20, v20
    v_rcp_f32 v21, v21
    v_rcp_f32 v22, v22
    v_rcp_f32 v23, v23
    v_mul_f32 v116, v116, v188
    v_mul_f32 v117, v117, v189
    v_mul_f32 v118, v118, v190
    v_mul_f32 v119, v119, v191
    v_mul_f32 v116, v116, v20
    v_mul_f32 v117, v117, v21
    v_mul_f32 v118, v118, v22
    v_mul_f32 v119, v119, v23
    v_cvt_pk_bf16_f32 v36, v116, v117
    v_cvt_pk_bf16_f32 v37, v118, v119
    v_mul_f32 v20, s48, v124
    v_mul_f32 v21, s48, v125
    v_mul_f32 v22, s48, v126
    v_mul_f32 v23, s48, v127
    v_exp_f32 v20, v20
    v_exp_f32 v21, v21
    v_exp_f32 v22, v22
    v_exp_f32 v23, v23
    v_add_f32 v20, 1.0, v20
    v_add_f32 v21, 1.0, v21
    v_add_f32 v22, 1.0, v22
    v_add_f32 v23, 1.0, v23
    v_rcp_f32 v20, v20
    v_rcp_f32 v21, v21
    v_rcp_f32 v22, v22
    v_rcp_f32 v23, v23
    v_mul_f32 v124, v124, v196
    v_mul_f32 v125, v125, v197
    v_mul_f32 v126, v126, v198
    v_mul_f32 v127, v127, v199
    v_mul_f32 v124, v124, v20
    v_mul_f32 v125, v125, v21
    v_mul_f32 v126, v126, v22
    v_mul_f32 v127, v127, v23
    v_cvt_pk_bf16_f32 v38, v124, v125
    v_cvt_pk_bf16_f32 v39, v126, v127
    buffer_store_dwordx4 v[36:39], v6, s[28:31], s49 offen offset:512 sc1
    s_add_u32 s49, s49, 131072
    v_mul_f32 v20, s48, v128
    v_mul_f32 v21, s48, v129
    v_mul_f32 v22, s48, v130
    v_mul_f32 v23, s48, v131
    v_exp_f32 v20, v20
    v_exp_f32 v21, v21
    v_exp_f32 v22, v22
    v_exp_f32 v23, v23
    v_add_f32 v20, 1.0, v20
    v_add_f32 v21, 1.0, v21
    v_add_f32 v22, 1.0, v22
    v_add_f32 v23, 1.0, v23
    v_rcp_f32 v20, v20
    v_rcp_f32 v21, v21
    v_rcp_f32 v22, v22
    v_rcp_f32 v23, v23
    v_mul_f32 v128, v128, v200
    v_mul_f32 v129, v129, v201
    v_mul_f32 v130, v130, v202
    v_mul_f32 v131, v131, v203
    v_mul_f32 v128, v128, v20
    v_mul_f32 v129, v129, v21
    v_mul_f32 v130, v130, v22
    v_mul_f32 v131, v131, v23
    v_cvt_pk_bf16_f32 v40, v128, v129
    v_cvt_pk_bf16_f32 v41, v130, v131
    v_mul_f32 v20, s48, v136
    v_mul_f32 v21, s48, v137
    v_mul_f32 v22, s48, v138
    v_mul_f32 v23, s48, v139
    v_exp_f32 v20, v20
    v_exp_f32 v21, v21
    v_exp_f32 v22, v22
    v_exp_f32 v23, v23
    v_add_f32 v20, 1.0, v20
    v_add_f32 v21, 1.0, v21
    v_add_f32 v22, 1.0, v22
    v_add_f32 v23, 1.0, v23
    v_rcp_f32 v20, v20
    v_rcp_f32 v21, v21
    v_rcp_f32 v22, v22
    v_rcp_f32 v23, v23
    v_mul_f32 v136, v136, v208
    v_mul_f32 v137, v137, v209
    v_mul_f32 v138, v138, v210
    v_mul_f32 v139, v139, v211
    v_mul_f32 v136, v136, v20
    v_mul_f32 v137, v137, v21
    v_mul_f32 v138, v138, v22
    v_mul_f32 v139, v139, v23
    v_cvt_pk_bf16_f32 v42, v136, v137
    v_cvt_pk_bf16_f32 v43, v138, v139
    buffer_store_dwordx4 v[40:43], v6, s[28:31], s49 offen offset:0 sc1
    v_mul_f32 v20, s48, v132
    v_mul_f32 v21, s48, v133
    v_mul_f32 v22, s48, v134
    v_mul_f32 v23, s48, v135
    v_exp_f32 v20, v20
    v_exp_f32 v21, v21
    v_exp_f32 v22, v22
    v_exp_f32 v23, v23
    v_add_f32 v20, 1.0, v20
    v_add_f32 v21, 1.0, v21
    v_add_f32 v22, 1.0, v22
    v_add_f32 v23, 1.0, v23
    v_rcp_f32 v20, v20
    v_rcp_f32 v21, v21
    v_rcp_f32 v22, v22
    v_rcp_f32 v23, v23
    v_mul_f32 v132, v132, v204
    v_mul_f32 v133, v133, v205
    v_mul_f32 v134, v134, v206
    v_mul_f32 v135, v135, v207
    v_mul_f32 v132, v132, v20
    v_mul_f32 v133, v133, v21
    v_mul_f32 v134, v134, v22
    v_mul_f32 v135, v135, v23
    v_cvt_pk_bf16_f32 v44, v132, v133
    v_cvt_pk_bf16_f32 v45, v134, v135
    v_mul_f32 v20, s48, v140
    v_mul_f32 v21, s48, v141
    v_mul_f32 v22, s48, v142
    v_mul_f32 v23, s48, v143
    v_exp_f32 v20, v20
    v_exp_f32 v21, v21
    v_exp_f32 v22, v22
    v_exp_f32 v23, v23
    v_add_f32 v20, 1.0, v20
    v_add_f32 v21, 1.0, v21
    v_add_f32 v22, 1.0, v22
    v_add_f32 v23, 1.0, v23
    v_rcp_f32 v20, v20
    v_rcp_f32 v21, v21
    v_rcp_f32 v22, v22
    v_rcp_f32 v23, v23
    v_mul_f32 v140, v140, v212
    v_mul_f32 v141, v141, v213
    v_mul_f32 v142, v142, v214
    v_mul_f32 v143, v143, v215
    v_mul_f32 v140, v140, v20
    v_mul_f32 v141, v141, v21
    v_mul_f32 v142, v142, v22
    v_mul_f32 v143, v143, v23
    v_cvt_pk_bf16_f32 v46, v140, v141
    v_cvt_pk_bf16_f32 v47, v142, v143
    buffer_store_dwordx4 v[44:47], v6, s[28:31], s49 offen offset:512 sc1
    s_add_u32 s49, s49, 131072
    v_mul_f32 v20, s48, v144
    v_mul_f32 v21, s48, v145
    v_mul_f32 v22, s48, v146
    v_mul_f32 v23, s48, v147
    v_exp_f32 v20, v20
    v_exp_f32 v21, v21
    v_exp_f32 v22, v22
    v_exp_f32 v23, v23
    v_add_f32 v20, 1.0, v20
    v_add_f32 v21, 1.0, v21
    v_add_f32 v22, 1.0, v22
    v_add_f32 v23, 1.0, v23
    v_rcp_f32 v20, v20
    v_rcp_f32 v21, v21
    v_rcp_f32 v22, v22
    v_rcp_f32 v23, v23
    v_mul_f32 v144, v144, v216
    v_mul_f32 v145, v145, v217
    v_mul_f32 v146, v146, v218
    v_mul_f32 v147, v147, v219
    v_mul_f32 v144, v144, v20
    v_mul_f32 v145, v145, v21
    v_mul_f32 v146, v146, v22
    v_mul_f32 v147, v147, v23
    v_cvt_pk_bf16_f32 v32, v144, v145
    v_cvt_pk_bf16_f32 v33, v146, v147
    v_mul_f32 v20, s48, v152
    v_mul_f32 v21, s48, v153
    v_mul_f32 v22, s48, v154
    v_mul_f32 v23, s48, v155
    v_exp_f32 v20, v20
    v_exp_f32 v21, v21
    v_exp_f32 v22, v22
    v_exp_f32 v23, v23
    v_add_f32 v20, 1.0, v20
    v_add_f32 v21, 1.0, v21
    v_add_f32 v22, 1.0, v22
    v_add_f32 v23, 1.0, v23
    v_rcp_f32 v20, v20
    v_rcp_f32 v21, v21
    v_rcp_f32 v22, v22
    v_rcp_f32 v23, v23
    v_mul_f32 v152, v152, v224
    v_mul_f32 v153, v153, v225
    v_mul_f32 v154, v154, v226
    v_mul_f32 v155, v155, v227
    v_mul_f32 v152, v152, v20
    v_mul_f32 v153, v153, v21
    v_mul_f32 v154, v154, v22
    v_mul_f32 v155, v155, v23
    v_cvt_pk_bf16_f32 v34, v152, v153
    v_cvt_pk_bf16_f32 v35, v154, v155
    buffer_store_dwordx4 v[32:35], v6, s[28:31], s49 offen offset:0 sc1
    v_mul_f32 v20, s48, v148
    v_mul_f32 v21, s48, v149
    v_mul_f32 v22, s48, v150
    v_mul_f32 v23, s48, v151
    v_exp_f32 v20, v20
    v_exp_f32 v21, v21
    v_exp_f32 v22, v22
    v_exp_f32 v23, v23
    v_add_f32 v20, 1.0, v20
    v_add_f32 v21, 1.0, v21
    v_add_f32 v22, 1.0, v22
    v_add_f32 v23, 1.0, v23
    v_rcp_f32 v20, v20
    v_rcp_f32 v21, v21
    v_rcp_f32 v22, v22
    v_rcp_f32 v23, v23
    v_mul_f32 v148, v148, v220
    v_mul_f32 v149, v149, v221
    v_mul_f32 v150, v150, v222
    v_mul_f32 v151, v151, v223
    v_mul_f32 v148, v148, v20
    v_mul_f32 v149, v149, v21
    v_mul_f32 v150, v150, v22
    v_mul_f32 v151, v151, v23
    v_cvt_pk_bf16_f32 v36, v148, v149
    v_cvt_pk_bf16_f32 v37, v150, v151
    v_mul_f32 v20, s48, v156
    v_mul_f32 v21, s48, v157
    v_mul_f32 v22, s48, v158
    v_mul_f32 v23, s48, v159
    v_exp_f32 v20, v20
    v_exp_f32 v21, v21
    v_exp_f32 v22, v22
    v_exp_f32 v23, v23
    v_add_f32 v20, 1.0, v20
    v_add_f32 v21, 1.0, v21
    v_add_f32 v22, 1.0, v22
    v_add_f32 v23, 1.0, v23
    v_rcp_f32 v20, v20
    v_rcp_f32 v21, v21
    v_rcp_f32 v22, v22
    v_rcp_f32 v23, v23
    v_mul_f32 v156, v156, v228
    v_mul_f32 v157, v157, v229
    v_mul_f32 v158, v158, v230
    v_mul_f32 v159, v159, v231
    v_mul_f32 v156, v156, v20
    v_mul_f32 v157, v157, v21
    v_mul_f32 v158, v158, v22
    v_mul_f32 v159, v159, v23
    v_cvt_pk_bf16_f32 v38, v156, v157
    v_cvt_pk_bf16_f32 v39, v158, v159
    buffer_store_dwordx4 v[36:39], v6, s[28:31], s49 offen offset:512 sc1
    s_add_u32 s49, s49, 131072
    v_mul_f32 v20, s48, v160
    v_mul_f32 v21, s48, v161
    v_mul_f32 v22, s48, v162
    v_mul_f32 v23, s48, v163
    v_exp_f32 v20, v20
    v_exp_f32 v21, v21
    v_exp_f32 v22, v22
    v_exp_f32 v23, v23
    v_add_f32 v20, 1.0, v20
    v_add_f32 v21, 1.0, v21
    v_add_f32 v22, 1.0, v22
    v_add_f32 v23, 1.0, v23
    v_rcp_f32 v20, v20
    v_rcp_f32 v21, v21
    v_rcp_f32 v22, v22
    v_rcp_f32 v23, v23
    v_mul_f32 v160, v160, v232
    v_mul_f32 v161, v161, v233
    v_mul_f32 v162, v162, v234
    v_mul_f32 v163, v163, v235
    v_mul_f32 v160, v160, v20
    v_mul_f32 v161, v161, v21
    v_mul_f32 v162, v162, v22
    v_mul_f32 v163, v163, v23
    v_cvt_pk_bf16_f32 v40, v160, v161
    v_cvt_pk_bf16_f32 v41, v162, v163
    v_mul_f32 v20, s48, v168
    v_mul_f32 v21, s48, v169
    v_mul_f32 v22, s48, v170
    v_mul_f32 v23, s48, v171
    v_exp_f32 v20, v20
    v_exp_f32 v21, v21
    v_exp_f32 v22, v22
    v_exp_f32 v23, v23
    v_add_f32 v20, 1.0, v20
    v_add_f32 v21, 1.0, v21
    v_add_f32 v22, 1.0, v22
    v_add_f32 v23, 1.0, v23
    v_rcp_f32 v20, v20
    v_rcp_f32 v21, v21
    v_rcp_f32 v22, v22
    v_rcp_f32 v23, v23
    v_mul_f32 v168, v168, v240
    v_mul_f32 v169, v169, v241
    v_mul_f32 v170, v170, v242
    v_mul_f32 v171, v171, v243
    v_mul_f32 v168, v168, v20
    v_mul_f32 v169, v169, v21
    v_mul_f32 v170, v170, v22
    v_mul_f32 v171, v171, v23
    v_cvt_pk_bf16_f32 v42, v168, v169
    v_cvt_pk_bf16_f32 v43, v170, v171
    buffer_store_dwordx4 v[40:43], v6, s[28:31], s49 offen offset:0 sc1
    v_mul_f32 v20, s48, v164
    v_mul_f32 v21, s48, v165
    v_mul_f32 v22, s48, v166
    v_mul_f32 v23, s48, v167
    v_exp_f32 v20, v20
    v_exp_f32 v21, v21
    v_exp_f32 v22, v22
    v_exp_f32 v23, v23
    v_add_f32 v20, 1.0, v20
    v_add_f32 v21, 1.0, v21
    v_add_f32 v22, 1.0, v22
    v_add_f32 v23, 1.0, v23
    v_rcp_f32 v20, v20
    v_rcp_f32 v21, v21
    v_rcp_f32 v22, v22
    v_rcp_f32 v23, v23
    v_mul_f32 v164, v164, v236
    v_mul_f32 v165, v165, v237
    v_mul_f32 v166, v166, v238
    v_mul_f32 v167, v167, v239
    v_mul_f32 v164, v164, v20
    v_mul_f32 v165, v165, v21
    v_mul_f32 v166, v166, v22
    v_mul_f32 v167, v167, v23
    v_cvt_pk_bf16_f32 v44, v164, v165
    v_cvt_pk_bf16_f32 v45, v166, v167
    v_mul_f32 v20, s48, v172
    v_mul_f32 v21, s48, v173
    v_mul_f32 v22, s48, v174
    v_mul_f32 v23, s48, v175
    v_exp_f32 v20, v20
    v_exp_f32 v21, v21
    v_exp_f32 v22, v22
    v_exp_f32 v23, v23
    v_add_f32 v20, 1.0, v20
    v_add_f32 v21, 1.0, v21
    v_add_f32 v22, 1.0, v22
    v_add_f32 v23, 1.0, v23
    v_rcp_f32 v20, v20
    v_rcp_f32 v21, v21
    v_rcp_f32 v22, v22
    v_rcp_f32 v23, v23
    v_mul_f32 v172, v172, v244
    v_mul_f32 v173, v173, v245
    v_mul_f32 v174, v174, v246
    v_mul_f32 v175, v175, v247
    v_mul_f32 v172, v172, v20
    v_mul_f32 v173, v173, v21
    v_mul_f32 v174, v174, v22
    v_mul_f32 v175, v175, v23
    v_cvt_pk_bf16_f32 v46, v172, v173
    v_cvt_pk_bf16_f32 v47, v174, v175
    buffer_store_dwordx4 v[44:47], v6, s[28:31], s49 offen offset:512 sc1
    s_add_u32 s49, s49, 131072
    v_mul_f32 v20, s48, v176
    v_mul_f32 v21, s48, v177
    v_mul_f32 v22, s48, v178
    v_mul_f32 v23, s48, v179
    v_exp_f32 v20, v20
    v_exp_f32 v21, v21
    v_exp_f32 v22, v22
    v_exp_f32 v23, v23
    v_add_f32 v20, 1.0, v20
    v_add_f32 v21, 1.0, v21
    v_add_f32 v22, 1.0, v22
    v_add_f32 v23, 1.0, v23
    v_rcp_f32 v20, v20
    v_rcp_f32 v21, v21
    v_rcp_f32 v22, v22
    v_rcp_f32 v23, v23
    v_mul_f32 v176, v176, v248
    v_mul_f32 v177, v177, v249
    v_mul_f32 v178, v178, v250
    v_mul_f32 v179, v179, v251
    v_mul_f32 v176, v176, v20
    v_mul_f32 v177, v177, v21
    v_mul_f32 v178, v178, v22
    v_mul_f32 v179, v179, v23
    v_cvt_pk_bf16_f32 v32, v176, v177
    v_cvt_pk_bf16_f32 v33, v178, v179
    buffer_store_dwordx2 v[32:33], v7, s[28:31], s49 offen offset:0 sc1
    v_mul_f32 v20, s48, v180
    v_mul_f32 v21, s48, v181
    v_mul_f32 v22, s48, v182
    v_mul_f32 v23, s48, v183
    v_exp_f32 v20, v20
    v_exp_f32 v21, v21
    v_exp_f32 v22, v22
    v_exp_f32 v23, v23
    v_add_f32 v20, 1.0, v20
    v_add_f32 v21, 1.0, v21
    v_add_f32 v22, 1.0, v22
    v_add_f32 v23, 1.0, v23
    v_rcp_f32 v20, v20
    v_rcp_f32 v21, v21
    v_rcp_f32 v22, v22
    v_rcp_f32 v23, v23
    v_mul_f32 v180, v180, v252
    v_mul_f32 v181, v181, v253
    v_mul_f32 v182, v182, v254
    v_mul_f32 v183, v183, v255
    v_mul_f32 v180, v180, v20
    v_mul_f32 v181, v181, v21
    v_mul_f32 v182, v182, v22
    v_mul_f32 v183, v183, v23
    v_cvt_pk_bf16_f32 v36, v180, v181
    v_cvt_pk_bf16_f32 v37, v182, v183
    buffer_store_dwordx2 v[36:37], v7, s[28:31], s49 offen offset:512 sc1
    s_waitcnt vmcnt(0)
    s_barrier
    s_cmp_lg_u32 s32, 0
    s_cbranch_scc1 L_ws_k5_ffn1_kernel_out
    s_lshl_b32 s96, s2, 7
    s_add_u32 s96, s96, 125927424
    v_mov_b32 v16, 1
    v_mov_b32 v17, 0
    s_mov_b64 exec, 1
    buffer_store_dword v16, v17, s[28:31], s96 offen sc1
    s_mov_b64 exec, -1
L_ws_k5_ffn1_kernel_out:
    s_load_dwordx2 s[8:9], s[0:1], 72
    s_load_dwordx2 s[12:13], s[0:1], 96
    s_load_dwordx2 s[90:91], s[0:1], 88
    s_load_dwordx2 s[4:5], s[0:1], 80
    v_lshrrev_b32 v1, 6, v0
    v_and_b32 v2, 63, v0
    s_nop 0
    v_readfirstlane_b32 s32, v1
    s_and_b32 s48, s2, 7
    s_lshr_b32 s49, s2, 3
    s_lshr_b32 s33, s48, 1
    s_lshr_b32 s50, s49, 2
    s_sub_u32 s34, 15, s50
    s_bitcmp1_b32 s48, 0
    s_cselect_b32 s34, s34, s50
    s_and_b32 s35, s49, 3
    s_and_b32 s36, s32, 3
    s_lshr_b32 s37, s32, 2
    s_waitcnt lgkmcnt(0)
    s_mov_b32 s20, s8
    s_and_b32 s21, s9, 0xffff
    s_mov_b32 s22, 5308416
    s_mov_b32 s23, 0x00020000
    s_mov_b32 s47, 5308416
    s_mov_b32 s16, s12
    s_and_b32 s17, s13, 0xffff
    s_mov_b32 s18, 268435456
    s_mov_b32 s19, 0x00020000
    s_mov_b32 s46, 268435456
    s_mov_b32 s28, s12
    s_and_b32 s29, s13, 0xffff
    s_mov_b32 s30, 268435456
    s_mov_b32 s31, 0x00020000
    s_mov_b32 s92, s90
    s_and_b32 s93, s91, 0xffff
    s_mov_b32 s94, 256
    s_mov_b32 s95, 0x00020000
    s_lshr_b32 s48, s32, 1
    s_lshl_b32 s48, s48, 16
    s_and_b32 s49, s32, 1
    s_lshl_b32 s49, s49, 11
    s_add_u32 s48, s48, s49
    v_lshlrev_b32 v20, 4, v2
    v_add_u32 v64, s48, v20
    s_mul_i32 s38, s33, 4718592
    s_lshl_b32 s48, s34, 12
    s_add_u32 s38, s38, s48
    s_add_u32 s38, s38, 83886080
    v_add_u32 v20, 0, v2
    v_mul_u32_u24 v21, 3641, v20
    v_lshrrev_b32 v21, 16, v21
    v_mul_u32_u24 v23, 18, v21
    v_sub_u32 v22, v20, v23
    v_and_b32 v23, 1, v22
    v_bfe_u32 v24, v22, 1, 1
    v_lshl_or_b32 v23, v23, 1, v24
    v_and_b32 v24, 28, v22
    v_or_b32 v23, v23, v24
    v_cmp_gt_u32 vcc, 16, v22
    s_nop 1
    v_cndmask_b32 v22, v22, v23, vcc
    s_lshl_b32 s48, s32, 3
    v_add_u32 v21, s48, v21
    v_mul_u32_u24 v21, 1152, v21
    v_lshl_add_u32 v66, v22, 4, v21
    v_add_u32 v20, 64, v2
    v_mul_u32_u24 v21, 3641, v20
    v_lshrrev_b32 v21, 16, v21
    v_mul_u32_u24 v23, 18, v21
    v_sub_u32 v22, v20, v23
    v_and_b32 v23, 1, v22
    v_bfe_u32 v24, v22, 1, 1
    v_lshl_or_b32 v23, v23, 1, v24
    v_and_b32 v24, 28, v22
    v_or_b32 v23, v23, v24
    v_cmp_gt_u32 vcc, 16, v22
    s_nop 1
    v_cndmask_b32 v22, v22, v23, vcc
    s_lshl_b32 s48, s32, 3
    v_add_u32 v21, s48, v21
    v_mul_u32_u24 v21, 1152, v21
    v_lshl_add_u32 v67, v22, 4, v21
    v_add_u32 v20, 128, v2
    v_mul_u32_u24 v21, 3641, v20
    v_lshrrev_b32 v21, 16, v21
    v_mul_u32_u24 v23, 18, v21
    v_sub_u32 v22, v20, v23
    v_and_b32 v23, 1, v22
    v_bfe_u32 v24, v22, 1, 1
    v_lshl_or_b32 v23, v23, 1, v24
    v_and_b32 v24, 28, v22
    v_or_b32 v23, v23, v24
    v_cmp_gt_u32 vcc, 16, v22
    s_nop 1
    v_cndmask_b32 v22, v22, v23, vcc
    s_lshl_b32 s48, s32, 3
    v_add_u32 v21, s48, v21
    v_mul_u32_u24 v21, 1152, v21
    v_lshl_add_u32 v68, v22, 4, v21
    s_mul_i32 s39, s33, 1327104
    s_mul_i32 s48, s35, 288
    s_add_u32 s39, s39, s48
    s_lshl_b32 s40, s32, 11
    s_mul_i32 s41, s32, 2304
    s_add_u32 s41, s41, 65536
    v_and_b32 v62, 15, v2
    v_lshrrev_b32 v61, 4, v2
    v_lshrrev_b32 v20, 1, v61
    s_lshl_b32 s48, s37, 1
    v_add_u32 v20, s48, v20
    v_lshlrev_b32 v20, 12, v20
    s_lshl_b32 s48, s36, 5
    v_add_u32 v21, s48, v62
    v_lshl_add_u32 v20, v21, 5, v20
    v_and_b32 v21, 1, v61
    v_lshl_add_u32 v70, v21, 4, v20
    v_lshrrev_b32 v20, 5, v2
    v_lshlrev_b32 v20, 4, v20
    v_bfe_u32 v21, v2, 2, 3
    v_add_u32 v20, v20, v21
    s_lshl_b32 s48, s37, 5
    v_add_u32 v20, s48, v20
    v_mul_u32_u24 v20, 288, v20
    v_add_u32 v20, 65536, v20
    v_and_b32 v21, 3, v2
    v_lshl_add_u32 v71, v21, 3, v20
    v_and_b32 v22, 1, v2
    v_lshl_add_u32 v20, v22, 4, v20
    v_bfe_u32 v22, v2, 1, 1
    v_lshl_add_u32 v69, v22, 3, v20
    s_mov_b32 s44, 0
    s_mov_b32 s53, 0
    s_mov_b32 s57, 0
    s_add_u32 m0, s53, s41
    s_nop 0
    buffer_load_dwordx4 v66, s[20:23], s39 offen lds
    s_add_u32 m0, m0, 1024
    s_nop 0
    buffer_load_dwordx4 v67, s[20:23], s39 offen lds
    s_add_u32 m0, m0, 1024
    s_mov_b64 exec, 0xffff
    buffer_load_dwordx4 v68, s[20:23], s39 offen lds
    s_mov_b64 exec, -1
    s_add_u32 s39, s39, 73728
    s_add_u32 s53, s53, 18432
    s_cmp_eq_u32 s53, 73728
    s_cselect_b32 s53, 0, s53
    s_add_u32 m0, s53, s41
    s_nop 0
    buffer_load_dwordx4 v66, s[20:23], s39 offen lds
    s_add_u32 m0, m0, 1024
    s_nop 0
    buffer_load_dwordx4 v67, s[20:23], s39 offen lds
    s_add_u32 m0, m0, 1024
    s_mov_b64 exec, 0xffff
    buffer_load_dwordx4 v68, s[20:23], s39 offen lds
    s_mov_b64 exec, -1
    s_add_u32 s39, s39, 73728
    s_add_u32 s53, s53, 18432
    s_cmp_eq_u32 s53, 73728
    s_cselect_b32 s53, 0, s53
    s_add_u32 m0, s53, s41
    s_nop 0
    buffer_load_dwordx4 v66, s[20:23], s39 offen lds
    s_add_u32 m0, m0, 1024
    s_nop 0
    buffer_load_dwordx4 v67, s[20:23], s39 offen lds
    s_add_u32 m0, m0, 1024
    s_mov_b64 exec, 0xffff
    buffer_load_dwordx4 v68, s[20:23], s39 offen lds
    s_mov_b64 exec, -1
    s_add_u32 s39, s39, 73728
    s_add_u32 s53, s53, 18432
    s_cmp_eq_u32 s53, 73728
    s_cselect_b32 s53, 0, s53
    s_cmp_lg_u32 s32, 0
    s_cbranch_scc1 L_ww_k67c_in_done
    v_and_b32 v16, 63, v0
    v_and_b32 v19, 3, v16
    v_lshrrev_b32 v17, 2, v16
    v_lshl_add_u32 v17, v19, 3, v17
    s_andn2_b32 s48, s2, 31
    s_lshl_b32 s49, s33, 1
    s_add_u32 s48, s48, s49
    v_add_u32 v17, s48, v17
    v_lshlrev_b32 v17, 7, v17
    s_mov_b32 s97, 125927424
    s_mov_b32 s96, 0x100000
    s_mov_b64 exec, 255
L_ww_k67c_in_loop:
    buffer_load_dword v18, v17, s[28:31], s97 offen sc1
    s_waitcnt vmcnt(0)
    v_cmp_ne_u32 vcc, 1, v18
    s_nop 1
    s_cbranch_vccz L_ww_k67c_in_ok
    s_sleep 2
    s_sub_u32 s96, s96, 1
    s_cmp_lg_u32 s96, 0
    s_cbranch_scc1 L_ww_k67c_in_loop
L_ww_k67c_in_ok:
    s_mov_b64 exec, -1
L_ww_k67c_in_done:
    s_barrier
    s_add_u32 m0, s57, s40
    s_nop 0
    buffer_load_dwordx4 v64, s[16:19], s38 offen lds
    buffer_load_dwordx4 v64, s[16:19], s38 offen offset:1024 lds
    s_add_u32 s38, s38, 262144
    s_add_u32 s44, s44, 1
    s_cmp_lt_u32 s44, 18
    s_cselect_b32 s18, s46, 0
    s_cselect_b32 s22, s47, 0
    s_add_u32 s57, s57, 16384
    s_cmp_eq_u32 s57, 65536
    s_cselect_b32 s57, 0, s57
    s_add_u32 m0, s57, s40
    s_nop 0
    buffer_load_dwordx4 v64, s[16:19], s38 offen lds
    buffer_load_dwordx4 v64, s[16:19], s38 offen offset:1024 lds
    s_add_u32 s38, s38, 262144
    s_add_u32 s44, s44, 1
    s_cmp_lt_u32 s44, 18
    s_cselect_b32 s18, s46, 0
    s_cselect_b32 s22, s47, 0
    s_add_u32 s57, s57, 16384
    s_cmp_eq_u32 s57, 65536
    s_cselect_b32 s57, 0, s57
    s_add_u32 m0, s57, s40
    s_nop 0
    buffer_load_dwordx4 v64, s[16:19], s38 offen lds
    buffer_load_dwordx4 v64, s[16:19], s38 offen offset:1024 lds
    s_add_u32 s38, s38, 262144
    s_add_u32 s44, s44, 1
    s_cmp_lt_u32 s44, 18
    s_cselect_b32 s18, s46, 0
    s_cselect_b32 s22, s47, 0
    s_add_u32 s57, s57, 16384
    s_cmp_eq_u32 s57, 65536
    s_cselect_b32 s57, 0, s57
    v_mov_b32 v128, 0
    v_mov_b32 v129, 0
    v_mov_b32 v130, 0
    v_mov_b32 v131, 0
    v_mov_b32 v132, 0
    v_mov_b32 v133, 0
    v_mov_b32 v134, 0
    v_mov_b32 v135, 0
    v_mov_b32 v136, 0
    v_mov_b32 v137, 0
    v_mov_b32 v138, 0
    v_mov_b32 v139, 0
    v_mov_b32 v140, 0
    v_mov_b32 v141, 0
    v_mov_b32 v142, 0
    v_mov_b32 v143, 0
    v_mov_b32 v144, 0
    v_mov_b32 v145, 0
    v_mov_b32 v146, 0
    v_mov_b32 v147, 0
    v_mov_b32 v148, 0
    v_mov_b32 v149, 0
    v_mov_b32 v150, 0
    v_mov_b32 v151, 0
    v_mov_b32 v152, 0
    v_mov_b32 v153, 0
    v_mov_b32 v154, 0
    v_mov_b32 v155, 0
    v_mov_b32 v156, 0
    v_mov_b32 v157, 0
    v_mov_b32 v158, 0
    v_mov_b32 v159, 0
    v_mov_b32 v160, 0
    v_mov_b32 v161, 0
    v_mov_b32 v162, 0
    v_mov_b32 v163, 0
    v_mov_b32 v164, 0
    v_mov_b32 v165, 0
    v_mov_b32 v166, 0
    v_mov_b32 v167, 0
    v_mov_b32 v168, 0
    v_mov_b32 v169, 0
    v_mov_b32 v170, 0
    v_mov_b32 v171, 0
    v_mov_b32 v172, 0
    v_mov_b32 v173, 0
    v_mov_b32 v174, 0
    v_mov_b32 v175, 0
    v_mov_b32 v176, 0
    v_mov_b32 v177, 0
    v_mov_b32 v178, 0
    v_mov_b32 v179, 0
    v_mov_b32 v180, 0
    v_mov_b32 v181, 0
    v_mov_b32 v182, 0
    v_mov_b32 v183, 0
    v_mov_b32 v184, 0
    v_mov_b32 v185, 0
    v_mov_b32 v186, 0
    v_mov_b32 v187, 0
    v_mov_b32 v188, 0
    v_mov_b32 v189, 0
    v_mov_b32 v190, 0
    v_mov_b32 v191, 0
    v_mov_b32 v192, 0
    v_mov_b32 v193, 0
    v_mov_b32 v194, 0
    v_mov_b32 v195, 0
    v_mov_b32 v196, 0
    v_mov_b32 v197, 0
    v_mov_b32 v198, 0
    v_mov_b32 v199, 0
    s_mov_b32 s51, 18432
    s_mov_b32 s54, 18432
    s_mov_b32 s52, 0
    s_mov_b32 s55, 16384
    s_mov_b32 s58, 16384
    s_mov_b32 s56, 0
    s_waitcnt vmcnt(2)
    s_barrier
    ds_read_b128 v[112:115], v70 offset:0
    ds_read_b128 v[116:119], v70 offset:512
    v_add_u32 v70, s55, v70
    ds_read_b64_tr_b16 v[200:201], v71 offset:0
    ds_read_b64_tr_b16 v[202:203], v71 offset:2304
    ds_read_b64_tr_b16 v[204:205], v71 offset:32
    ds_read_b64_tr_b16 v[206:207], v71 offset:2336
    ds_read_b64_tr_b16 v[208:209], v71 offset:64
    ds_read_b64_tr_b16 v[210:211], v71 offset:2368
    ds_read_b64_tr_b16 v[212:213], v71 offset:96
    ds_read_b64_tr_b16 v[214:215], v71 offset:2400
    ds_read_b64_tr_b16 v[216:217], v71 offset:128
    ds_read_b64_tr_b16 v[218:219], v71 offset:2432
    s_mov_b32 s45, 9
L_k67c_loop:
    s_waitcnt vmcnt(5)
    s_barrier
    s_mov_b32 s50, s51
    s_add_u32 s52, s52, 1
    s_cmp_eq_u32 s52, 4
    s_cselect_b32 s52, 0, s52
    s_cmp_eq_u32 s52, 3
    s_cselect_b32 s51, 4294912000, s54
    s_add_u32 s56, s56, 1
    s_cmp_eq_u32 s56, 4
    s_cselect_b32 s56, 0, s56
    s_cmp_eq_u32 s56, 3
    s_cselect_b32 s55, 4294918144, s58
    ds_read_b64_tr_b16 v[220:221], v71 offset:160
    ds_read_b64_tr_b16 v[222:223], v71 offset:2464
    ds_read_b128 v[120:123], v70 offset:0
    s_waitcnt lgkmcnt(11)
    v_mfma_f32_16x16x32_bf16 v[128:131], v[200:203], v[112:115], v[128:131]
    s_add_u32 m0, s53, s41
    s_nop 0
    buffer_load_dwordx4 v66, s[20:23], s39 offen lds
    v_mfma_f32_16x16x32_bf16 v[132:135], v[200:203], v[116:119], v[132:135]
    ds_read_b64_tr_b16 v[200:201], v71 offset:192
    ds_read_b64_tr_b16 v[202:203], v71 offset:2496
    ds_read_b128 v[124:127], v70 offset:512
    v_add_u32 v70, s55, v70
    s_waitcnt lgkmcnt(12)
    v_mfma_f32_16x16x32_bf16 v[136:139], v[204:207], v[112:115], v[136:139]
    s_add_u32 m0, m0, 1024
    s_nop 0
    buffer_load_dwordx4 v67, s[20:23], s39 offen lds
    v_mfma_f32_16x16x32_bf16 v[140:143], v[204:207], v[116:119], v[140:143]
    ds_read_b64_tr_b16 v[204:205], v71 offset:224
    ds_read_b64_tr_b16 v[206:207], v71 offset:2528
    v_add_u32 v71, s50, v71
    s_waitcnt lgkmcnt(12)
    v_mfma_f32_16x16x32_bf16 v[144:147], v[208:211], v[112:115], v[144:147]
    v_mfma_f32_16x16x32_bf16 v[148:151], v[208:211], v[116:119], v[148:151]
    s_add_u32 m0, m0, 1024
    s_mov_b64 exec, 0xffff
    buffer_load_dwordx4 v68, s[20:23], s39 offen lds
    s_mov_b64 exec, -1
    s_add_u32 s39, s39, 73728
    s_add_u32 s53, s53, 18432
    s_cmp_eq_u32 s53, 73728
    s_cselect_b32 s53, 0, s53
    ds_read_b64_tr_b16 v[208:209], v69 offset:256
    ds_read_b64_tr_b16 v[210:211], v69 offset:2560
    v_add_u32 v69, s50, v69
    s_waitcnt lgkmcnt(12)
    v_mfma_f32_16x16x32_bf16 v[152:155], v[212:215], v[112:115], v[152:155]
    v_mfma_f32_16x16x32_bf16 v[156:159], v[212:215], v[116:119], v[156:159]
    ds_read_b64_tr_b16 v[212:213], v71 offset:0
    ds_read_b64_tr_b16 v[214:215], v71 offset:2304
    s_waitcnt lgkmcnt(12)
    v_mfma_f32_16x16x32_bf16 v[160:163], v[216:219], v[112:115], v[160:163]
    s_add_u32 m0, s57, s40
    s_nop 0
    buffer_load_dwordx4 v64, s[16:19], s38 offen lds
    v_mfma_f32_16x16x32_bf16 v[164:167], v[216:219], v[116:119], v[164:167]
    ds_read_b64_tr_b16 v[216:217], v71 offset:32
    ds_read_b64_tr_b16 v[218:219], v71 offset:2336
    s_waitcnt lgkmcnt(12)
    v_mfma_f32_16x16x32_bf16 v[168:171], v[220:223], v[112:115], v[168:171]
    v_mfma_f32_16x16x32_bf16 v[172:175], v[220:223], v[116:119], v[172:175]
    buffer_load_dwordx4 v64, s[16:19], s38 offen offset:1024 lds
    s_add_u32 s38, s38, 262144
    s_add_u32 s44, s44, 1
    s_cmp_lt_u32 s44, 18
    s_cselect_b32 s18, s46, 0
    s_cselect_b32 s22, s47, 0
    s_add_u32 s57, s57, 16384
    s_cmp_eq_u32 s57, 65536
    s_cselect_b32 s57, 0, s57
    ds_read_b64_tr_b16 v[220:221], v71 offset:64
    ds_read_b64_tr_b16 v[222:223], v71 offset:2368
    s_waitcnt lgkmcnt(11)
    v_mfma_f32_16x16x32_bf16 v[176:179], v[200:203], v[112:115], v[176:179]
    v_mfma_f32_16x16x32_bf16 v[180:183], v[200:203], v[116:119], v[180:183]
    ds_read_b64_tr_b16 v[200:201], v71 offset:96
    ds_read_b64_tr_b16 v[202:203], v71 offset:2400
    s_waitcnt lgkmcnt(10)
    v_mfma_f32_16x16x32_bf16 v[184:187], v[204:207], v[112:115], v[184:187]
    v_mfma_f32_16x16x32_bf16 v[188:191], v[204:207], v[116:119], v[188:191]
    ds_read_b64_tr_b16 v[204:205], v71 offset:128
    ds_read_b64_tr_b16 v[206:207], v71 offset:2432
    s_waitcnt lgkmcnt(10)
    v_mfma_f32_16x16x32_bf16 v[192:195], v[208:211], v[112:115], v[192:195]
    v_mfma_f32_16x16x32_bf16 v[196:199], v[208:211], v[116:119], v[196:199]
    s_waitcnt vmcnt(5)
    s_barrier
    s_mov_b32 s50, s51
    s_add_u32 s52, s52, 1
    s_cmp_eq_u32 s52, 4
    s_cselect_b32 s52, 0, s52
    s_cmp_eq_u32 s52, 3
    s_cselect_b32 s51, 4294912000, s54
    s_add_u32 s56, s56, 1
    s_cmp_eq_u32 s56, 4
    s_cselect_b32 s56, 0, s56
    s_cmp_eq_u32 s56, 3
    s_cselect_b32 s55, 4294918144, s58
    ds_read_b64_tr_b16 v[208:209], v71 offset:160
    ds_read_b64_tr_b16 v[210:211], v71 offset:2464
    ds_read_b128 v[112:115], v70 offset:0
    s_waitcnt lgkmcnt(11)
    v_mfma_f32_16x16x32_bf16 v[128:131], v[212:215], v[120:123], v[128:131]
    s_add_u32 m0, s53, s41
    s_nop 0
    buffer_load_dwordx4 v66, s[20:23], s39 offen lds
    v_mfma_f32_16x16x32_bf16 v[132:135], v[212:215], v[124:127], v[132:135]
    ds_read_b64_tr_b16 v[212:213], v71 offset:192
    ds_read_b64_tr_b16 v[214:215], v71 offset:2496
    ds_read_b128 v[116:119], v70 offset:512
    v_add_u32 v70, s55, v70
    s_waitcnt lgkmcnt(12)
    v_mfma_f32_16x16x32_bf16 v[136:139], v[216:219], v[120:123], v[136:139]
    s_add_u32 m0, m0, 1024
    s_nop 0
    buffer_load_dwordx4 v67, s[20:23], s39 offen lds
    v_mfma_f32_16x16x32_bf16 v[140:143], v[216:219], v[124:127], v[140:143]
    ds_read_b64_tr_b16 v[216:217], v71 offset:224
    ds_read_b64_tr_b16 v[218:219], v71 offset:2528
    v_add_u32 v71, s50, v71
    s_waitcnt lgkmcnt(12)
    v_mfma_f32_16x16x32_bf16 v[144:147], v[220:223], v[120:123], v[144:147]
    v_mfma_f32_16x16x32_bf16 v[148:151], v[220:223], v[124:127], v[148:151]
    s_add_u32 m0, m0, 1024
    s_mov_b64 exec, 0xffff
    buffer_load_dwordx4 v68, s[20:23], s39 offen lds
    s_mov_b64 exec, -1
    s_add_u32 s39, s39, 73728
    s_add_u32 s53, s53, 18432
    s_cmp_eq_u32 s53, 73728
    s_cselect_b32 s53, 0, s53
    ds_read_b64_tr_b16 v[220:221], v69 offset:256
    ds_read_b64_tr_b16 v[222:223], v69 offset:2560
    v_add_u32 v69, s50, v69
    s_waitcnt lgkmcnt(12)
    v_mfma_f32_16x16x32_bf16 v[152:155], v[200:203], v[120:123], v[152:155]
    v_mfma_f32_16x16x32_bf16 v[156:159], v[200:203], v[124:127], v[156:159]
    ds_read_b64_tr_b16 v[200:201], v71 offset:0
    ds_read_b64_tr_b16 v[202:203], v71 offset:2304
    s_waitcnt lgkmcnt(12)
    v_mfma_f32_16x16x32_bf16 v[160:163], v[204:207], v[120:123], v[160:163]
    s_add_u32 m0, s57, s40
    s_nop 0
    buffer_load_dwordx4 v64, s[16:19], s38 offen lds
    v_mfma_f32_16x16x32_bf16 v[164:167], v[204:207], v[124:127], v[164:167]
    ds_read_b64_tr_b16 v[204:205], v71 offset:32
    ds_read_b64_tr_b16 v[206:207], v71 offset:2336
    s_waitcnt lgkmcnt(12)
    v_mfma_f32_16x16x32_bf16 v[168:171], v[208:211], v[120:123], v[168:171]
    v_mfma_f32_16x16x32_bf16 v[172:175], v[208:211], v[124:127], v[172:175]
    buffer_load_dwordx4 v64, s[16:19], s38 offen offset:1024 lds
    s_add_u32 s38, s38, 262144
    s_add_u32 s44, s44, 1
    s_cmp_lt_u32 s44, 18
    s_cselect_b32 s18, s46, 0
    s_cselect_b32 s22, s47, 0
    s_add_u32 s57, s57, 16384
    s_cmp_eq_u32 s57, 65536
    s_cselect_b32 s57, 0, s57
    ds_read_b64_tr_b16 v[208:209], v71 offset:64
    ds_read_b64_tr_b16 v[210:211], v71 offset:2368
    s_waitcnt lgkmcnt(11)
    v_mfma_f32_16x16x32_bf16 v[176:179], v[212:215], v[120:123], v[176:179]
    v_mfma_f32_16x16x32_bf16 v[180:183], v[212:215], v[124:127], v[180:183]
    ds_read_b64_tr_b16 v[212:213], v71 offset:96
    ds_read_b64_tr_b16 v[214:215], v71 offset:2400
    s_waitcnt lgkmcnt(10)
    v_mfma_f32_16x16x32_bf16 v[184:187], v[216:219], v[120:123], v[184:187]
    v_mfma_f32_16x16x32_bf16 v[188:191], v[216:219], v[124:127], v[188:191]
    ds_read_b64_tr_b16 v[216:217], v71 offset:128
    ds_read_b64_tr_b16 v[218:219], v71 offset:2432
    s_waitcnt lgkmcnt(10)
    v_mfma_f32_16x16x32_bf16 v[192:195], v[220:223], v[120:123], v[192:195]
    v_mfma_f32_16x16x32_bf16 v[196:199], v[220:223], v[124:127], v[196:199]
    s_sub_u32 s45, s45, 1
    s_cmp_lg_u32 s45, 0
    s_cbranch_scc1 L_k67c_loop
    s_waitcnt lgkmcnt(0)
    s_nop 7
    s_nop 7
    s_waitcnt vmcnt(0)
    s_barrier
    s_mul_i32 s48, s32, 9216
    s_xor_b32 s49, s32, 4
    s_mul_i32 s49, s49, 9216
    v_lshlrev_b32 v3, 4, v2
    v_add_u32 v4, s49, v3
    v_add_u32 v3, s48, v3
    s_cmp_eq_u32 s37, 1
    s_cbranch_scc1 L_k67c_e1
    ds_write_b128 v3, v[132:135] offset:0
    ds_write_b128 v3, v[140:143] offset:1024
    ds_write_b128 v3, v[148:151] offset:2048
    ds_write_b128 v3, v[156:159] offset:3072
    ds_write_b128 v3, v[164:167] offset:4096
    ds_write_b128 v3, v[172:175] offset:5120
    ds_write_b128 v3, v[180:183] offset:6144
    ds_write_b128 v3, v[188:191] offset:7168
    ds_write_b128 v3, v[196:199] offset:8192
    s_branch L_k67c_e2
L_k67c_e1:
    ds_write_b128 v3, v[128:131] offset:0
    ds_write_b128 v3, v[136:139] offset:1024
    ds_write_b128 v3, v[144:147] offset:2048
    ds_write_b128 v3, v[152:155] offset:3072
    ds_write_b128 v3, v[160:163] offset:4096
    ds_write_b128 v3, v[168:171] offset:5120
    ds_write_b128 v3, v[176:179] offset:6144
    ds_write_b128 v3, v[184:187] offset:7168
    ds_write_b128 v3, v[192:195] offset:8192
    v_mov_b32 v128, v132
    v_mov_b32 v129, v133
    v_mov_b32 v130, v134
    v_mov_b32 v131, v135
    v_mov_b32 v136, v140
    v_mov_b32 v137, v141
    v_mov_b32 v138, v142
    v_mov_b32 v139, v143
    v_mov_b32 v144, v148
    v_mov_b32 v145, v149
    v_mov_b32 v146, v150
    v_mov_b32 v147, v151
    v_mov_b32 v152, v156
    v_mov_b32 v153, v157
    v_mov_b32 v154, v158
    v_mov_b32 v155, v159
    v_mov_b32 v160, v164
    v_mov_b32 v161, v165
    v_mov_b32 v162, v166
    v_mov_b32 v163, v167
    v_mov_b32 v168, v172
    v_mov_b32 v169, v173
    v_mov_b32 v170, v174
    v_mov_b32 v171, v175
    v_mov_b32 v176, v180
    v_mov_b32 v177, v181
    v_mov_b32 v178, v182
    v_mov_b32 v179, v183
    v_mov_b32 v184, v188
    v_mov_b32 v185, v189
    v_mov_b32 v186, v190
    v_mov_b32 v187, v191
    v_mov_b32 v192, v196
    v_mov_b32 v193, v197
    v_mov_b32 v194, v198
    v_mov_b32 v195, v199
L_k67c_e2:
    s_waitcnt lgkmcnt(0)
    s_barrier
    ds_read_b128 v[132:135], v4 offset:0
    ds_read_b128 v[140:143], v4 offset:1024
    ds_read_b128 v[148:151], v4 offset:2048
    ds_read_b128 v[156:159], v4 offset:3072
    ds_read_b128 v[164:167], v4 offset:4096
    ds_read_b128 v[172:175], v4 offset:5120
    ds_read_b128 v[180:183], v4 offset:6144
    ds_read_b128 v[188:191], v4 offset:7168
    ds_read_b128 v[196:199], v4 offset:8192
    s_mul_i32 s48, s33, 2621440
    s_lshl_b32 s49, s34, 7
    s_lshl_b32 s50, s36, 5
    s_add_u32 s49, s49, s50
    s_lshl_b32 s50, s37, 4
    s_add_u32 s49, s49, s50
    s_mul_i32 s49, s49, 1280
    s_add_u32 s48, s48, s49
    s_mul_i32 s49, s35, 320
    s_add_u32 s48, s48, s49
    s_add_u32 s48, s48, 134217728
    v_mul_u32_u24 v5, 1280, v62
    v_lshl_add_u32 v6, v61, 3, v5
    v_lshl_add_u32 v5, v61, 4, v5
    s_waitcnt lgkmcnt(8)
    v_add_f32 v128, v128, v132
    v_add_f32 v129, v129, v133
    v_add_f32 v130, v130, v134
    v_add_f32 v131, v131, v135
    v_cvt_pk_bf16_f32 v8, v128, v129
    v_cvt_pk_bf16_f32 v9, v130, v131
    s_waitcnt lgkmcnt(7)
    v_add_f32 v136, v136, v140
    v_add_f32 v137, v137, v141
    v_add_f32 v138, v138, v142
    v_add_f32 v139, v139, v143
    v_cvt_pk_bf16_f32 v10, v136, v137
    v_cvt_pk_bf16_f32 v11, v138, v139
    buffer_store_dwordx4 v[8:11], v5, s[28:31], s48 offen offset:0 sc1
    s_waitcnt lgkmcnt(6)
    v_add_f32 v144, v144, v148
    v_add_f32 v145, v145, v149
    v_add_f32 v146, v146, v150
    v_add_f32 v147, v147, v151
    v_cvt_pk_bf16_f32 v12, v144, v145
    v_cvt_pk_bf16_f32 v13, v146, v147
    s_waitcnt lgkmcnt(5)
    v_add_f32 v152, v152, v156
    v_add_f32 v153, v153, v157
    v_add_f32 v154, v154, v158
    v_add_f32 v155, v155, v159
    v_cvt_pk_bf16_f32 v14, v152, v153
    v_cvt_pk_bf16_f32 v15, v154, v155
    buffer_store_dwordx4 v[12:15], v5, s[28:31], s48 offen offset:64 sc1
    s_waitcnt lgkmcnt(4)
    v_add_f32 v160, v160, v164
    v_add_f32 v161, v161, v165
    v_add_f32 v162, v162, v166
    v_add_f32 v163, v163, v167
    v_cvt_pk_bf16_f32 v16, v160, v161
    v_cvt_pk_bf16_f32 v17, v162, v163
    s_waitcnt lgkmcnt(3)
    v_add_f32 v168, v168, v172
    v_add_f32 v169, v169, v173
    v_add_f32 v170, v170, v174
    v_add_f32 v171, v171, v175
    v_cvt_pk_bf16_f32 v18, v168, v169
    v_cvt_pk_bf16_f32 v19, v170, v171
    buffer_store_dwordx4 v[16:19], v5, s[28:31], s48 offen offset:128 sc1
    s_waitcnt lgkmcnt(2)
    v_add_f32 v176, v176, v180
    v_add_f32 v177, v177, v181
    v_add_f32 v178, v178, v182
    v_add_f32 v179, v179, v183
    v_cvt_pk_bf16_f32 v20, v176, v177
    v_cvt_pk_bf16_f32 v21, v178, v179
    s_waitcnt lgkmcnt(1)
    v_add_f32 v184, v184, v188
    v_add_f32 v185, v185, v189
    v_add_f32 v186, v186, v190
    v_add_f32 v187, v187, v191
    v_cvt_pk_bf16_f32 v22, v184, v185
    v_cvt_pk_bf16_f32 v23, v186, v187
    buffer_store_dwordx4 v[20:23], v5, s[28:31], s48 offen offset:192 sc1
    s_waitcnt lgkmcnt(0)
    v_add_f32 v192, v192, v196
    v_add_f32 v193, v193, v197
    v_add_f32 v194, v194, v198
    v_add_f32 v195, v195, v199
    v_cvt_pk_bf16_f32 v24, v192, v193
    v_cvt_pk_bf16_f32 v25, v194, v195
    buffer_store_dwordx2 v[24:25], v6, s[28:31], s48 offen offset:256 sc1
    s_waitcnt vmcnt(0)
    s_barrier
    s_cmp_lg_u32 s32, 0
    s_cbranch_scc1 L_ws_k67c
    s_lshl_b32 s96, s2, 7
    s_add_u32 s96, s96, 125861888
    v_mov_b32 v16, 1
    v_mov_b32 v17, 0
    s_mov_b64 exec, 1
    buffer_store_dword v16, v17, s[28:31], s96 offen sc1
    s_mov_b64 exec, -1
L_ws_k67c:
    s_cmp_lg_u32 s32, 0
    s_cbranch_scc1 L_ww_k67c_done
    v_and_b32 v16, 63, v0
    v_lshrrev_b32 v19, 2, v16
    v_and_b32 v17, 3, v16
    v_lshlrev_b32 v17, 1, v17
    v_lshl_add_u32 v17, v19, 3, v17
    s_andn2_b32 s48, s2, 31
    s_lshr_b32 s49, s34, 3
    s_add_u32 s48, s48, s49
    v_add_u32 v17, s48, v17
    v_lshlrev_b32 v17, 7, v17
    s_mov_b32 s97, 125861888
    s_mov_b32 s96, 0x100000
    s_mov_b64 exec, 65535
L_ww_k67c_loop:
    buffer_load_dword v18, v17, s[28:31], s97 offen sc1
    s_waitcnt vmcnt(0)
    v_cmp_ne_u32 vcc, 1, v18
    s_nop 1
    s_cbranch_vccz L_ww_k67c_ok
    s_sleep 2
    s_sub_u32 s96, s96, 1
    s_cmp_lg_u32 s96, 0
    s_cbranch_scc1 L_ww_k67c_loop
L_ww_k67c_ok:
    s_mov_b64 exec, -1
L_ww_k67c_done:
    s_barrier
    s_lshl_b32 s49, s35, 2
    s_add_u32 s49, s49, s33
    s_lshl_b32 s49, s49, 3
    s_add_u32 s49, s49, s32
    s_lshl_b32 s48, s34, 7
    s_add_u32 s49, s49, s48
    v_lshrrev_b32 v3, 1, v2
    v_lshlrev_b32 v3, 4, v3
    v_and_b32 v4, 1, v2
    v_lshl_add_u32 v3, v4, 2, v3
    v_mul_u32_u24 v6, 3641, v2
    v_lshrrev_b32 v6, 16, v6
    v_mul_u32_u24 v8, 18, v6
    v_sub_u32 v7, v2, v8
    v_mul_u32_u24 v6, 320, v6
    v_lshl_add_u32 v4, v7, 4, v6
    v_add_u32 v8, 64, v2
    v_lshlrev_b32 v9, 4, v2
    v_add_u32 v9, 1120, v9
    v_lshlrev_b32 v5, 1, v3
    s_mul_i32 s50, s49, 1280
    s_add_u32 s50, s50, 134217728
    s_mul_i32 s51, s49, 1152
    s_waitcnt lgkmcnt(0)
    s_mov_b32 s24, s4
    s_and_b32 s25, s5, 0xffff
    s_mov_b32 s26, 2359296
    s_mov_b32 s27, 0x00020000
    s_mov_b32 s28, s12
    s_and_b32 s29, s13, 0xffff
    s_mov_b32 s30, 268435456
    s_mov_b32 s31, 0x00020000
    v_mov_b32 v80, 0
    v_mov_b32 v81, 0
    v_mov_b32 v82, 0
    v_mov_b32 v83, 0
    v_mov_b32 v84, 0
    v_mov_b32 v85, 0
    v_mov_b32 v86, 0
    v_mov_b32 v87, 0
    v_mov_b32 v88, 0
    v_mov_b32 v89, 0
    v_mov_b32 v90, 0
    v_mov_b32 v91, 0
    v_mov_b32 v92, 0
    v_mov_b32 v93, 0
    v_mov_b32 v94, 0
    v_mov_b32 v95, 0
    v_mov_b32 v96, 0
    v_mov_b32 v97, 0
    v_mov_b32 v98, 0
    v_mov_b32 v99, 0
    v_mov_b32 v100, 0
    v_mov_b32 v101, 0
    v_mov_b32 v102, 0
    v_mov_b32 v103, 0
    v_mov_b32 v104, 0
    v_mov_b32 v105, 0
    v_mov_b32 v106, 0
    v_mov_b32 v107, 0
    v_mov_b32 v108, 0
    v_mov_b32 v109, 0
    v_mov_b32 v110, 0
    v_mov_b32 v111, 0
    v_mov_b32 v112, 0
    v_mov_b32 v113, 0
    v_mov_b32 v114, 0
    v_mov_b32 v115, 0
    v_mov_b32 v116, 0
    v_mov_b32 v117, 0
    v_mov_b32 v118, 0
    v_mov_b32 v119, 0
    buffer_load_dwordx4 v[88:91], v4, s[28:31], s50 offen sc1
    s_mov_b64 exec, 0xff
    buffer_load_dwordx4 v[92:95], v9, s[28:31], s50 offen sc1
    s_mov_b64 exec, -1
    s_add_u32 s50, s50, 2621440
    buffer_load_dwordx4 v[96:99], v4, s[28:31], s50 offen sc1
    s_mov_b64 exec, 0xff
    buffer_load_dwordx4 v[100:103], v9, s[28:31], s50 offen sc1
    s_mov_b64 exec, -1
    s_add_u32 s50, s50, 2621440
    buffer_load_dwordx4 v[104:107], v4, s[28:31], s50 offen sc1
    s_mov_b64 exec, 0xff
    buffer_load_dwordx4 v[108:111], v9, s[28:31], s50 offen sc1
    s_mov_b64 exec, -1
    s_add_u32 s50, s50, 2621440
    buffer_load_dwordx4 v[112:115], v4, s[28:31], s50 offen sc1
    s_mov_b64 exec, 0xff
    buffer_load_dwordx4 v[116:119], v9, s[28:31], s50 offen sc1
    s_mov_b64 exec, -1
    s_add_u32 s52, s51, 75497472
    buffer_load_dwordx2 v[80:81], v5, s[28:31], s52 offen
    buffer_load_dwordx2 v[82:83], v5, s[28:31], s52 offen offset:16
    s_mov_b64 exec, 0xff
    buffer_load_dwordx2 v[84:85], v5, s[28:31], s52 offen offset:1024
    buffer_load_dwordx2 v[86:87], v5, s[28:31], s52 offen offset:1040
    s_mov_b64 exec, -1
    s_waitcnt vmcnt(0)
    v_lshlrev_b32 v16, 16, v88
    v_and_b32 v17, 0xffff0000, v88
    v_lshlrev_b32 v18, 16, v89
    v_and_b32 v19, 0xffff0000, v89
    v_lshlrev_b32 v20, 16, v90
    v_and_b32 v21, 0xffff0000, v90
    v_lshlrev_b32 v22, 16, v91
    v_and_b32 v23, 0xffff0000, v91
    v_lshlrev_b32 v24, 16, v92
    v_and_b32 v25, 0xffff0000, v92
    v_lshlrev_b32 v26, 16, v93
    v_and_b32 v27, 0xffff0000, v93
    v_lshlrev_b32 v28, 16, v94
    v_and_b32 v29, 0xffff0000, v94
    v_lshlrev_b32 v30, 16, v95
    v_and_b32 v31, 0xffff0000, v95
    v_lshlrev_b32 v32, 16, v96
    v_and_b32 v33, 0xffff0000, v96
    v_lshlrev_b32 v34, 16, v97
    v_and_b32 v35, 0xffff0000, v97
    v_lshlrev_b32 v36, 16, v98
    v_and_b32 v37, 0xffff0000, v98
    v_lshlrev_b32 v38, 16, v99
    v_and_b32 v39, 0xffff0000, v99
    v_lshlrev_b32 v40, 16, v100
    v_and_b32 v41, 0xffff0000, v100
    v_lshlrev_b32 v42, 16, v101
    v_and_b32 v43, 0xffff0000, v101
    v_lshlrev_b32 v44, 16, v102
    v_and_b32 v45, 0xffff0000, v102
    v_lshlrev_b32 v46, 16, v103
    v_and_b32 v47, 0xffff0000, v103
    v_lshlrev_b32 v48, 16, v104
    v_and_b32 v49, 0xffff0000, v104
    v_lshlrev_b32 v50, 16, v105
    v_and_b32 v51, 0xffff0000, v105
    v_lshlrev_b32 v52, 16, v106
    v_and_b32 v53, 0xffff0000, v106
    v_lshlrev_b32 v54, 16, v107
    v_and_b32 v55, 0xffff0000, v107
    v_lshlrev_b32 v56, 16, v108
    v_and_b32 v57, 0xffff0000, v108
    v_lshlrev_b32 v58, 16, v109
    v_and_b32 v59, 0xffff0000, v109
    v_lshlrev_b32 v60, 16, v110
    v_and_b32 v61, 0xffff0000, v110
    v_lshlrev_b32 v62, 16, v111
    v_and_b32 v63, 0xffff0000, v111
    v_lshlrev_b32 v64, 16, v112
    v_and_b32 v65, 0xffff0000, v112
    v_lshlrev_b32 v66, 16, v113
    v_and_b32 v67, 0xffff0000, v113
    v_lshlrev_b32 v68, 16, v114
    v_and_b32 v69, 0xffff0000, v114
    v_lshlrev_b32 v70, 16, v115
    v_and_b32 v71, 0xffff0000, v115
    v_lshlrev_b32 v72, 16, v116
    v_and_b32 v73, 0xffff0000, v116
    v_lshlrev_b32 v74, 16, v117
    v_and_b32 v75, 0xffff0000, v117
    v_lshlrev_b32 v76, 16, v118
    v_and_b32 v77, 0xffff0000, v118
    v_lshlrev_b32 v78, 16, v119
    v_and_b32 v79, 0xffff0000, v119
    v_add_f32 v16, v16, v32
    v_add_f32 v48, v48, v64
    v_add_f32 v17, v17, v33
    v_add_f32 v49, v49, v65
    v_add_f32 v18, v18, v34
    v_add_f32 v50, v50, v66
    v_add_f32 v19, v19, v35
    v_add_f32 v51, v51, v67
    v_add_f32 v20, v20, v36
    v_add_f32 v52, v52, v68
    v_add_f32 v21, v21, v37
    v_add_f32 v53, v53, v69
    v_add_f32 v22, v22, v38
    v_add_f32 v54, v54, v70
    v_add_f32 v23, v23, v39
    v_add_f32 v55, v55, v71
    v_add_f32 v24, v24, v40
    v_add_f32 v56, v56, v72
    v_add_f32 v25, v25, v41
    v_add_f32 v57, v57, v73
    v_add_f32 v26, v26, v42
    v_add_f32 v58, v58, v74
    v_add_f32 v27, v27, v43
    v_add_f32 v59, v59, v75
    v_add_f32 v28, v28, v44
    v_add_f32 v60, v60, v76
    v_add_f32 v29, v29, v45
    v_add_f32 v61, v61, v77
    v_add_f32 v30, v30, v46
    v_add_f32 v62, v62, v78
    v_add_f32 v31, v31, v47
    v_add_f32 v63, v63, v79
    v_add_f32 v16, v16, v48
    v_add_f32 v17, v17, v49
    v_add_f32 v18, v18, v50
    v_add_f32 v19, v19, v51
    v_add_f32 v20, v20, v52
    v_add_f32 v21, v21, v53
    v_add_f32 v22, v22, v54
    v_add_f32 v23, v23, v55
    v_add_f32 v24, v24, v56
    v_add_f32 v25, v25, v57
    v_add_f32 v26, v26, v58
    v_add_f32 v27, v27, v59
    v_add_f32 v28, v28, v60
    v_add_f32 v29, v29, v61
    v_add_f32 v30, v30, v62
    v_add_f32 v31, v31, v63
    v_cvt_pk_bf16_f32 v6, v16, v17
    v_lshlrev_b32 v16, 16, v6
    v_and_b32 v17, 0xffff0000, v6
    v_lshlrev_b32 v6, 16, v80
    v_and_b32 v7, 0xffff0000, v80
    v_add_f32 v16, v16, v6
    v_add_f32 v17, v17, v7
    v_cvt_pk_bf16_f32 v80, v16, v17
    v_cvt_pk_bf16_f32 v6, v18, v19
    v_lshlrev_b32 v18, 16, v6
    v_and_b32 v19, 0xffff0000, v6
    v_lshlrev_b32 v6, 16, v81
    v_and_b32 v7, 0xffff0000, v81
    v_add_f32 v18, v18, v6
    v_add_f32 v19, v19, v7
    v_cvt_pk_bf16_f32 v81, v18, v19
    v_cvt_pk_bf16_f32 v6, v20, v21
    v_lshlrev_b32 v20, 16, v6
    v_and_b32 v21, 0xffff0000, v6
    v_lshlrev_b32 v6, 16, v82
    v_and_b32 v7, 0xffff0000, v82
    v_add_f32 v20, v20, v6
    v_add_f32 v21, v21, v7
    v_cvt_pk_bf16_f32 v82, v20, v21
    v_cvt_pk_bf16_f32 v6, v22, v23
    v_lshlrev_b32 v22, 16, v6
    v_and_b32 v23, 0xffff0000, v6
    v_lshlrev_b32 v6, 16, v83
    v_and_b32 v7, 0xffff0000, v83
    v_add_f32 v22, v22, v6
    v_add_f32 v23, v23, v7
    v_cvt_pk_bf16_f32 v83, v22, v23
    v_cvt_pk_bf16_f32 v6, v24, v25
    v_lshlrev_b32 v24, 16, v6
    v_and_b32 v25, 0xffff0000, v6
    v_lshlrev_b32 v6, 16, v84
    v_and_b32 v7, 0xffff0000, v84
    v_add_f32 v24, v24, v6
    v_add_f32 v25, v25, v7
    v_cvt_pk_bf16_f32 v84, v24, v25
    v_cvt_pk_bf16_f32 v6, v26, v27
    v_lshlrev_b32 v26, 16, v6
    v_and_b32 v27, 0xffff0000, v6
    v_lshlrev_b32 v6, 16, v85
    v_and_b32 v7, 0xffff0000, v85
    v_add_f32 v26, v26, v6
    v_add_f32 v27, v27, v7
    v_cvt_pk_bf16_f32 v85, v26, v27
    v_cvt_pk_bf16_f32 v6, v28, v29
    v_lshlrev_b32 v28, 16, v6
    v_and_b32 v29, 0xffff0000, v6
    v_lshlrev_b32 v6, 16, v86
    v_and_b32 v7, 0xffff0000, v86
    v_add_f32 v28, v28, v6
    v_add_f32 v29, v29, v7
    v_cvt_pk_bf16_f32 v86, v28, v29
    v_cvt_pk_bf16_f32 v6, v30, v31
    v_lshlrev_b32 v30, 16, v6
    v_and_b32 v31, 0xffff0000, v6
    v_lshlrev_b32 v6, 16, v87
    v_and_b32 v7, 0xffff0000, v87
    v_add_f32 v30, v30, v6
    v_add_f32 v31, v31, v7
    v_cvt_pk_bf16_f32 v87, v30, v31
    v_and_b32 v6, 1, v2
    v_cmp_eq_u32 vcc, 1, v6
    v_lshlrev_b32 v7, 4, v2
    s_nop 0
    v_cndmask_b32 v16, v82, v80, vcc
    v_cndmask_b32 v17, v83, v81, vcc
    s_nop 1
    v_mov_b32_dpp v18, v16 quad_perm:[1,0,3,2] row_mask:0xf bank_mask:0xf
    v_mov_b32_dpp v19, v17 quad_perm:[1,0,3,2] row_mask:0xf bank_mask:0xf
    v_cndmask_b32 v80, v80, v18, vcc
    v_cndmask_b32 v81, v81, v19, vcc
    v_cndmask_b32 v82, v18, v82, vcc
    v_cndmask_b32 v83, v19, v83, vcc
    v_cndmask_b32 v16, v86, v84, vcc
    v_cndmask_b32 v17, v87, v85, vcc
    s_nop 1
    v_mov_b32_dpp v18, v16 quad_perm:[1,0,3,2] row_mask:0xf bank_mask:0xf
    v_mov_b32_dpp v19, v17 quad_perm:[1,0,3,2] row_mask:0xf bank_mask:0xf
    v_cndmask_b32 v84, v84, v18, vcc
    v_cndmask_b32 v85, v85, v19, vcc
    v_cndmask_b32 v86, v18, v86, vcc
    v_cndmask_b32 v87, v19, v87, vcc
    buffer_store_dwordx4 v[80:83], v7, s[24:27], s51 offen sc1
    s_mov_b64 exec, 0xff
    buffer_store_dwordx4 v[84:87], v7, s[24:27], s51 offen offset:1024 sc1
    s_mov_b64 exec, -1
L_k67c_end:
    s_endpgm
L_k2_p0_mask:
    s_sub_i32 s48, s48, 0
    v_add_u32 v11, s48, v46
    v_mov_b32 v10, 4048155338
    s_nop 7
    v_cmp_le_i32 s[60:61], 0, v11
    v_cmp_le_i32 s[62:63], 1, v11
    v_cmp_le_i32 s[64:65], 2, v11
    v_cndmask_b32 v160, v10, v160, s[60:61]
    v_cmp_le_i32 s[60:61], 3, v11
    v_cndmask_b32 v161, v10, v161, s[62:63]
    v_cmp_le_i32 s[62:63], 8, v11
    v_cndmask_b32 v162, v10, v162, s[64:65]
    v_cmp_le_i32 s[64:65], 9, v11
    v_cndmask_b32 v163, v10, v163, s[60:61]
    v_cmp_le_i32 s[60:61], 10, v11
    v_cndmask_b32 v164, v10, v164, s[62:63]
    v_cmp_le_i32 s[62:63], 11, v11
    v_cndmask_b32 v165, v10, v165, s[64:65]
    v_cmp_le_i32 s[64:65], 16, v11
    v_cndmask_b32 v166, v10, v166, s[60:61]
    v_cmp_le_i32 s[60:61], 17, v11
    v_cndmask_b32 v167, v10, v167, s[62:63]
    v_cmp_le_i32 s[62:63], 18, v11
    v_cndmask_b32 v168, v10, v168, s[64:65]
    v_cmp_le_i32 s[64:65], 19, v11
    v_cndmask_b32 v169, v10, v169, s[60:61]
    v_cmp_le_i32 s[60:61], 24, v11
    v_cndmask_b32 v170, v10, v170, s[62:63]
    v_cmp_le_i32 s[62:63], 25, v11
    v_cndmask_b32 v171, v10, v171, s[64:65]
    v_cmp_le_i32 s[64:65], 26, v11
    v_cndmask_b32 v172, v10, v172, s[60:61]
    v_cmp_le_i32 s[60:61], 27, v11
    v_cndmask_b32 v173, v10, v173, s[62:63]
    s_nop 0
    v_cndmask_b32 v174, v10, v174, s[64:65]
    s_nop 0
    v_cndmask_b32 v175, v10, v175, s[60:61]
    s_branch L_k2_p0_nomask
L_k2_fin_small:
    v_mov_b32 v10, v44
    v_mov_b32 v11, v44
    s_lshl_b32 s48, s33, 14
    s_add_u32 s48, s48, s52
    s_lshl_b32 s48, s48, 5
    s_add_u32 s48, s48, 37748736
    v_and_b32 v3, 31, v2
    v_lshrrev_b32 v4, 5, v2
    v_lshlrev_b32 v3, 5, v3
    v_lshl_add_u32 v3, v4, 4, v3
    v_permlane32_swap_b32 v10, v11
    s_nop 1
    v_add_f32 v10, v10, v11
    v_rcp_f32 v10, v10
    s_nop 0
    v_mul_f32 v192, v192, v10
    v_mul_f32 v193, v193, v10
    v_mul_f32 v194, v194, v10
    v_mul_f32 v195, v195, v10
    v_mul_f32 v196, v196, v10
    v_mul_f32 v197, v197, v10
    v_mul_f32 v198, v198, v10
    v_mul_f32 v199, v199, v10
    v_cvt_pk_bf16_f32 v192, v192, v193
    v_cvt_pk_bf16_f32 v193, v194, v195
    v_cvt_pk_bf16_f32 v194, v196, v197
    v_cvt_pk_bf16_f32 v195, v198, v199
    buffer_store_dwordx4 v[192:195], v3, s[20:23], s48 offen sc1
    s_add_u32 s48, s48, 65536
    v_mul_f32 v200, v200, v10
    v_mul_f32 v201, v201, v10
    v_mul_f32 v202, v202, v10
    v_mul_f32 v203, v203, v10
    v_mul_f32 v204, v204, v10
    v_mul_f32 v205, v205, v10
    v_mul_f32 v206, v206, v10
    v_mul_f32 v207, v207, v10
    v_cvt_pk_bf16_f32 v200, v200, v201
    v_cvt_pk_bf16_f32 v201, v202, v203
    v_cvt_pk_bf16_f32 v202, v204, v205
    v_cvt_pk_bf16_f32 v203, v206, v207
    buffer_store_dwordx4 v[200:203], v3, s[20:23], s48 offen sc1
    s_add_u32 s48, s48, 65536
    v_mul_f32 v208, v208, v10
    v_mul_f32 v209, v209, v10
    v_mul_f32 v210, v210, v10
    v_mul_f32 v211, v211, v10
    v_mul_f32 v212, v212, v10
    v_mul_f32 v213, v213, v10
    v_mul_f32 v214, v214, v10
    v_mul_f32 v215, v215, v10
    v_cvt_pk_bf16_f32 v208, v208, v209
    v_cvt_pk_bf16_f32 v209, v210, v211
    v_cvt_pk_bf16_f32 v210, v212, v213
    v_cvt_pk_bf16_f32 v211, v214, v215
    buffer_store_dwordx4 v[208:211], v3, s[20:23], s48 offen sc1
    s_add_u32 s48, s48, 65536
    v_mul_f32 v216, v216, v10
    v_mul_f32 v217, v217, v10
    v_mul_f32 v218, v218, v10
    v_mul_f32 v219, v219, v10
    v_mul_f32 v220, v220, v10
    v_mul_f32 v221, v221, v10
    v_mul_f32 v222, v222, v10
    v_mul_f32 v223, v223, v10
    v_cvt_pk_bf16_f32 v216, v216, v217
    v_cvt_pk_bf16_f32 v217, v218, v219
    v_cvt_pk_bf16_f32 v218, v220, v221
    v_cvt_pk_bf16_f32 v219, v222, v223
    buffer_store_dwordx4 v[216:219], v3, s[20:23], s48 offen sc1
    s_add_u32 s48, s48, 65536
    v_mul_f32 v224, v224, v10
    v_mul_f32 v225, v225, v10
    v_mul_f32 v226, v226, v10
    v_mul_f32 v227, v227, v10
    v_mul_f32 v228, v228, v10
    v_mul_f32 v229, v229, v10
    v_mul_f32 v230, v230, v10
    v_mul_f32 v231, v231, v10
    v_cvt_pk_bf16_f32 v224, v224, v225
    v_cvt_pk_bf16_f32 v225, v226, v227
    v_cvt_pk_bf16_f32 v226, v228, v229
    v_cvt_pk_bf16_f32 v227, v230, v231
    buffer_store_dwordx4 v[224:227], v3, s[20:23], s48 offen sc1
    s_add_u32 s48, s48, 65536
    v_mul_f32 v232, v232, v10
    v_mul_f32 v233, v233, v10
    v_mul_f32 v234, v234, v10
    v_mul_f32 v235, v235, v10
    v_mul_f32 v236, v236, v10
    v_mul_f32 v237, v237, v10
    v_mul_f32 v238, v238, v10
    v_mul_f32 v239, v239, v10
    v_cvt_pk_bf16_f32 v232, v232, v233
    v_cvt_pk_bf16_f32 v233, v234, v235
    v_cvt_pk_bf16_f32 v234, v236, v237
    v_cvt_pk_bf16_f32 v235, v238, v239
    buffer_store_dwordx4 v[232:235], v3, s[20:23], s48 offen sc1
    s_add_u32 s48, s48, 65536
    v_mul_f32 v240, v240, v10
    v_mul_f32 v241, v241, v10
    v_mul_f32 v242, v242, v10
    v_mul_f32 v243, v243, v10
    v_mul_f32 v244, v244, v10
    v_mul_f32 v245, v245, v10
    v_mul_f32 v246, v246, v10
    v_mul_f32 v247, v247, v10
    v_cvt_pk_bf16_f32 v240, v240, v241
    v_cvt_pk_bf16_f32 v241, v242, v243
    v_cvt_pk_bf16_f32 v242, v244, v245
    v_cvt_pk_bf16_f32 v243, v246, v247
    buffer_store_dwordx4 v[240:243], v3, s[20:23], s48 offen sc1
    s_add_u32 s48, s48, 65536
    v_mul_f32 v248, v248, v10
    v_mul_f32 v249, v249, v10
    v_mul_f32 v250, v250, v10
    v_mul_f32 v251, v251, v10
    v_mul_f32 v252, v252, v10
    v_mul_f32 v253, v253, v10
    v_mul_f32 v254, v254, v10
    v_mul_f32 v255, v255, v10
    v_cvt_pk_bf16_f32 v248, v248, v249
    v_cvt_pk_bf16_f32 v249, v250, v251
    v_cvt_pk_bf16_f32 v250, v252, v253
    v_cvt_pk_bf16_f32 v251, v254, v255
    buffer_store_dwordx4 v[248:251], v3, s[20:23], s48 offen sc1
    s_add_u32 s48, s48, 65536
    s_nop 1
    v_mov_b32 v192, 0
    v_mov_b32 v193, 0
    v_mov_b32 v194, 0
    v_mov_b32 v195, 0
    v_mov_b32 v196, 0
    v_mov_b32 v197, 0
    v_mov_b32 v198, 0
    v_mov_b32 v199, 0
    v_mov_b32 v200, 0
    v_mov_b32 v201, 0
    v_mov_b32 v202, 0
    v_mov_b32 v203, 0
    v_mov_b32 v204, 0
    v_mov_b32 v205, 0
    v_mov_b32 v206, 0
    v_mov_b32 v207, 0
    v_mov_b32 v208, 0
    v_mov_b32 v209, 0
    v_mov_b32 v210, 0
    v_mov_b32 v211, 0
    v_mov_b32 v212, 0
    v_mov_b32 v213, 0
    v_mov_b32 v214, 0
    v_mov_b32 v215, 0
    v_mov_b32 v216, 0
    v_mov_b32 v217, 0
    v_mov_b32 v218, 0
    v_mov_b32 v219, 0
    v_mov_b32 v220, 0
    v_mov_b32 v221, 0
    v_mov_b32 v222, 0
    v_mov_b32 v223, 0
    v_mov_b32 v224, 0
    v_mov_b32 v225, 0
    v_mov_b32 v226, 0
    v_mov_b32 v227, 0
    v_mov_b32 v228, 0
    v_mov_b32 v229, 0
    v_mov_b32 v230, 0
    v_mov_b32 v231, 0
    v_mov_b32 v232, 0
    v_mov_b32 v233, 0
    v_mov_b32 v234, 0
    v_mov_b32 v235, 0
    v_mov_b32 v236, 0
    v_mov_b32 v237, 0
    v_mov_b32 v238, 0
    v_mov_b32 v239, 0
    v_mov_b32 v240, 0
    v_mov_b32 v241, 0
    v_mov_b32 v242, 0
    v_mov_b32 v243, 0
    v_mov_b32 v244, 0
    v_mov_b32 v245, 0
    v_mov_b32 v246, 0
    v_mov_b32 v247, 0
    v_mov_b32 v248, 0
    v_mov_b32 v249, 0
    v_mov_b32 v250, 0
    v_mov_b32 v251, 0
    v_mov_b32 v252, 0
    v_mov_b32 v253, 0
    v_mov_b32 v254, 0
    v_mov_b32 v255, 0
    v_mov_b32 v44, 0
    v_mov_b32 v45, 3769465068
    s_mov_b32 s57, -1.0
    s_branch L_k2_fin_small_done
L_k2_m1_mask:
    s_sub_i32 s48, s48, 32
    v_add_u32 v11, s48, v46
    v_mov_b32 v10, 4048155338
    s_nop 7
    v_cmp_le_i32 s[60:61], 0, v11
    v_cmp_le_i32 s[62:63], 1, v11
    v_cmp_le_i32 s[64:65], 2, v11
    v_cndmask_b32 v176, v10, v176, s[60:61]
    v_cmp_le_i32 s[60:61], 3, v11
    v_cndmask_b32 v177, v10, v177, s[62:63]
    v_cmp_le_i32 s[62:63], 8, v11
    v_cndmask_b32 v178, v10, v178, s[64:65]
    v_cmp_le_i32 s[64:65], 9, v11
    v_cndmask_b32 v179, v10, v179, s[60:61]
    v_cmp_le_i32 s[60:61], 10, v11
    v_cndmask_b32 v180, v10, v180, s[62:63]
    v_cmp_le_i32 s[62:63], 11, v11
    v_cndmask_b32 v181, v10, v181, s[64:65]
    v_cmp_le_i32 s[64:65], 16, v11
    v_cndmask_b32 v182, v10, v182, s[60:61]
    v_cmp_le_i32 s[60:61], 17, v11
    v_cndmask_b32 v183, v10, v183, s[62:63]
    v_cmp_le_i32 s[62:63], 18, v11
    v_cndmask_b32 v184, v10, v184, s[64:65]
    v_cmp_le_i32 s[64:65], 19, v11
    v_cndmask_b32 v185, v10, v185, s[60:61]
    v_cmp_le_i32 s[60:61], 24, v11
    v_cndmask_b32 v186, v10, v186, s[62:63]
    v_cmp_le_i32 s[62:63], 25, v11
    v_cndmask_b32 v187, v10, v187, s[64:65]
    v_cmp_le_i32 s[64:65], 26, v11
    v_cndmask_b32 v188, v10, v188, s[60:61]
    v_cmp_le_i32 s[60:61], 27, v11
    v_cndmask_b32 v189, v10, v189, s[62:63]
    s_nop 0
    v_cndmask_b32 v190, v10, v190, s[64:65]
    s_nop 0
    v_cndmask_b32 v191, v10, v191, s[60:61]
    s_branch L_k2_m1_nomask
L_k2_a_rare:
    s_mov_b32 s57, 65536.0
    s_nop 7
    s_nop 3
    v_max3_f32 v10, v160, v161, v45
    v_max3_f32 v10, v10, v162, v163
    v_max3_f32 v10, v10, v164, v165
    v_max3_f32 v10, v10, v166, v167
    v_max3_f32 v10, v10, v168, v169
    v_max3_f32 v10, v10, v170, v171
    v_max3_f32 v10, v10, v172, v173
    v_max3_f32 v10, v10, v174, v175
    v_mov_b32 v11, v10
    s_nop 1
    v_permlane32_swap_b32 v10, v11
    s_nop 1
    v_max_f32 v10, v10, v11
    v_mov_b32 v45, 0
    v_max_f32 v11, 0, v10
    v_exp_f32 v11, -v11
    v_sub_f32 v160, v160, v10
    v_sub_f32 v161, v161, v10
    v_sub_f32 v162, v162, v10
    v_sub_f32 v163, v163, v10
    v_sub_f32 v164, v164, v10
    v_sub_f32 v165, v165, v10
    v_sub_f32 v166, v166, v10
    v_sub_f32 v167, v167, v10
    v_sub_f32 v168, v168, v10
    v_sub_f32 v169, v169, v10
    v_sub_f32 v170, v170, v10
    v_sub_f32 v171, v171, v10
    v_sub_f32 v172, v172, v10
    v_sub_f32 v173, v173, v10
    v_sub_f32 v174, v174, v10
    v_sub_f32 v175, v175, v10
    v_sub_f32 v176, v176, v10
    v_sub_f32 v177, v177, v10
    v_sub_f32 v178, v178, v10
    v_sub_f32 v179, v179, v10
    v_sub_f32 v180, v180, v10
    v_sub_f32 v181, v181, v10
    v_sub_f32 v182, v182, v10
    v_sub_f32 v183, v183, v10
    v_sub_f32 v184, v184, v10
    v_sub_f32 v185, v185, v10
    v_sub_f32 v186, v186, v10
    v_sub_f32 v187, v187, v10
    v_sub_f32 v188, v188, v10
    v_sub_f32 v189, v189, v10
    v_sub_f32 v190, v190, v10
    v_sub_f32 v191, v191, v10
    v_sub_f32 v112, v112, v10
    v_sub_f32 v113, v113, v10
    v_sub_f32 v114, v114, v10
    v_sub_f32 v115, v115, v10
    v_sub_f32 v116, v116, v10
    v_sub_f32 v117, v117, v10
    v_sub_f32 v118, v118, v10
    v_sub_f32 v119, v119, v10
    v_sub_f32 v120, v120, v10
    v_sub_f32 v121, v121, v10
    v_sub_f32 v122, v122, v10
    v_sub_f32 v123, v123, v10
    v_sub_f32 v124, v124, v10
    v_sub_f32 v125, v125, v10
    v_sub_f32 v126, v126, v10
    v_sub_f32 v127, v127, v10
    v_mul_f32 v192, v192, v11
    v_mul_f32 v193, v193, v11
    v_mul_f32 v194, v194, v11
    v_mul_f32 v195, v195, v11
    v_mul_f32 v196, v196, v11
    v_mul_f32 v197, v197, v11
    v_mul_f32 v198, v198, v11
    v_mul_f32 v199, v199, v11
    v_mul_f32 v200, v200, v11
    v_mul_f32 v201, v201, v11
    v_mul_f32 v202, v202, v11
    v_mul_f32 v203, v203, v11
    v_mul_f32 v204, v204, v11
    v_mul_f32 v205, v205, v11
    v_mul_f32 v206, v206, v11
    v_mul_f32 v207, v207, v11
    v_mul_f32 v208, v208, v11
    v_mul_f32 v209, v209, v11
    v_mul_f32 v210, v210, v11
    v_mul_f32 v211, v211, v11
    v_mul_f32 v212, v212, v11
    v_mul_f32 v213, v213, v11
    v_mul_f32 v214, v214, v11
    v_mul_f32 v215, v215, v11
    v_mul_f32 v216, v216, v11
    v_mul_f32 v217, v217, v11
    v_mul_f32 v218, v218, v11
    v_mul_f32 v219, v219, v11
    v_mul_f32 v220, v220, v11
    v_mul_f32 v221, v221, v11
    v_mul_f32 v222, v222, v11
    v_mul_f32 v223, v223, v11
    v_mul_f32 v224, v224, v11
    v_mul_f32 v225, v225, v11
    v_mul_f32 v226, v226, v11
    v_mul_f32 v227, v227, v11
    v_mul_f32 v228, v228, v11
    v_mul_f32 v229, v229, v11
    v_mul_f32 v230, v230, v11
    v_mul_f32 v231, v231, v11
    v_mul_f32 v232, v232, v11
    v_mul_f32 v233, v233, v11
    v_mul_f32 v234, v234, v11
    v_mul_f32 v235, v235, v11
    v_mul_f32 v236, v236, v11
    v_mul_f32 v237, v237, v11
    v_mul_f32 v238, v238, v11
    v_mul_f32 v239, v239, v11
    v_mul_f32 v240, v240, v11
    v_mul_f32 v241, v241, v11
    v_mul_f32 v242, v242, v11
    v_mul_f32 v243, v243, v11
    v_mul_f32 v244, v244, v11
    v_mul_f32 v245, v245, v11
    v_mul_f32 v246, v246, v11
    v_mul_f32 v247, v247, v11
    v_mul_f32 v248, v248, v11
    v_mul_f32 v249, v249, v11
    v_mul_f32 v250, v250, v11
    v_mul_f32 v251, v251, v11
    v_mul_f32 v252, v252, v11
    v_mul_f32 v253, v253, v11
    v_mul_f32 v254, v254, v11
    v_mul_f32 v255, v255, v11
    v_mul_f32 v44, v44, v11
    v_exp_f32 v48, v160
    v_exp_f32 v49, v161
    v_exp_f32 v50, v162
    v_exp_f32 v51, v163
    v_add_f32 v8, v48, v49
    v_cvt_pk_bf16_f32 v96, v48, v49
    v_exp_f32 v52, v164
    v_add_f32 v8, v8, v50
    v_add_f32 v8, v8, v51
    v_exp_f32 v53, v165
    v_cvt_pk_bf16_f32 v97, v50, v51
    v_add_f32 v8, v8, v52
    v_exp_f32 v54, v166
    v_add_f32 v8, v8, v53
    v_cvt_pk_bf16_f32 v98, v52, v53
    v_exp_f32 v55, v167
    v_add_f32 v8, v8, v54
    v_add_f32 v8, v8, v55
    v_cvt_pk_bf16_f32 v99, v54, v55
    s_nop 0
    v_exp_f32 v48, v168
    v_exp_f32 v49, v169
    v_exp_f32 v50, v170
    v_exp_f32 v51, v171
    v_add_f32 v8, v8, v48
    v_add_f32 v8, v8, v49
    v_exp_f32 v52, v172
    v_cvt_pk_bf16_f32 v100, v48, v49
    v_add_f32 v8, v8, v50
    v_exp_f32 v53, v173
    v_add_f32 v8, v8, v51
    v_cvt_pk_bf16_f32 v101, v50, v51
    v_exp_f32 v54, v174
    v_add_f32 v8, v8, v52
    v_add_f32 v8, v8, v53
    v_exp_f32 v55, v175
    v_cvt_pk_bf16_f32 v102, v52, v53
    v_add_f32 v8, v8, v54
    v_add_f32 v8, v8, v55
    v_cvt_pk_bf16_f32 v103, v54, v55
    s_nop 0
    s_branch L_k2_a_go
L_k2_sw1:
    ds_read_b128 v[128:131], v22 offset:0
    ds_read_b128 v[132:135], v22 offset:1024
    ds_read_b128 v[136:139], v22 offset:2048
    ds_read_b128 v[140:143], v22 offset:3072
    ds_read_b128 v[144:147], v22 offset:4096
    ds_read_b128 v[148:151], v22 offset:5120
    ds_read_b128 v[152:155], v22 offset:6144
    ds_read_b128 v[156:159], v22 offset:7168
    s_mov_b32 s52, s39
    s_mov_b32 s39, s56
    s_branch L_k2_sw1_done
L_k2_pfrot:
    s_sub_u32 s46, s46, 5767168
    s_mov_b32 s16, s12
    s_and_b32 s17, s13, 0xffff
    s_cmp_gt_i32 s47, 0
    s_cselect_b32 s18, 5308416, 0
    s_mov_b64 s[12:13], s[14:15]
    s_mov_b64 s[14:15], s[10:11]
    s_branch L_k2_pfdone
L_k2_m0_mask:
    s_sub_i32 s48, s48, 0
    v_add_u32 v11, s48, v46
    v_mov_b32 v10, 4048155338
    s_nop 7
    v_cmp_le_i32 s[60:61], 0, v11
    v_cmp_le_i32 s[62:63], 1, v11
    v_cmp_le_i32 s[64:65], 2, v11
    v_cndmask_b32 v160, v10, v160, s[60:61]
    v_cmp_le_i32 s[60:61], 3, v11
    v_cndmask_b32 v161, v10, v161, s[62:63]
    v_cmp_le_i32 s[62:63], 8, v11
    v_cndmask_b32 v162, v10, v162, s[64:65]
    v_cmp_le_i32 s[64:65], 9, v11
    v_cndmask_b32 v163, v10, v163, s[60:61]
    v_cmp_le_i32 s[60:61], 10, v11
    v_cndmask_b32 v164, v10, v164, s[62:63]
    v_cmp_le_i32 s[62:63], 11, v11
    v_cndmask_b32 v165, v10, v165, s[64:65]
    v_cmp_le_i32 s[64:65], 16, v11
    v_cndmask_b32 v166, v10, v166, s[60:61]
    v_cmp_le_i32 s[60:61], 17, v11
    v_cndmask_b32 v167, v10, v167, s[62:63]
    v_cmp_le_i32 s[62:63], 18, v11
    v_cndmask_b32 v168, v10, v168, s[64:65]
    v_cmp_le_i32 s[64:65], 19, v11
    v_cndmask_b32 v169, v10, v169, s[60:61]
    v_cmp_le_i32 s[60:61], 24, v11
    v_cndmask_b32 v170, v10, v170, s[62:63]
    v_cmp_le_i32 s[62:63], 25, v11
    v_cndmask_b32 v171, v10, v171, s[64:65]
    v_cmp_le_i32 s[64:65], 26, v11
    v_cndmask_b32 v172, v10, v172, s[60:61]
    v_cmp_le_i32 s[60:61], 27, v11
    v_cndmask_b32 v173, v10, v173, s[62:63]
    s_nop 0
    v_cndmask_b32 v174, v10, v174, s[64:65]
    s_nop 0
    v_cndmask_b32 v175, v10, v175, s[60:61]
    s_branch L_k2_m0_nomask
L_k2_b_rare:
    s_mov_b32 s57, 65536.0
    s_nop 7
    s_nop 3
    v_max3_f32 v10, v176, v177, v45
    v_max3_f32 v10, v10, v178, v179
    v_max3_f32 v10, v10, v180, v181
    v_max3_f32 v10, v10, v182, v183
    v_max3_f32 v10, v10, v184, v185
    v_max3_f32 v10, v10, v186, v187
    v_max3_f32 v10, v10, v188, v189
    v_max3_f32 v10, v10, v190, v191
    v_mov_b32 v11, v10
    s_nop 1
    v_permlane32_swap_b32 v10, v11
    s_nop 1
    v_max_f32 v10, v10, v11
    v_mov_b32 v45, 0
    v_max_f32 v11, 0, v10
    v_exp_f32 v11, -v11
    v_sub_f32 v176, v176, v10
    v_sub_f32 v177, v177, v10
    v_sub_f32 v178, v178, v10
    v_sub_f32 v179, v179, v10
    v_sub_f32 v180, v180, v10
    v_sub_f32 v181, v181, v10
    v_sub_f32 v182, v182, v10
    v_sub_f32 v183, v183, v10
    v_sub_f32 v184, v184, v10
    v_sub_f32 v185, v185, v10
    v_sub_f32 v186, v186, v10
    v_sub_f32 v187, v187, v10
    v_sub_f32 v188, v188, v10
    v_sub_f32 v189, v189, v10
    v_sub_f32 v190, v190, v10
    v_sub_f32 v191, v191, v10
    v_sub_f32 v160, v160, v10
    v_sub_f32 v161, v161, v10
    v_sub_f32 v162, v162, v10
    v_sub_f32 v163, v163, v10
    v_sub_f32 v164, v164, v10
    v_sub_f32 v165, v165, v10
    v_sub_f32 v166, v166, v10
    v_sub_f32 v167, v167, v10
    v_sub_f32 v168, v168, v10
    v_sub_f32 v169, v169, v10
    v_sub_f32 v170, v170, v10
    v_sub_f32 v171, v171, v10
    v_sub_f32 v172, v172, v10
    v_sub_f32 v173, v173, v10
    v_sub_f32 v174, v174, v10
    v_sub_f32 v175, v175, v10
    v_sub_f32 v112, v112, v10
    v_sub_f32 v113, v113, v10
    v_sub_f32 v114, v114, v10
    v_sub_f32 v115, v115, v10
    v_sub_f32 v116, v116, v10
    v_sub_f32 v117, v117, v10
    v_sub_f32 v118, v118, v10
    v_sub_f32 v119, v119, v10
    v_sub_f32 v120, v120, v10
    v_sub_f32 v121, v121, v10
    v_sub_f32 v122, v122, v10
    v_sub_f32 v123, v123, v10
    v_sub_f32 v124, v124, v10
    v_sub_f32 v125, v125, v10
    v_sub_f32 v126, v126, v10
    v_sub_f32 v127, v127, v10
    v_mul_f32 v192, v192, v11
    v_mul_f32 v193, v193, v11
    v_mul_f32 v194, v194, v11
    v_mul_f32 v195, v195, v11
    v_mul_f32 v196, v196, v11
    v_mul_f32 v197, v197, v11
    v_mul_f32 v198, v198, v11
    v_mul_f32 v199, v199, v11
    v_mul_f32 v200, v200, v11
    v_mul_f32 v201, v201, v11
    v_mul_f32 v202, v202, v11
    v_mul_f32 v203, v203, v11
    v_mul_f32 v204, v204, v11
    v_mul_f32 v205, v205, v11
    v_mul_f32 v206, v206, v11
    v_mul_f32 v207, v207, v11
    v_mul_f32 v208, v208, v11
    v_mul_f32 v209, v209, v11
    v_mul_f32 v210, v210, v11
    v_mul_f32 v211, v211, v11
    v_mul_f32 v212, v212, v11
    v_mul_f32 v213, v213, v11
    v_mul_f32 v214, v214, v11
    v_mul_f32 v215, v215, v11
    v_mul_f32 v216, v216, v11
    v_mul_f32 v217, v217, v11
    v_mul_f32 v218, v218, v11
    v_mul_f32 v219, v219, v11
    v_mul_f32 v220, v220, v11
    v_mul_f32 v221, v221, v11
    v_mul_f32 v222, v222, v11
    v_mul_f32 v223, v223, v11
    v_mul_f32 v224, v224, v11
    v_mul_f32 v225, v225, v11
    v_mul_f32 v226, v226, v11
    v_mul_f32 v227, v227, v11
    v_mul_f32 v228, v228, v11
    v_mul_f32 v229, v229, v11
    v_mul_f32 v230, v230, v11
    v_mul_f32 v231, v231, v11
    v_mul_f32 v232, v232, v11
    v_mul_f32 v233, v233, v11
    v_mul_f32 v234, v234, v11
    v_mul_f32 v235, v235, v11
    v_mul_f32 v236, v236, v11
    v_mul_f32 v237, v237, v11
    v_mul_f32 v238, v238, v11
    v_mul_f32 v239, v239, v11
    v_mul_f32 v240, v240, v11
    v_mul_f32 v241, v241, v11
    v_mul_f32 v242, v242, v11
    v_mul_f32 v243, v243, v11
    v_mul_f32 v244, v244, v11
    v_mul_f32 v245, v245, v11
    v_mul_f32 v246, v246, v11
    v_mul_f32 v247, v247, v11
    v_mul_f32 v248, v248, v11
    v_mul_f32 v249, v249, v11
    v_mul_f32 v250, v250, v11
    v_mul_f32 v251, v251, v11
    v_mul_f32 v252, v252, v11
    v_mul_f32 v253, v253, v11
    v_mul_f32 v254, v254, v11
    v_mul_f32 v255, v255, v11
    v_mul_f32 v44, v44, v11
    v_exp_f32 v48, v176
    v_exp_f32 v49, v177
    v_exp_f32 v50, v178
    v_exp_f32 v51, v179
    v_add_f32 v9, v48, v49
    v_cvt_pk_bf16_f32 v104, v48, v49
    v_exp_f32 v52, v180
    v_add_f32 v9, v9, v50
    v_add_f32 v9, v9, v51
    v_exp_f32 v53, v181
    v_cvt_pk_bf16_f32 v105, v50, v51
    v_add_f32 v9, v9, v52
    v_exp_f32 v54, v182
    v_add_f32 v9, v9, v53
    v_cvt_pk_bf16_f32 v106, v52, v53
    v_exp_f32 v55, v183
    v_add_f32 v9, v9, v54
    v_add_f32 v9, v9, v55
    v_cvt_pk_bf16_f32 v107, v54, v55
    s_nop 0
    v_exp_f32 v48, v184
    v_exp_f32 v49, v185
    v_exp_f32 v50, v186
    v_exp_f32 v51, v187
    v_add_f32 v9, v9, v48
    v_add_f32 v9, v9, v49
    v_exp_f32 v52, v188
    v_cvt_pk_bf16_f32 v108, v48, v49
    v_add_f32 v9, v9, v50
    v_exp_f32 v53, v189
    v_add_f32 v9, v9, v51
    v_cvt_pk_bf16_f32 v109, v50, v51
    v_exp_f32 v54, v190
    v_add_f32 v9, v9, v52
    v_add_f32 v9, v9, v53
    v_exp_f32 v55, v191
    v_cvt_pk_bf16_f32 v110, v52, v53
    v_add_f32 v9, v9, v54
    v_add_f32 v9, v9, v55
    v_cvt_pk_bf16_f32 v111, v54, v55
    s_nop 0
    s_branch L_k2_b_go
L_code_end:
.section .rodata,"a"
.p2align 6
.amdhsa_kernel mega_kernel
  .amdhsa_next_free_vgpr 256
  .amdhsa_next_free_sgpr 102
  .amdhsa_accum_offset 256
  .amdhsa_group_segment_fixed_size 0
  .amdhsa_kernarg_size 104
  .amdhsa_user_sgpr_count 2
  .amdhsa_user_sgpr_kernarg_segment_ptr 1
  .amdhsa_system_sgpr_workgroup_id_x 1
.end_amdhsa_kernel
```
